```python
import torch

def _softmax(x, axis=-1):
    return torch.softmax(x, dim=axis)
def _gelu(x):
    return torch.nn.functional.gelu(x, approximate="tanh")
def _silu(x):
    return torch.nn.functional.silu(x)
def _sigmoid(x):
    return torch.sigmoid(x)
def _layernorm(x, axis=-1, eps=1e-5):
    m = x.mean(dim=axis, keepdim=True)
    v = x.var(dim=axis, keepdim=True, unbiased=False)
    return (x - m) / torch.sqrt(v + eps)
def _scatter_add(tgt, idx, src, axis=0):
    return tgt.clone().index_add_(axis, idx, src)
def _segment_sum(src, seg, n):
    out = torch.zeros((n,) + src.shape[1:], dtype=src.dtype)
    return out.index_add_(0, seg, src)
def _pad(x, pw):
    flat = tuple(v for pair in reversed(pw) for v in pair)
    return torch.nn.functional.pad(x, flat)

kernel_name = 'interleave_layers__softmax_full_mha__glu_gated_swiglu__prompt'

def setup_inputs():

    _w = (lambda a: (lambda t: t.to(torch.bfloat16) if t.is_floating_point() else t)(torch.as_tensor(a)))
    def _A_setup():
        B, S, D = 1, 2048, 512
        return {
            "x": _w((lambda *s: torch.randn(*s, dtype=torch.bfloat16) * 0.05)(B, S, D)),
            "wqkv": _w((lambda *s: torch.randn(*s, dtype=torch.bfloat16) * 0.05)(D, 3 * D)),
            "wo": _w((lambda *s: torch.randn(*s, dtype=torch.bfloat16) * 0.05)(D, D)),
        }
    _A_in = _A_setup()

    def _B_setup():
        B, S, D, F = 1, 2048, 512, 1792
        return {
            "x": _w((lambda *s: torch.randn(*s, dtype=torch.bfloat16) * 0.05)(B, S, D)),
            "w1": _w((lambda *s: torch.randn(*s, dtype=torch.bfloat16) * 0.4)(D, F) * (2.0 / D) ** 0.5),
            "w3": _w((lambda *s: torch.randn(*s, dtype=torch.bfloat16) * 0.4)(D, F) * (2.0 / D) ** 0.5),
            "w2": _w((lambda *s: torch.randn(*s, dtype=torch.bfloat16) * 0.4)(F, D) * (2.0 / F) ** 0.5),
        }
    _B_in = _B_setup()

    return {
        "A_x": _A_in["x"],
        "A_wqkv": _A_in["wqkv"],
        "A_wo": _A_in["wo"],
        "B_x": _B_in["x"],
        "B_w1": _B_in["w1"],
        "B_w3": _B_in["w3"],
        "B_w2": _B_in["w2"],
    }

def reference(A_x, A_wqkv, A_wo, B_x, B_w1, B_w3, B_w2):
    def _A_ref(x, wqkv, wo):
        B, S, D = x.shape
        H = 32; Dh = D // H
        qkv = (lambda x, *d: x.permute(*d))((x @ wqkv).reshape(B, S, 3, H, Dh), 2, 0, 3, 1, 4)
        q, k, v = qkv[0], qkv[1], qkv[2]
        scale = Dh ** -0.5
        scores = torch.einsum("bhqd,bhkd->bhqk", q, k) * scale
        p = _softmax(scores, axis=-1)
        o = torch.einsum("bhqk,bhkd->bhqd", p, v)
        return (lambda x, *d: x.permute(*d))(o, 0, 2, 1, 3).reshape(B, S, D) @ wo

    def _B_ref(x, w1, w3, w2):
        gate = torch.einsum("bsd,df->bsf", x, w1)
        up = torch.einsum("bsd,df->bsf", x, w3)
        h = _silu(gate) * up
        out = torch.einsum("bsf,fd->bsd", h, w2)
        return out

    x = A_x
    x = x + _A_ref(_layernorm(x, axis=-1), A_wqkv, A_wo)
    x = x + _B_ref(_layernorm(x, axis=-1), B_w1, B_w3, B_w2)
    x = x + _A_ref(_layernorm(x, axis=-1), A_wqkv, A_wo)
    x = x + _B_ref(_layernorm(x, axis=-1), B_w1, B_w3, B_w2)
    return x
```

```asm
; @launch grid=(256,1,1) block=(512,1,1) lds=163840
.amdgcn_target "amdgcn-amd-amdhsa--gfx950"
.text
.globl interleave_layers__softmax_full_mha__glu_gated_swiglu__prompt_kernel
.p2align 8
.type interleave_layers__softmax_full_mha__glu_gated_swiglu__prompt_kernel,@function
interleave_layers__softmax_full_mha__glu_gated_swiglu__prompt_kernel:
    s_getpc_b64 s[96:97]
L_pc:
    s_load_dwordx16 s[20:35], s[0:1], 0
    v_lshrrev_b32 v2, 5, v0
    s_lshr_b32 s41, s2, 3
    v_lshl_add_u32 v2, s41, 4, v2
    v_lshlrev_b32 v2, 7, v2
    v_min_u32 v2, L_end-L_pc-4, v2
    global_load_dword v14, v2, s[96:97]
    s_load_dwordx4 s[36:39], s[0:1], 64
    s_cmp_ge_u32 s2, 256
    s_cbranch_scc1 L_exit
    s_and_b32 s40, s2, 7
    v_lshrrev_b32 v1, 6, v0
    v_and_b32 v0, 63, v0
    v_readfirstlane_b32 s42, v1
    v_lshlrev_b32 v1, 4, v0
    v_lshrrev_b32 v4, 3, v0
    v_and_b32 v5, 0x70, v1
    v_lshl_add_u32 v6, v4, 10, v5
    s_lshl_b32 s52, s40, 18
    s_and_b32 s57, s41, 3
    s_lshl_b32 s57, s57, 16
    s_add_u32 s52, s52, s57
    s_lshl_b32 s57, s42, 13
    s_add_u32 s52, s52, s57
    s_lshr_b32 s53, s41, 2
    s_waitcnt lgkmcnt(0)
    s_mov_b32 s8, s20
    s_and_b32 s9, s21, 0xffff
    s_mov_b32 s10, 2097152
    s_mov_b32 s11, 0x20000
    s_and_b32 s54, s53, 7
    s_lshl_b32 s54, s54, 7
    s_add_u32 s54, s54, s52
    buffer_load_dwordx4 v[128:131], v6, s[8:11], s54 offen
    v_lshlrev_b32 v7, 4, v4
    v_xor_b32 v7, v7, v5
    v_lshl_add_u32 v7, v5, 5, v7
    s_lshr_b32 s50, s42, 2
    s_lshl_b32 s50, s50, 15
    s_and_b32 s57, s42, 3
    s_lshl_b32 s57, s57, 7
    s_add_u32 s50, s50, s57
    v_add_u32 v7, s50, v7
    s_and_b32 s51, s41, 1
    s_mov_b32 s82, 0xffff0000
    s_barrier
    s_sub_u32 s50, s53, s40
    s_xor_b32 s50, s50, s51
    s_and_b32 s50, s50, 7
    v_lshl_add_u32 v224, s50, 12, v7
    s_add_u32 s53, s53, 1
    s_and_b32 s54, s53, 7
    s_lshl_b32 s54, s54, 7
    s_add_u32 s54, s54, s52
    buffer_load_dwordx4 v[132:135], v6, s[8:11], s54 offen
    s_sub_u32 s50, s53, s40
    s_xor_b32 s50, s50, s51
    s_and_b32 s50, s50, 7
    v_lshl_add_u32 v225, s50, 12, v7
    s_add_u32 s53, s53, 1
    s_and_b32 s54, s53, 7
    s_lshl_b32 s54, s54, 7
    s_add_u32 s54, s54, s52
    buffer_load_dwordx4 v[136:139], v6, s[8:11], s54 offen
    s_sub_u32 s50, s53, s40
    s_xor_b32 s50, s50, s51
    s_and_b32 s50, s50, 7
    v_lshl_add_u32 v226, s50, 12, v7
    s_add_u32 s53, s53, 1
    s_and_b32 s54, s53, 7
    s_lshl_b32 s54, s54, 7
    s_add_u32 s54, s54, s52
    buffer_load_dwordx4 v[140:143], v6, s[8:11], s54 offen
    s_sub_u32 s50, s53, s40
    s_xor_b32 s50, s50, s51
    s_and_b32 s50, s50, 7
    v_lshl_add_u32 v227, s50, 12, v7
    s_add_u32 s53, s53, 1
    s_and_b32 s54, s53, 7
    s_lshl_b32 s54, s54, 7
    s_add_u32 s54, s54, s52
    buffer_load_dwordx4 v[144:147], v6, s[8:11], s54 offen
    s_sub_u32 s50, s53, s40
    s_xor_b32 s50, s50, s51
    s_and_b32 s50, s50, 7
    v_lshl_add_u32 v228, s50, 12, v7
    s_add_u32 s53, s53, 1
    s_and_b32 s54, s53, 7
    s_lshl_b32 s54, s54, 7
    s_add_u32 s54, s54, s52
    buffer_load_dwordx4 v[148:151], v6, s[8:11], s54 offen
    s_sub_u32 s50, s53, s40
    s_xor_b32 s50, s50, s51
    s_and_b32 s50, s50, 7
    v_lshl_add_u32 v229, s50, 12, v7
    s_add_u32 s53, s53, 1
    s_and_b32 s54, s53, 7
    s_lshl_b32 s54, s54, 7
    s_add_u32 s54, s54, s52
    buffer_load_dwordx4 v[152:155], v6, s[8:11], s54 offen
    s_sub_u32 s50, s53, s40
    s_xor_b32 s50, s50, s51
    s_and_b32 s50, s50, 7
    v_lshl_add_u32 v230, s50, 12, v7
    s_add_u32 s53, s53, 1
    s_and_b32 s54, s53, 7
    s_lshl_b32 s54, s54, 7
    s_add_u32 s54, s54, s52
    buffer_load_dwordx4 v[156:159], v6, s[8:11], s54 offen
    s_sub_u32 s50, s53, s40
    s_xor_b32 s50, s50, s51
    s_and_b32 s50, s50, 7
    v_lshl_add_u32 v231, s50, 12, v7
    s_mov_b32 s4, s38
    s_and_b32 s5, s39, 0xffff
    s_mov_b32 s6, 28311552
    s_mov_b32 s7, 0x20000
    s_cmp_ge_u32 s42, 4
    s_cbranch_scc1 L_startL
    s_mov_b32 s3, 0
    s_cmp_lg_u32 s3, 0
    s_waitcnt vmcnt(6)
.p2align 3
L_ln0:
    v_lshlrev_b32 v160, 16, v128
    v_and_b32 v161, s82, v128
    v_pk_mul_f32 v[28:29], v[160:161], v[160:161]
    v_lshlrev_b32 v162, 16, v129
    v_and_b32 v163, s82, v129
    v_pk_add_f32 v[26:27], v[162:163], v[160:161]
    v_pk_fma_f32 v[28:29], v[162:163], v[162:163], v[28:29]
    v_lshlrev_b32 v164, 16, v130
    v_and_b32 v165, s82, v130
    v_pk_add_f32 v[26:27], v[164:165], v[26:27]
    v_pk_fma_f32 v[28:29], v[164:165], v[164:165], v[28:29]
    v_lshlrev_b32 v166, 16, v131
    v_and_b32 v167, s82, v131
    v_pk_add_f32 v[26:27], v[166:167], v[26:27]
    v_pk_fma_f32 v[28:29], v[166:167], v[166:167], v[28:29]
    v_lshlrev_b32 v168, 16, v132
    v_and_b32 v169, s82, v132
    v_pk_add_f32 v[26:27], v[168:169], v[26:27]
    v_pk_fma_f32 v[28:29], v[168:169], v[168:169], v[28:29]
    v_lshlrev_b32 v170, 16, v133
    v_and_b32 v171, s82, v133
    v_pk_add_f32 v[26:27], v[170:171], v[26:27]
    v_pk_fma_f32 v[28:29], v[170:171], v[170:171], v[28:29]
    v_lshlrev_b32 v172, 16, v134
    v_and_b32 v173, s82, v134
    v_pk_add_f32 v[26:27], v[172:173], v[26:27]
    v_pk_fma_f32 v[28:29], v[172:173], v[172:173], v[28:29]
    v_lshlrev_b32 v174, 16, v135
    v_and_b32 v175, s82, v135
    v_pk_add_f32 v[26:27], v[174:175], v[26:27]
    v_pk_fma_f32 v[28:29], v[174:175], v[174:175], v[28:29]
    s_cbranch_scc1 L_ln8
    s_waitcnt vmcnt(4)
L_ln8:
    v_lshlrev_b32 v176, 16, v136
    v_and_b32 v177, s82, v136
    v_pk_add_f32 v[26:27], v[176:177], v[26:27]
    v_pk_fma_f32 v[28:29], v[176:177], v[176:177], v[28:29]
    v_lshlrev_b32 v178, 16, v137
    v_and_b32 v179, s82, v137
    v_pk_add_f32 v[26:27], v[178:179], v[26:27]
    v_pk_fma_f32 v[28:29], v[178:179], v[178:179], v[28:29]
    v_lshlrev_b32 v180, 16, v138
    v_and_b32 v181, s82, v138
    v_pk_add_f32 v[26:27], v[180:181], v[26:27]
    v_pk_fma_f32 v[28:29], v[180:181], v[180:181], v[28:29]
    v_lshlrev_b32 v182, 16, v139
    v_and_b32 v183, s82, v139
    v_pk_add_f32 v[26:27], v[182:183], v[26:27]
    v_pk_fma_f32 v[28:29], v[182:183], v[182:183], v[28:29]
    v_lshlrev_b32 v184, 16, v140
    v_and_b32 v185, s82, v140
    v_pk_add_f32 v[26:27], v[184:185], v[26:27]
    v_pk_fma_f32 v[28:29], v[184:185], v[184:185], v[28:29]
    v_lshlrev_b32 v186, 16, v141
    v_and_b32 v187, s82, v141
    v_pk_add_f32 v[26:27], v[186:187], v[26:27]
    v_pk_fma_f32 v[28:29], v[186:187], v[186:187], v[28:29]
    v_lshlrev_b32 v188, 16, v142
    v_and_b32 v189, s82, v142
    v_pk_add_f32 v[26:27], v[188:189], v[26:27]
    v_pk_fma_f32 v[28:29], v[188:189], v[188:189], v[28:29]
    v_lshlrev_b32 v190, 16, v143
    v_and_b32 v191, s82, v143
    v_pk_add_f32 v[26:27], v[190:191], v[26:27]
    v_pk_fma_f32 v[28:29], v[190:191], v[190:191], v[28:29]
    s_cbranch_scc1 L_ln16
    s_waitcnt vmcnt(2)
L_ln16:
    v_lshlrev_b32 v192, 16, v144
    v_and_b32 v193, s82, v144
    v_pk_add_f32 v[26:27], v[192:193], v[26:27]
    v_pk_fma_f32 v[28:29], v[192:193], v[192:193], v[28:29]
    v_lshlrev_b32 v194, 16, v145
    v_and_b32 v195, s82, v145
    v_pk_add_f32 v[26:27], v[194:195], v[26:27]
    v_pk_fma_f32 v[28:29], v[194:195], v[194:195], v[28:29]
    v_lshlrev_b32 v196, 16, v146
    v_and_b32 v197, s82, v146
    v_pk_add_f32 v[26:27], v[196:197], v[26:27]
    v_pk_fma_f32 v[28:29], v[196:197], v[196:197], v[28:29]
    v_lshlrev_b32 v198, 16, v147
    v_and_b32 v199, s82, v147
    v_pk_add_f32 v[26:27], v[198:199], v[26:27]
    v_pk_fma_f32 v[28:29], v[198:199], v[198:199], v[28:29]
    v_lshlrev_b32 v200, 16, v148
    v_and_b32 v201, s82, v148
    v_pk_add_f32 v[26:27], v[200:201], v[26:27]
    v_pk_fma_f32 v[28:29], v[200:201], v[200:201], v[28:29]
    v_lshlrev_b32 v202, 16, v149
    v_and_b32 v203, s82, v149
    v_pk_add_f32 v[26:27], v[202:203], v[26:27]
    v_pk_fma_f32 v[28:29], v[202:203], v[202:203], v[28:29]
    v_lshlrev_b32 v204, 16, v150
    v_and_b32 v205, s82, v150
    v_pk_add_f32 v[26:27], v[204:205], v[26:27]
    v_pk_fma_f32 v[28:29], v[204:205], v[204:205], v[28:29]
    v_lshlrev_b32 v206, 16, v151
    v_and_b32 v207, s82, v151
    v_pk_add_f32 v[26:27], v[206:207], v[26:27]
    v_pk_fma_f32 v[28:29], v[206:207], v[206:207], v[28:29]
    s_cbranch_scc1 L_ln24
    s_waitcnt vmcnt(0)
L_ln24:
    v_lshlrev_b32 v208, 16, v152
    v_and_b32 v209, s82, v152
    v_pk_add_f32 v[26:27], v[208:209], v[26:27]
    v_pk_fma_f32 v[28:29], v[208:209], v[208:209], v[28:29]
    v_lshlrev_b32 v210, 16, v153
    v_and_b32 v211, s82, v153
    v_pk_add_f32 v[26:27], v[210:211], v[26:27]
    v_pk_fma_f32 v[28:29], v[210:211], v[210:211], v[28:29]
    v_lshlrev_b32 v212, 16, v154
    v_and_b32 v213, s82, v154
    v_pk_add_f32 v[26:27], v[212:213], v[26:27]
    v_pk_fma_f32 v[28:29], v[212:213], v[212:213], v[28:29]
    v_lshlrev_b32 v214, 16, v155
    v_and_b32 v215, s82, v155
    v_pk_add_f32 v[26:27], v[214:215], v[26:27]
    v_pk_fma_f32 v[28:29], v[214:215], v[214:215], v[28:29]
    v_lshlrev_b32 v216, 16, v156
    v_and_b32 v217, s82, v156
    v_pk_add_f32 v[26:27], v[216:217], v[26:27]
    v_pk_fma_f32 v[28:29], v[216:217], v[216:217], v[28:29]
    v_lshlrev_b32 v218, 16, v157
    v_and_b32 v219, s82, v157
    v_pk_add_f32 v[26:27], v[218:219], v[26:27]
    v_pk_fma_f32 v[28:29], v[218:219], v[218:219], v[28:29]
    v_lshlrev_b32 v220, 16, v158
    v_and_b32 v221, s82, v158
    v_pk_add_f32 v[26:27], v[220:221], v[26:27]
    v_pk_fma_f32 v[28:29], v[220:221], v[220:221], v[28:29]
    v_lshlrev_b32 v222, 16, v159
    v_and_b32 v223, s82, v159
    v_pk_add_f32 v[26:27], v[222:223], v[26:27]
    v_pk_fma_f32 v[28:29], v[222:223], v[222:223], v[28:29]
    v_add_f32 v26, v26, v27
    v_add_f32 v28, v28, v29
    s_nop 0
    v_add_f32_dpp v26, v26, v26 quad_perm:[1,0,3,2] row_mask:0xf bank_mask:0xf
    v_add_f32_dpp v28, v28, v28 quad_perm:[1,0,3,2] row_mask:0xf bank_mask:0xf
    s_nop 0
    v_add_f32_dpp v26, v26, v26 quad_perm:[2,3,0,1] row_mask:0xf bank_mask:0xf
    v_add_f32_dpp v28, v28, v28 quad_perm:[2,3,0,1] row_mask:0xf bank_mask:0xf
    s_nop 0
    v_add_f32_dpp v26, v26, v26 row_half_mirror row_mask:0xf bank_mask:0xf
    v_add_f32_dpp v28, v28, v28 row_half_mirror row_mask:0xf bank_mask:0xf
    v_mul_f32 v26, 0xbb000000, v26
    v_mul_f32 v28, 0x3b000000, v28
    v_fma_f32 v28, -v26, v26, v28
    v_max_f32 v28, 0, v28
    v_add_f32 v28, 0x3727c5ac, v28
    v_rsq_f32 v28, v28
    s_nop 0
    v_mul_f32 v26, v26, v28
.p2align 3
    v_pk_fma_f32 v[160:161], v[160:161], v[28:29], v[26:27] op_sel_hi:[1,0,0]
    v_cvt_pk_bf16_f32 v128, v160, v161
    v_pk_fma_f32 v[162:163], v[162:163], v[28:29], v[26:27] op_sel_hi:[1,0,0]
    v_cvt_pk_bf16_f32 v129, v162, v163
    v_pk_fma_f32 v[164:165], v[164:165], v[28:29], v[26:27] op_sel_hi:[1,0,0]
    v_cvt_pk_bf16_f32 v130, v164, v165
    v_pk_fma_f32 v[166:167], v[166:167], v[28:29], v[26:27] op_sel_hi:[1,0,0]
    v_cvt_pk_bf16_f32 v131, v166, v167
    ds_write_b128 v224, v[128:131]
    v_pk_fma_f32 v[168:169], v[168:169], v[28:29], v[26:27] op_sel_hi:[1,0,0]
    v_cvt_pk_bf16_f32 v132, v168, v169
    v_pk_fma_f32 v[170:171], v[170:171], v[28:29], v[26:27] op_sel_hi:[1,0,0]
    v_cvt_pk_bf16_f32 v133, v170, v171
    v_pk_fma_f32 v[172:173], v[172:173], v[28:29], v[26:27] op_sel_hi:[1,0,0]
    v_cvt_pk_bf16_f32 v134, v172, v173
    v_pk_fma_f32 v[174:175], v[174:175], v[28:29], v[26:27] op_sel_hi:[1,0,0]
    v_cvt_pk_bf16_f32 v135, v174, v175
    ds_write_b128 v225, v[132:135]
    v_pk_fma_f32 v[176:177], v[176:177], v[28:29], v[26:27] op_sel_hi:[1,0,0]
    v_cvt_pk_bf16_f32 v136, v176, v177
    v_pk_fma_f32 v[178:179], v[178:179], v[28:29], v[26:27] op_sel_hi:[1,0,0]
    v_cvt_pk_bf16_f32 v137, v178, v179
    v_pk_fma_f32 v[180:181], v[180:181], v[28:29], v[26:27] op_sel_hi:[1,0,0]
    v_cvt_pk_bf16_f32 v138, v180, v181
    v_pk_fma_f32 v[182:183], v[182:183], v[28:29], v[26:27] op_sel_hi:[1,0,0]
    v_cvt_pk_bf16_f32 v139, v182, v183
    ds_write_b128 v226, v[136:139]
    v_pk_fma_f32 v[184:185], v[184:185], v[28:29], v[26:27] op_sel_hi:[1,0,0]
    v_cvt_pk_bf16_f32 v140, v184, v185
    v_pk_fma_f32 v[186:187], v[186:187], v[28:29], v[26:27] op_sel_hi:[1,0,0]
    v_cvt_pk_bf16_f32 v141, v186, v187
    v_pk_fma_f32 v[188:189], v[188:189], v[28:29], v[26:27] op_sel_hi:[1,0,0]
    v_cvt_pk_bf16_f32 v142, v188, v189
    v_pk_fma_f32 v[190:191], v[190:191], v[28:29], v[26:27] op_sel_hi:[1,0,0]
    v_cvt_pk_bf16_f32 v143, v190, v191
    ds_write_b128 v227, v[140:143]
    v_pk_fma_f32 v[192:193], v[192:193], v[28:29], v[26:27] op_sel_hi:[1,0,0]
    v_cvt_pk_bf16_f32 v144, v192, v193
    v_pk_fma_f32 v[194:195], v[194:195], v[28:29], v[26:27] op_sel_hi:[1,0,0]
    v_cvt_pk_bf16_f32 v145, v194, v195
    v_pk_fma_f32 v[196:197], v[196:197], v[28:29], v[26:27] op_sel_hi:[1,0,0]
    v_cvt_pk_bf16_f32 v146, v196, v197
    v_pk_fma_f32 v[198:199], v[198:199], v[28:29], v[26:27] op_sel_hi:[1,0,0]
    v_cvt_pk_bf16_f32 v147, v198, v199
    ds_write_b128 v228, v[144:147]
    v_pk_fma_f32 v[200:201], v[200:201], v[28:29], v[26:27] op_sel_hi:[1,0,0]
    v_cvt_pk_bf16_f32 v148, v200, v201
    v_pk_fma_f32 v[202:203], v[202:203], v[28:29], v[26:27] op_sel_hi:[1,0,0]
    v_cvt_pk_bf16_f32 v149, v202, v203
    v_pk_fma_f32 v[204:205], v[204:205], v[28:29], v[26:27] op_sel_hi:[1,0,0]
    v_cvt_pk_bf16_f32 v150, v204, v205
    v_pk_fma_f32 v[206:207], v[206:207], v[28:29], v[26:27] op_sel_hi:[1,0,0]
    v_cvt_pk_bf16_f32 v151, v206, v207
    ds_write_b128 v229, v[148:151]
    v_pk_fma_f32 v[208:209], v[208:209], v[28:29], v[26:27] op_sel_hi:[1,0,0]
    v_cvt_pk_bf16_f32 v152, v208, v209
    v_pk_fma_f32 v[210:211], v[210:211], v[28:29], v[26:27] op_sel_hi:[1,0,0]
    v_cvt_pk_bf16_f32 v153, v210, v211
    v_pk_fma_f32 v[212:213], v[212:213], v[28:29], v[26:27] op_sel_hi:[1,0,0]
    v_cvt_pk_bf16_f32 v154, v212, v213
    v_pk_fma_f32 v[214:215], v[214:215], v[28:29], v[26:27] op_sel_hi:[1,0,0]
    v_cvt_pk_bf16_f32 v155, v214, v215
    ds_write_b128 v230, v[152:155]
    v_pk_fma_f32 v[216:217], v[216:217], v[28:29], v[26:27] op_sel_hi:[1,0,0]
    v_cvt_pk_bf16_f32 v156, v216, v217
    v_pk_fma_f32 v[218:219], v[218:219], v[28:29], v[26:27] op_sel_hi:[1,0,0]
    v_cvt_pk_bf16_f32 v157, v218, v219
    v_pk_fma_f32 v[220:221], v[220:221], v[28:29], v[26:27] op_sel_hi:[1,0,0]
    v_cvt_pk_bf16_f32 v158, v220, v221
    v_pk_fma_f32 v[222:223], v[222:223], v[28:29], v[26:27] op_sel_hi:[1,0,0]
    v_cvt_pk_bf16_f32 v159, v222, v223
    ds_write_b128 v231, v[156:159]
    s_cmp_lg_u32 s3, 0
    s_cbranch_scc1 L_lnL
    s_mov_b32 s44, 0
    s_mov_b32 s45, 0
    s_mov_b32 s49, 0
    s_mov_b32 s46, 100000
    s_mov_b32 s80, 0
    s_mov_b32 s81, -1
    s_mov_b32 s82, 0xffff0000
    s_mov_b32 s83, 0xffff0000
    s_lshl_b32 s58, s40, 14
    s_add_u32 s58, s58, 25165824
    s_mov_b32 s47, s58
    s_lshl_b32 s48, s41, 2
    s_lshl_b32 s57, s42, 7
    s_add_u32 s48, s48, s57
    s_add_u32 s48, s48, s58
    s_lshl_b32 s59, s41, 17
    s_add_u32 s59, s59, 16777216
    s_lshr_b32 s75, s42, 1
    s_lshr_b32 s76, s41, 3
    s_lshl_b32 s76, s76, 1
    s_and_b32 s57, s42, 1
    s_add_u32 s76, s76, s57
    s_and_b32 s50, s41, 7
    s_lshl_b32 s50, s50, 1
    s_add_u32 s50, s50, s75
    s_lshl_b32 s51, s40, 3
    s_add_u32 s51, s51, s76
    s_lshl_b32 s66, s51, 15
    s_lshl_b32 s57, s50, 11
    s_add_u32 s66, s66, s57
    s_lshl_b32 s67, s51, 12
    s_lshr_b32 s57, s50, 2
    s_lshl_b32 s57, s57, 10
    s_add_u32 s67, s67, s57
    s_and_b32 s57, s50, 3
    s_lshl_b32 s57, s57, 2
    s_add_u32 s67, s67, s57
    s_add_u32 s67, s67, 9437184
    s_mul_i32 s68, s51, 114688
    s_lshl_b32 s57, s75, 14
    s_add_u32 s68, s68, s57
    s_add_u32 s68, s68, 2097152
    s_mul_i32 s69, s51, 114688
    s_lshl_b32 s57, s75, 13
    s_add_u32 s69, s69, s57
    s_add_u32 s69, s69, 2097152
    s_lshl_b32 s70, s51, 15
    s_lshl_b32 s57, s50, 6
    s_add_u32 s70, s70, s57
    s_lshl_b32 s51, s40, 3
    s_lshr_b32 s57, s41, 4
    s_lshl_b32 s57, s57, 2
    s_add_u32 s51, s51, s57
    s_add_u32 s51, s51, s42
    s_lshl_b32 s71, s51, 15
    s_lshl_b32 s72, s51, 12
    s_add_u32 s72, s72, 9437184
    s_and_b32 s73, s41, 15
    s_mul_i32 s73, s73, 7168
    s_add_u32 s73, s73, 14155776
    s_mul_i32 s74, s51, 114688
    s_and_b32 s57, s41, 15
    s_lshl_b32 s57, s57, 10
    s_add_u32 s74, s74, s57
    s_add_u32 s74, s74, 2097152
    s_lshl_b32 s51, s40, 3
    s_and_b32 s57, s41, 1
    s_lshl_b32 s57, s57, 2
    s_add_u32 s51, s51, s57
    s_add_u32 s51, s51, s42
    s_lshl_b32 s61, s51, 15
    s_lshl_b32 s62, s51, 12
    s_add_u32 s62, s62, 9437184
    s_mul_i32 s63, s40, 917504
    s_mul_i32 s57, s42, 229376
    s_add_u32 s63, s63, s57
    s_lshl_b32 s57, s41, 10
    s_add_u32 s63, s63, s57
    s_add_u32 s63, s63, 2097152
    s_lshl_b32 s51, s40, 3
    s_and_b32 s57, s41, 3
    s_lshl_b32 s57, s57, 1
    s_add_u32 s51, s51, s57
    s_and_b32 s57, s42, 1
    s_add_u32 s51, s51, s57
    s_and_b32 s50, s41, 28
    s_and_b32 s57, s42, 2
    s_add_u32 s50, s50, s57
    s_lshl_b32 s64, s50, 17
    s_lshl_b32 s57, s51, 11
    s_add_u32 s64, s64, s57
    s_add_u32 s64, s64, 16777216
    s_mul_i32 s65, s51, 114688
    s_lshl_b32 s57, s50, 10
    s_add_u32 s65, s65, s57
    s_add_u32 s65, s65, 2097152
    s_lshl_b32 s43, s50, 10
    s_add_u32 s43, s43, s65
    s_add_u32 s43, s43, 32768
    s_and_b32 s51, s42, 1
    s_lshl_b32 s51, s51, 15
    v_and_b32 v6, 0x300, v1
    v_add3_u32 v7, v6, v1, s51
    v_lshrrev_b32 v6, 4, v6
    v_xor_b32 v8, v7, v6
    v_xor_b32 v9, 64, v8
    s_lshr_b32 s50, s42, 1
    s_lshl_b32 s50, s50, 6
    v_bfe_u32 v10, v0, 3, 1
    v_lshlrev_b32 v10, 6, v10
    v_xor_b32 v10, s50, v10
    v_and_b32 v11, 3, v0
    v_lshl_add_u32 v10, v11, 3, v10
    v_bfe_u32 v11, v0, 4, 1
    v_lshl_add_u32 v10, v11, 5, v10
    v_bfe_u32 v11, v0, 2, 2
    v_lshl_add_u32 v10, v11, 7, v10
    v_lshrrev_b32 v11, 4, v0
    v_mul_u32_u24 v11, 3072, v11
    v_add_u32 v10, v10, v11
    v_add_u32 v10, 65536, v10
    v_xor_b32 v11, 32, v10
    v_add_u32 v12, 49152, v10
    v_add_u32 v13, 49152, v11
    s_waitcnt lgkmcnt(0)
    s_barrier
    ds_read_b128 v[176:179], v8 offset:0
    ds_read_b128 v[180:183], v8 offset:256
    ds_read_b64_tr_b16 v[132:133], v10 offset:1024
    ds_read_b64_tr_b16 v[134:135], v10 offset:1536
    ds_read_b64_tr_b16 v[136:137], v10 offset:2048
    ds_read_b64_tr_b16 v[138:139], v10 offset:2560
    ds_read_b64_tr_b16 v[128:129], v10 offset:0
    ds_read_b64_tr_b16 v[130:131], v10 offset:512
    ds_read_b64_tr_b16 v[144:145], v11 offset:1024
    ds_read_b64_tr_b16 v[146:147], v11 offset:1536
    ds_read_b64_tr_b16 v[148:149], v11 offset:2048
    ds_read_b64_tr_b16 v[150:151], v11 offset:2560
    ds_read_b64_tr_b16 v[140:141], v11 offset:0
    ds_read_b64_tr_b16 v[142:143], v11 offset:512
    s_waitcnt lgkmcnt(6)
    v_mfma_f32_16x16x32_bf16 v[48:51], v[132:135], v[176:179], 0
    ds_read_b128 v[184:187], v9 offset:2048
    ds_read_b128 v[188:191], v9 offset:2304
    v_mfma_f32_16x16x32_bf16 v[52:55], v[132:135], v[180:183], 0
    ds_read_b64_tr_b16 v[156:157], v10 offset:13312
    ds_read_b64_tr_b16 v[158:159], v10 offset:13824
    v_mfma_f32_16x16x32_bf16 v[64:67], v[176:179], v[136:139], 0
    ds_read_b64_tr_b16 v[160:161], v10 offset:14336
    ds_read_b64_tr_b16 v[162:163], v10 offset:14848
    v_mfma_f32_16x16x32_bf16 v[72:75], v[180:183], v[136:139], 0
    ds_read_b64_tr_b16 v[152:153], v10 offset:12288
    ds_read_b64_tr_b16 v[154:155], v10 offset:12800
    v_mfma_f32_16x16x32_bf16 v[32:35], v[128:131], v[176:179], 0
    v_lshrrev_b32 v29, 5, v0
    v_and_b32 v30, 0xf0, v1
    v_mfma_f32_16x16x32_bf16 v[36:39], v[128:131], v[180:183], 0
    s_waitcnt lgkmcnt(8)
    v_mfma_f32_16x16x32_bf16 v[56:59], v[144:147], v[176:179], 0
    ds_read_b64_tr_b16 v[132:133], v11 offset:13312
    ds_read_b64_tr_b16 v[134:135], v11 offset:13824
    v_mfma_f32_16x16x32_bf16 v[60:63], v[144:147], v[180:183], 0
    ds_read_b64_tr_b16 v[136:137], v11 offset:14336
    ds_read_b64_tr_b16 v[138:139], v11 offset:14848
    v_mfma_f32_16x16x32_bf16 v[68:71], v[176:179], v[148:151], 0
    ds_read_b64_tr_b16 v[128:129], v11 offset:12288
    ds_read_b64_tr_b16 v[130:131], v11 offset:12800
    v_mfma_f32_16x16x32_bf16 v[76:79], v[180:183], v[148:151], 0
    v_lshl_add_u32 v30, v29, 8, v30
    v_bfe_u32 v28, v0, 4, 1
    v_mfma_f32_16x16x32_bf16 v[40:43], v[140:143], v[176:179], 0
    v_mfma_f32_16x16x32_bf16 v[44:47], v[140:143], v[180:183], 0
    s_waitcnt lgkmcnt(6)
    v_mfma_f32_16x16x32_bf16 v[48:51], v[156:159], v[184:187], v[48:51]
    s_waitcnt lgkmcnt(0)
    s_barrier
    ds_read_b128 v[176:179], v8 offset:4096
    ds_read_b128 v[180:183], v8 offset:4352
    v_mfma_f32_16x16x32_bf16 v[52:55], v[156:159], v[188:191], v[52:55]
    ds_read_b64_tr_b16 v[144:145], v10 offset:25600
    ds_read_b64_tr_b16 v[146:147], v10 offset:26112
    v_mfma_f32_16x16x32_bf16 v[64:67], v[184:187], v[160:163], v[64:67]
    ds_read_b64_tr_b16 v[148:149], v10 offset:26624
    ds_read_b64_tr_b16 v[150:151], v10 offset:27136
    v_mfma_f32_16x16x32_bf16 v[72:75], v[188:191], v[160:163], v[72:75]
    ds_read_b64_tr_b16 v[140:141], v10 offset:24576
    ds_read_b64_tr_b16 v[142:143], v10 offset:25088
    v_mfma_f32_16x16x32_bf16 v[32:35], v[152:155], v[184:187], v[32:35]
    v_lshl_add_u32 v24, v28, 9, v30
    v_and_b32 v2, 0x330, v24
    v_mfma_f32_16x16x32_bf16 v[36:39], v[152:155], v[188:191], v[36:39]
    s_waitcnt lgkmcnt(8)
    v_mfma_f32_16x16x32_bf16 v[56:59], v[132:135], v[184:187], v[56:59]
    ds_read_b64_tr_b16 v[156:157], v11 offset:25600
    ds_read_b64_tr_b16 v[158:159], v11 offset:26112
    v_mfma_f32_16x16x32_bf16 v[60:63], v[132:135], v[188:191], v[60:63]
    ds_read_b64_tr_b16 v[160:161], v11 offset:26624
    ds_read_b64_tr_b16 v[162:163], v11 offset:27136
    v_mfma_f32_16x16x32_bf16 v[68:71], v[184:187], v[136:139], v[68:71]
    ds_read_b64_tr_b16 v[152:153], v11 offset:24576
    ds_read_b64_tr_b16 v[154:155], v11 offset:25088
    v_mfma_f32_16x16x32_bf16 v[76:79], v[188:191], v[136:139], v[76:79]
    v_and_b32 v31, 0x1f0, v1
    v_lshl_add_u32 v3, v29, 17, v31
    v_mfma_f32_16x16x32_bf16 v[40:43], v[128:131], v[184:187], v[40:43]
    v_mfma_f32_16x16x32_bf16 v[44:47], v[128:131], v[188:191], v[44:47]
    s_waitcnt lgkmcnt(6)
    v_mfma_f32_16x16x32_bf16 v[48:51], v[144:147], v[176:179], v[48:51]
    ds_read_b128 v[184:187], v9 offset:6144
    ds_read_b128 v[188:191], v9 offset:6400
    v_mfma_f32_16x16x32_bf16 v[52:55], v[144:147], v[180:183], v[52:55]
    ds_read_b64_tr_b16 v[132:133], v10 offset:37888
    ds_read_b64_tr_b16 v[134:135], v10 offset:38400
    v_mfma_f32_16x16x32_bf16 v[64:67], v[176:179], v[148:151], v[64:67]
    ds_read_b64_tr_b16 v[136:137], v10 offset:38912
    ds_read_b64_tr_b16 v[138:139], v10 offset:39424
    v_mfma_f32_16x16x32_bf16 v[72:75], v[180:183], v[148:151], v[72:75]
    ds_read_b64_tr_b16 v[128:129], v10 offset:36864
    ds_read_b64_tr_b16 v[130:131], v10 offset:37376
    v_mfma_f32_16x16x32_bf16 v[32:35], v[140:143], v[176:179], v[32:35]
    v_lshl_add_u32 v4, v29, 11, v31
    v_bfe_u32 v31, v0, 2, 1
    v_mfma_f32_16x16x32_bf16 v[36:39], v[140:143], v[180:183], v[36:39]
    s_waitcnt lgkmcnt(8)
    v_mfma_f32_16x16x32_bf16 v[56:59], v[156:159], v[176:179], v[56:59]
    ds_read_b64_tr_b16 v[144:145], v11 offset:37888
    ds_read_b64_tr_b16 v[146:147], v11 offset:38400
    v_mfma_f32_16x16x32_bf16 v[60:63], v[156:159], v[180:183], v[60:63]
    ds_read_b64_tr_b16 v[148:149], v11 offset:38912
    ds_read_b64_tr_b16 v[150:151], v11 offset:39424
    v_mfma_f32_16x16x32_bf16 v[68:71], v[176:179], v[160:163], v[68:71]
    ds_read_b64_tr_b16 v[140:141], v11 offset:36864
    ds_read_b64_tr_b16 v[142:143], v11 offset:37376
    v_mfma_f32_16x16x32_bf16 v[76:79], v[180:183], v[160:163], v[76:79]
    v_lshl_add_u32 v2, v31, 7, v2
    v_bfe_u32 v31, v0, 3, 1
    v_mfma_f32_16x16x32_bf16 v[40:43], v[152:155], v[176:179], v[40:43]
    v_mfma_f32_16x16x32_bf16 v[44:47], v[152:155], v[180:183], v[44:47]
    s_waitcnt lgkmcnt(6)
    v_mfma_f32_16x16x32_bf16 v[48:51], v[132:135], v[184:187], v[48:51]
    s_waitcnt lgkmcnt(0)
    s_barrier
    ds_read_b128 v[176:179], v8 offset:8192
    ds_read_b128 v[180:183], v8 offset:8448
    v_mfma_f32_16x16x32_bf16 v[52:55], v[132:135], v[188:191], v[52:55]
    ds_read_b64_tr_b16 v[156:157], v12 offset:1024
    ds_read_b64_tr_b16 v[158:159], v12 offset:1536
    v_mfma_f32_16x16x32_bf16 v[64:67], v[184:187], v[136:139], v[64:67]
    ds_read_b64_tr_b16 v[160:161], v12 offset:2048
    ds_read_b64_tr_b16 v[162:163], v12 offset:2560
    v_mfma_f32_16x16x32_bf16 v[72:75], v[188:191], v[136:139], v[72:75]
    ds_read_b64_tr_b16 v[152:153], v12 offset:0
    ds_read_b64_tr_b16 v[154:155], v12 offset:512
    v_mfma_f32_16x16x32_bf16 v[32:35], v[128:131], v[184:187], v[32:35]
    v_lshl_add_u32 v2, v31, 6, v2
    s_lshl_b32 s50, s42, 3
    v_mfma_f32_16x16x32_bf16 v[36:39], v[128:131], v[188:191], v[36:39]
    s_waitcnt lgkmcnt(8)
    v_mfma_f32_16x16x32_bf16 v[56:59], v[144:147], v[184:187], v[56:59]
    ds_read_b64_tr_b16 v[132:133], v13 offset:1024
    ds_read_b64_tr_b16 v[134:135], v13 offset:1536
    v_mfma_f32_16x16x32_bf16 v[60:63], v[144:147], v[188:191], v[60:63]
    ds_read_b64_tr_b16 v[136:137], v13 offset:2048
    ds_read_b64_tr_b16 v[138:139], v13 offset:2560
    v_mfma_f32_16x16x32_bf16 v[68:71], v[184:187], v[148:151], v[68:71]
    ds_read_b64_tr_b16 v[128:129], v13 offset:0
    ds_read_b64_tr_b16 v[130:131], v13 offset:512
    v_mfma_f32_16x16x32_bf16 v[76:79], v[188:191], v[148:151], v[76:79]
    s_add_u32 s50, s50, 130752
    v_lshl_add_u32 v5, v29, 2, s50
    v_mfma_f32_16x16x32_bf16 v[40:43], v[140:143], v[184:187], v[40:43]
    v_mfma_f32_16x16x32_bf16 v[44:47], v[140:143], v[188:191], v[44:47]
    s_waitcnt lgkmcnt(6)
    v_mfma_f32_16x16x32_bf16 v[48:51], v[156:159], v[176:179], v[48:51]
    ds_read_b128 v[184:187], v9 offset:10240
    ds_read_b128 v[188:191], v9 offset:10496
    v_mfma_f32_16x16x32_bf16 v[52:55], v[156:159], v[180:183], v[52:55]
    ds_read_b64_tr_b16 v[144:145], v12 offset:13312
    ds_read_b64_tr_b16 v[146:147], v12 offset:13824
    v_mfma_f32_16x16x32_bf16 v[64:67], v[176:179], v[160:163], v[64:67]
    ds_read_b64_tr_b16 v[148:149], v12 offset:14336
    ds_read_b64_tr_b16 v[150:151], v12 offset:14848
    v_mfma_f32_16x16x32_bf16 v[72:75], v[180:183], v[160:163], v[72:75]
    ds_read_b64_tr_b16 v[140:141], v12 offset:12288
    ds_read_b64_tr_b16 v[142:143], v12 offset:12800
    v_mfma_f32_16x16x32_bf16 v[32:35], v[152:155], v[176:179], v[32:35]
    v_mfma_f32_16x16x32_bf16 v[36:39], v[152:155], v[180:183], v[36:39]
    s_waitcnt lgkmcnt(8)
    v_mfma_f32_16x16x32_bf16 v[56:59], v[132:135], v[176:179], v[56:59]
    ds_read_b64_tr_b16 v[156:157], v13 offset:13312
    ds_read_b64_tr_b16 v[158:159], v13 offset:13824
    v_mfma_f32_16x16x32_bf16 v[60:63], v[132:135], v[180:183], v[60:63]
    ds_read_b64_tr_b16 v[160:161], v13 offset:14336
    ds_read_b64_tr_b16 v[162:163], v13 offset:14848
    v_mfma_f32_16x16x32_bf16 v[68:71], v[176:179], v[136:139], v[68:71]
    ds_read_b64_tr_b16 v[152:153], v13 offset:12288
    ds_read_b64_tr_b16 v[154:155], v13 offset:12800
    v_mfma_f32_16x16x32_bf16 v[76:79], v[180:183], v[136:139], v[76:79]
    v_mfma_f32_16x16x32_bf16 v[40:43], v[128:131], v[176:179], v[40:43]
    v_mfma_f32_16x16x32_bf16 v[44:47], v[128:131], v[180:183], v[44:47]
    s_waitcnt lgkmcnt(6)
    v_mfma_f32_16x16x32_bf16 v[48:51], v[144:147], v[184:187], v[48:51]
    s_waitcnt lgkmcnt(0)
    s_barrier
    ds_read_b128 v[176:179], v8 offset:12288
    ds_read_b128 v[180:183], v8 offset:12544
    v_mfma_f32_16x16x32_bf16 v[52:55], v[144:147], v[188:191], v[52:55]
    ds_read_b64_tr_b16 v[132:133], v12 offset:25600
    ds_read_b64_tr_b16 v[134:135], v12 offset:26112
    v_mfma_f32_16x16x32_bf16 v[64:67], v[184:187], v[148:151], v[64:67]
    ds_read_b64_tr_b16 v[136:137], v12 offset:26624
    ds_read_b64_tr_b16 v[138:139], v12 offset:27136
    v_mfma_f32_16x16x32_bf16 v[72:75], v[188:191], v[148:151], v[72:75]
    ds_read_b64_tr_b16 v[128:129], v12 offset:24576
    ds_read_b64_tr_b16 v[130:131], v12 offset:25088
    v_mfma_f32_16x16x32_bf16 v[32:35], v[140:143], v[184:187], v[32:35]
    v_mfma_f32_16x16x32_bf16 v[36:39], v[140:143], v[188:191], v[36:39]
    s_waitcnt lgkmcnt(8)
    v_mfma_f32_16x16x32_bf16 v[56:59], v[156:159], v[184:187], v[56:59]
    ds_read_b64_tr_b16 v[144:145], v13 offset:25600
    ds_read_b64_tr_b16 v[146:147], v13 offset:26112
    v_mfma_f32_16x16x32_bf16 v[60:63], v[156:159], v[188:191], v[60:63]
    ds_read_b64_tr_b16 v[148:149], v13 offset:26624
    ds_read_b64_tr_b16 v[150:151], v13 offset:27136
    v_mfma_f32_16x16x32_bf16 v[68:71], v[184:187], v[160:163], v[68:71]
    ds_read_b64_tr_b16 v[140:141], v13 offset:24576
    ds_read_b64_tr_b16 v[142:143], v13 offset:25088
    v_mfma_f32_16x16x32_bf16 v[76:79], v[188:191], v[160:163], v[76:79]
    v_mfma_f32_16x16x32_bf16 v[40:43], v[152:155], v[184:187], v[40:43]
    v_mfma_f32_16x16x32_bf16 v[44:47], v[152:155], v[188:191], v[44:47]
    s_waitcnt lgkmcnt(6)
    v_mfma_f32_16x16x32_bf16 v[48:51], v[132:135], v[176:179], v[48:51]
    ds_read_b128 v[184:187], v9 offset:14336
    ds_read_b128 v[188:191], v9 offset:14592
    v_mfma_f32_16x16x32_bf16 v[52:55], v[132:135], v[180:183], v[52:55]
    ds_read_b64_tr_b16 v[156:157], v12 offset:37888
    ds_read_b64_tr_b16 v[158:159], v12 offset:38400
    v_mfma_f32_16x16x32_bf16 v[64:67], v[176:179], v[136:139], v[64:67]
    ds_read_b64_tr_b16 v[160:161], v12 offset:38912
    ds_read_b64_tr_b16 v[162:163], v12 offset:39424
    v_mfma_f32_16x16x32_bf16 v[72:75], v[180:183], v[136:139], v[72:75]
    ds_read_b64_tr_b16 v[152:153], v12 offset:36864
    ds_read_b64_tr_b16 v[154:155], v12 offset:37376
    v_mfma_f32_16x16x32_bf16 v[32:35], v[128:131], v[176:179], v[32:35]
    v_mfma_f32_16x16x32_bf16 v[36:39], v[128:131], v[180:183], v[36:39]
    s_waitcnt lgkmcnt(8)
    v_mfma_f32_16x16x32_bf16 v[56:59], v[144:147], v[176:179], v[56:59]
    ds_read_b64_tr_b16 v[132:133], v13 offset:37888
    ds_read_b64_tr_b16 v[134:135], v13 offset:38400
    v_mfma_f32_16x16x32_bf16 v[60:63], v[144:147], v[180:183], v[60:63]
    ds_read_b64_tr_b16 v[136:137], v13 offset:38912
    ds_read_b64_tr_b16 v[138:139], v13 offset:39424
    v_mfma_f32_16x16x32_bf16 v[68:71], v[176:179], v[148:151], v[68:71]
    ds_read_b64_tr_b16 v[128:129], v13 offset:36864
    ds_read_b64_tr_b16 v[130:131], v13 offset:37376
    v_mfma_f32_16x16x32_bf16 v[76:79], v[180:183], v[148:151], v[76:79]
    v_mfma_f32_16x16x32_bf16 v[40:43], v[140:143], v[176:179], v[40:43]
    v_mfma_f32_16x16x32_bf16 v[44:47], v[140:143], v[180:183], v[44:47]
    s_waitcnt lgkmcnt(6)
    v_mfma_f32_16x16x32_bf16 v[48:51], v[156:159], v[184:187], v[48:51]
    s_waitcnt lgkmcnt(0)
    s_barrier
    ds_read_b128 v[176:179], v8 offset:16384
    ds_read_b128 v[180:183], v8 offset:16640
    v_mfma_f32_16x16x32_bf16 v[52:55], v[156:159], v[188:191], v[52:55]
    ds_read_b64_tr_b16 v[144:145], v10 offset:1024
    ds_read_b64_tr_b16 v[146:147], v10 offset:1536
    v_mfma_f32_16x16x32_bf16 v[64:67], v[184:187], v[160:163], v[64:67]
    ds_read_b64_tr_b16 v[148:149], v10 offset:2048
    ds_read_b64_tr_b16 v[150:151], v10 offset:2560
    v_mfma_f32_16x16x32_bf16 v[72:75], v[188:191], v[160:163], v[72:75]
    ds_read_b64_tr_b16 v[140:141], v10 offset:0
    ds_read_b64_tr_b16 v[142:143], v10 offset:512
    v_mfma_f32_16x16x32_bf16 v[32:35], v[152:155], v[184:187], v[32:35]
    v_mfma_f32_16x16x32_bf16 v[36:39], v[152:155], v[188:191], v[36:39]
    s_waitcnt lgkmcnt(8)
    v_mfma_f32_16x16x32_bf16 v[56:59], v[132:135], v[184:187], v[56:59]
    ds_read_b64_tr_b16 v[156:157], v11 offset:1024
    ds_read_b64_tr_b16 v[158:159], v11 offset:1536
    v_mfma_f32_16x16x32_bf16 v[60:63], v[132:135], v[188:191], v[60:63]
    ds_read_b64_tr_b16 v[160:161], v11 offset:2048
    ds_read_b64_tr_b16 v[162:163], v11 offset:2560
    v_mfma_f32_16x16x32_bf16 v[68:71], v[184:187], v[136:139], v[68:71]
    ds_read_b64_tr_b16 v[152:153], v11 offset:0
    ds_read_b64_tr_b16 v[154:155], v11 offset:512
    v_mfma_f32_16x16x32_bf16 v[76:79], v[188:191], v[136:139], v[76:79]
    v_mfma_f32_16x16x32_bf16 v[40:43], v[128:131], v[184:187], v[40:43]
    v_mfma_f32_16x16x32_bf16 v[44:47], v[128:131], v[188:191], v[44:47]
    s_waitcnt lgkmcnt(6)
    v_mfma_f32_16x16x32_bf16 v[48:51], v[144:147], v[176:179], v[48:51]
    ds_read_b128 v[184:187], v9 offset:18432
    ds_read_b128 v[188:191], v9 offset:18688
    v_mfma_f32_16x16x32_bf16 v[52:55], v[144:147], v[180:183], v[52:55]
    ds_read_b64_tr_b16 v[132:133], v10 offset:13312
    ds_read_b64_tr_b16 v[134:135], v10 offset:13824
    v_mfma_f32_16x16x32_bf16 v[64:67], v[176:179], v[148:151], v[64:67]
    ds_read_b64_tr_b16 v[136:137], v10 offset:14336
    ds_read_b64_tr_b16 v[138:139], v10 offset:14848
    v_mfma_f32_16x16x32_bf16 v[72:75], v[180:183], v[148:151], v[72:75]
    ds_read_b64_tr_b16 v[128:129], v10 offset:12288
    ds_read_b64_tr_b16 v[130:131], v10 offset:12800
    v_mfma_f32_16x16x32_bf16 v[32:35], v[140:143], v[176:179], v[32:35]
    v_mfma_f32_16x16x32_bf16 v[36:39], v[140:143], v[180:183], v[36:39]
    s_waitcnt lgkmcnt(8)
    v_mfma_f32_16x16x32_bf16 v[56:59], v[156:159], v[176:179], v[56:59]
    ds_read_b64_tr_b16 v[144:145], v11 offset:13312
    ds_read_b64_tr_b16 v[146:147], v11 offset:13824
    v_mfma_f32_16x16x32_bf16 v[60:63], v[156:159], v[180:183], v[60:63]
    ds_read_b64_tr_b16 v[148:149], v11 offset:14336
    ds_read_b64_tr_b16 v[150:151], v11 offset:14848
    v_mfma_f32_16x16x32_bf16 v[68:71], v[176:179], v[160:163], v[68:71]
    ds_read_b64_tr_b16 v[140:141], v11 offset:12288
    ds_read_b64_tr_b16 v[142:143], v11 offset:12800
    v_mfma_f32_16x16x32_bf16 v[76:79], v[180:183], v[160:163], v[76:79]
    v_mfma_f32_16x16x32_bf16 v[40:43], v[152:155], v[176:179], v[40:43]
    v_mfma_f32_16x16x32_bf16 v[44:47], v[152:155], v[180:183], v[44:47]
    s_waitcnt lgkmcnt(6)
    v_mfma_f32_16x16x32_bf16 v[48:51], v[132:135], v[184:187], v[48:51]
    s_waitcnt lgkmcnt(0)
    s_barrier
    ds_read_b128 v[176:179], v8 offset:20480
    ds_read_b128 v[180:183], v8 offset:20736
    v_mfma_f32_16x16x32_bf16 v[52:55], v[132:135], v[188:191], v[52:55]
    ds_read_b64_tr_b16 v[156:157], v10 offset:25600
    ds_read_b64_tr_b16 v[158:159], v10 offset:26112
    v_mfma_f32_16x16x32_bf16 v[64:67], v[184:187], v[136:139], v[64:67]
    ds_read_b64_tr_b16 v[160:161], v10 offset:26624
    ds_read_b64_tr_b16 v[162:163], v10 offset:27136
    v_mfma_f32_16x16x32_bf16 v[72:75], v[188:191], v[136:139], v[72:75]
    ds_read_b64_tr_b16 v[152:153], v10 offset:24576
    ds_read_b64_tr_b16 v[154:155], v10 offset:25088
    v_mfma_f32_16x16x32_bf16 v[32:35], v[128:131], v[184:187], v[32:35]
    v_mfma_f32_16x16x32_bf16 v[36:39], v[128:131], v[188:191], v[36:39]
    s_waitcnt lgkmcnt(8)
    v_mfma_f32_16x16x32_bf16 v[56:59], v[144:147], v[184:187], v[56:59]
    ds_read_b64_tr_b16 v[132:133], v11 offset:25600
    ds_read_b64_tr_b16 v[134:135], v11 offset:26112
    v_mfma_f32_16x16x32_bf16 v[60:63], v[144:147], v[188:191], v[60:63]
    ds_read_b64_tr_b16 v[136:137], v11 offset:26624
    ds_read_b64_tr_b16 v[138:139], v11 offset:27136
    v_mfma_f32_16x16x32_bf16 v[68:71], v[184:187], v[148:151], v[68:71]
    ds_read_b64_tr_b16 v[128:129], v11 offset:24576
    ds_read_b64_tr_b16 v[130:131], v11 offset:25088
    v_mfma_f32_16x16x32_bf16 v[76:79], v[188:191], v[148:151], v[76:79]
    v_mfma_f32_16x16x32_bf16 v[40:43], v[140:143], v[184:187], v[40:43]
    v_mfma_f32_16x16x32_bf16 v[44:47], v[140:143], v[188:191], v[44:47]
    s_waitcnt lgkmcnt(6)
    v_mfma_f32_16x16x32_bf16 v[48:51], v[156:159], v[176:179], v[48:51]
    ds_read_b128 v[184:187], v9 offset:22528
    ds_read_b128 v[188:191], v9 offset:22784
    v_mfma_f32_16x16x32_bf16 v[52:55], v[156:159], v[180:183], v[52:55]
    ds_read_b64_tr_b16 v[144:145], v10 offset:37888
    ds_read_b64_tr_b16 v[146:147], v10 offset:38400
    v_mfma_f32_16x16x32_bf16 v[64:67], v[176:179], v[160:163], v[64:67]
    ds_read_b64_tr_b16 v[148:149], v10 offset:38912
    ds_read_b64_tr_b16 v[150:151], v10 offset:39424
    v_mfma_f32_16x16x32_bf16 v[72:75], v[180:183], v[160:163], v[72:75]
    ds_read_b64_tr_b16 v[140:141], v10 offset:36864
    ds_read_b64_tr_b16 v[142:143], v10 offset:37376
    v_mfma_f32_16x16x32_bf16 v[32:35], v[152:155], v[176:179], v[32:35]
    v_mfma_f32_16x16x32_bf16 v[36:39], v[152:155], v[180:183], v[36:39]
    s_waitcnt lgkmcnt(8)
    v_mfma_f32_16x16x32_bf16 v[56:59], v[132:135], v[176:179], v[56:59]
    ds_read_b64_tr_b16 v[156:157], v11 offset:37888
    ds_read_b64_tr_b16 v[158:159], v11 offset:38400
    v_mfma_f32_16x16x32_bf16 v[60:63], v[132:135], v[180:183], v[60:63]
    ds_read_b64_tr_b16 v[160:161], v11 offset:38912
    ds_read_b64_tr_b16 v[162:163], v11 offset:39424
    v_mfma_f32_16x16x32_bf16 v[68:71], v[176:179], v[136:139], v[68:71]
    ds_read_b64_tr_b16 v[152:153], v11 offset:36864
    ds_read_b64_tr_b16 v[154:155], v11 offset:37376
    v_mfma_f32_16x16x32_bf16 v[76:79], v[180:183], v[136:139], v[76:79]
    v_mfma_f32_16x16x32_bf16 v[40:43], v[128:131], v[176:179], v[40:43]
    v_mfma_f32_16x16x32_bf16 v[44:47], v[128:131], v[180:183], v[44:47]
    s_waitcnt lgkmcnt(6)
    v_mfma_f32_16x16x32_bf16 v[48:51], v[144:147], v[184:187], v[48:51]
    s_waitcnt lgkmcnt(0)
    s_barrier
    ds_read_b128 v[176:179], v8 offset:24576
    ds_read_b128 v[180:183], v8 offset:24832
    v_mfma_f32_16x16x32_bf16 v[52:55], v[144:147], v[188:191], v[52:55]
    ds_read_b64_tr_b16 v[132:133], v12 offset:1024
    ds_read_b64_tr_b16 v[134:135], v12 offset:1536
    v_mfma_f32_16x16x32_bf16 v[64:67], v[184:187], v[148:151], v[64:67]
    ds_read_b64_tr_b16 v[136:137], v12 offset:2048
    ds_read_b64_tr_b16 v[138:139], v12 offset:2560
    v_mfma_f32_16x16x32_bf16 v[72:75], v[188:191], v[148:151], v[72:75]
    ds_read_b64_tr_b16 v[128:129], v12 offset:0
    ds_read_b64_tr_b16 v[130:131], v12 offset:512
    v_mfma_f32_16x16x32_bf16 v[32:35], v[140:143], v[184:187], v[32:35]
    v_mfma_f32_16x16x32_bf16 v[36:39], v[140:143], v[188:191], v[36:39]
    s_waitcnt lgkmcnt(8)
    v_mfma_f32_16x16x32_bf16 v[56:59], v[156:159], v[184:187], v[56:59]
    ds_read_b64_tr_b16 v[144:145], v13 offset:1024
    ds_read_b64_tr_b16 v[146:147], v13 offset:1536
    v_mfma_f32_16x16x32_bf16 v[60:63], v[156:159], v[188:191], v[60:63]
    ds_read_b64_tr_b16 v[148:149], v13 offset:2048
    ds_read_b64_tr_b16 v[150:151], v13 offset:2560
    v_mfma_f32_16x16x32_bf16 v[68:71], v[184:187], v[160:163], v[68:71]
    ds_read_b64_tr_b16 v[140:141], v13 offset:0
    ds_read_b64_tr_b16 v[142:143], v13 offset:512
    v_mfma_f32_16x16x32_bf16 v[76:79], v[188:191], v[160:163], v[76:79]
    v_mfma_f32_16x16x32_bf16 v[40:43], v[152:155], v[184:187], v[40:43]
    v_mfma_f32_16x16x32_bf16 v[44:47], v[152:155], v[188:191], v[44:47]
    s_waitcnt lgkmcnt(6)
    v_mfma_f32_16x16x32_bf16 v[48:51], v[132:135], v[176:179], v[48:51]
    ds_read_b128 v[184:187], v9 offset:26624
    ds_read_b128 v[188:191], v9 offset:26880
    v_mfma_f32_16x16x32_bf16 v[52:55], v[132:135], v[180:183], v[52:55]
    ds_read_b64_tr_b16 v[156:157], v12 offset:13312
    ds_read_b64_tr_b16 v[158:159], v12 offset:13824
    v_mfma_f32_16x16x32_bf16 v[64:67], v[176:179], v[136:139], v[64:67]
    ds_read_b64_tr_b16 v[160:161], v12 offset:14336
    ds_read_b64_tr_b16 v[162:163], v12 offset:14848
    v_mfma_f32_16x16x32_bf16 v[72:75], v[180:183], v[136:139], v[72:75]
    ds_read_b64_tr_b16 v[152:153], v12 offset:12288
    ds_read_b64_tr_b16 v[154:155], v12 offset:12800
    v_mfma_f32_16x16x32_bf16 v[32:35], v[128:131], v[176:179], v[32:35]
    v_mfma_f32_16x16x32_bf16 v[36:39], v[128:131], v[180:183], v[36:39]
    s_waitcnt lgkmcnt(8)
    v_mfma_f32_16x16x32_bf16 v[56:59], v[144:147], v[176:179], v[56:59]
    ds_read_b64_tr_b16 v[132:133], v13 offset:13312
    ds_read_b64_tr_b16 v[134:135], v13 offset:13824
    v_mfma_f32_16x16x32_bf16 v[60:63], v[144:147], v[180:183], v[60:63]
    ds_read_b64_tr_b16 v[136:137], v13 offset:14336
    ds_read_b64_tr_b16 v[138:139], v13 offset:14848
    v_mfma_f32_16x16x32_bf16 v[68:71], v[176:179], v[148:151], v[68:71]
    ds_read_b64_tr_b16 v[128:129], v13 offset:12288
    ds_read_b64_tr_b16 v[130:131], v13 offset:12800
    v_mfma_f32_16x16x32_bf16 v[76:79], v[180:183], v[148:151], v[76:79]
    v_mfma_f32_16x16x32_bf16 v[40:43], v[140:143], v[176:179], v[40:43]
    v_mfma_f32_16x16x32_bf16 v[44:47], v[140:143], v[180:183], v[44:47]
    s_waitcnt lgkmcnt(6)
    v_mfma_f32_16x16x32_bf16 v[48:51], v[156:159], v[184:187], v[48:51]
    s_waitcnt lgkmcnt(0)
    s_barrier
    ds_read_b128 v[176:179], v8 offset:28672
    ds_read_b128 v[180:183], v8 offset:28928
    v_mfma_f32_16x16x32_bf16 v[52:55], v[156:159], v[188:191], v[52:55]
    ds_read_b64_tr_b16 v[144:145], v12 offset:25600
    ds_read_b64_tr_b16 v[146:147], v12 offset:26112
    v_mfma_f32_16x16x32_bf16 v[64:67], v[184:187], v[160:163], v[64:67]
    ds_read_b64_tr_b16 v[148:149], v12 offset:26624
    ds_read_b64_tr_b16 v[150:151], v12 offset:27136
    v_mfma_f32_16x16x32_bf16 v[72:75], v[188:191], v[160:163], v[72:75]
    ds_read_b64_tr_b16 v[140:141], v12 offset:24576
    ds_read_b64_tr_b16 v[142:143], v12 offset:25088
    v_mfma_f32_16x16x32_bf16 v[32:35], v[152:155], v[184:187], v[32:35]
    v_mfma_f32_16x16x32_bf16 v[36:39], v[152:155], v[188:191], v[36:39]
    s_waitcnt lgkmcnt(8)
    v_mfma_f32_16x16x32_bf16 v[56:59], v[132:135], v[184:187], v[56:59]
    ds_read_b64_tr_b16 v[156:157], v13 offset:25600
    ds_read_b64_tr_b16 v[158:159], v13 offset:26112
    v_mfma_f32_16x16x32_bf16 v[60:63], v[132:135], v[188:191], v[60:63]
    ds_read_b64_tr_b16 v[160:161], v13 offset:26624
    ds_read_b64_tr_b16 v[162:163], v13 offset:27136
    v_mfma_f32_16x16x32_bf16 v[68:71], v[184:187], v[136:139], v[68:71]
    ds_read_b64_tr_b16 v[152:153], v13 offset:24576
    ds_read_b64_tr_b16 v[154:155], v13 offset:25088
    v_mfma_f32_16x16x32_bf16 v[76:79], v[188:191], v[136:139], v[76:79]
    v_mfma_f32_16x16x32_bf16 v[40:43], v[128:131], v[184:187], v[40:43]
    v_mfma_f32_16x16x32_bf16 v[44:47], v[128:131], v[188:191], v[44:47]
    s_waitcnt lgkmcnt(6)
    v_mfma_f32_16x16x32_bf16 v[48:51], v[144:147], v[176:179], v[48:51]
    ds_read_b128 v[184:187], v9 offset:30720
    ds_read_b128 v[188:191], v9 offset:30976
    v_mfma_f32_16x16x32_bf16 v[52:55], v[144:147], v[180:183], v[52:55]
    ds_read_b64_tr_b16 v[132:133], v12 offset:37888
    ds_read_b64_tr_b16 v[134:135], v12 offset:38400
    v_mfma_f32_16x16x32_bf16 v[64:67], v[176:179], v[148:151], v[64:67]
    ds_read_b64_tr_b16 v[136:137], v12 offset:38912
    ds_read_b64_tr_b16 v[138:139], v12 offset:39424
    v_mfma_f32_16x16x32_bf16 v[72:75], v[180:183], v[148:151], v[72:75]
    ds_read_b64_tr_b16 v[128:129], v12 offset:36864
    ds_read_b64_tr_b16 v[130:131], v12 offset:37376
    v_mfma_f32_16x16x32_bf16 v[32:35], v[140:143], v[176:179], v[32:35]
    v_mfma_f32_16x16x32_bf16 v[36:39], v[140:143], v[180:183], v[36:39]
    s_waitcnt lgkmcnt(8)
    v_mfma_f32_16x16x32_bf16 v[56:59], v[156:159], v[176:179], v[56:59]
    ds_read_b64_tr_b16 v[144:145], v13 offset:37888
    ds_read_b64_tr_b16 v[146:147], v13 offset:38400
    v_mfma_f32_16x16x32_bf16 v[60:63], v[156:159], v[180:183], v[60:63]
    ds_read_b64_tr_b16 v[148:149], v13 offset:38912
    ds_read_b64_tr_b16 v[150:151], v13 offset:39424
    v_mfma_f32_16x16x32_bf16 v[68:71], v[176:179], v[160:163], v[68:71]
    ds_read_b64_tr_b16 v[140:141], v13 offset:36864
    ds_read_b64_tr_b16 v[142:143], v13 offset:37376
    v_mfma_f32_16x16x32_bf16 v[76:79], v[180:183], v[160:163], v[76:79]
    v_mfma_f32_16x16x32_bf16 v[40:43], v[152:155], v[176:179], v[40:43]
    v_mfma_f32_16x16x32_bf16 v[44:47], v[152:155], v[180:183], v[44:47]
    s_waitcnt lgkmcnt(6)
    v_mfma_f32_16x16x32_bf16 v[48:51], v[132:135], v[184:187], v[48:51]
    v_mfma_f32_16x16x32_bf16 v[52:55], v[132:135], v[188:191], v[52:55]
    v_mfma_f32_16x16x32_bf16 v[64:67], v[184:187], v[136:139], v[64:67]
    v_mfma_f32_16x16x32_bf16 v[72:75], v[188:191], v[136:139], v[72:75]
    v_mfma_f32_16x16x32_bf16 v[32:35], v[128:131], v[184:187], v[32:35]
    v_mfma_f32_16x16x32_bf16 v[36:39], v[128:131], v[188:191], v[36:39]
    s_waitcnt lgkmcnt(0)
    v_mfma_f32_16x16x32_bf16 v[56:59], v[144:147], v[184:187], v[56:59]
    v_mfma_f32_16x16x32_bf16 v[60:63], v[144:147], v[188:191], v[60:63]
    v_mfma_f32_16x16x32_bf16 v[68:71], v[184:187], v[148:151], v[68:71]
    v_mfma_f32_16x16x32_bf16 v[76:79], v[188:191], v[148:151], v[76:79]
    v_mfma_f32_16x16x32_bf16 v[40:43], v[140:143], v[184:187], v[40:43]
    v_mfma_f32_16x16x32_bf16 v[44:47], v[140:143], v[188:191], v[44:47]
    s_barrier
    v_mov_b32 v6, 0x3eb8aa3b
    v_mov_b32 v30, 130788
    ds_read_b32 v30, v30
    v_cvt_pk_bf16_f32 v152, v48, v49
    v_cvt_pk_bf16_f32 v153, v50, v51
    v_cvt_pk_bf16_f32 v154, v52, v53
    v_cvt_pk_bf16_f32 v155, v54, v55
    v_cvt_pk_bf16_f32 v156, v56, v57
    v_cvt_pk_bf16_f32 v157, v58, v59
    v_cvt_pk_bf16_f32 v158, v60, v61
    v_cvt_pk_bf16_f32 v159, v62, v63
    v_permlane32_swap_b32 v152, v154
    v_permlane32_swap_b32 v153, v155
    v_permlane32_swap_b32 v156, v158
    v_permlane32_swap_b32 v157, v159
    buffer_store_dwordx4 v[152:155], v2, s[4:7], s64 offen sc1
    s_add_u32 s51, s64, 131072
    buffer_store_dwordx4 v[156:159], v2, s[4:7], s51 offen sc1
    v_cvt_pk_bf16_f32 v160, v64, v65
    v_cvt_pk_bf16_f32 v161, v66, v67
    v_cvt_pk_bf16_f32 v162, v68, v69
    v_cvt_pk_bf16_f32 v163, v70, v71
    v_cvt_pk_bf16_f32 v164, v72, v73
    v_cvt_pk_bf16_f32 v165, v74, v75
    v_cvt_pk_bf16_f32 v166, v76, v77
    v_cvt_pk_bf16_f32 v167, v78, v79
    v_permlane32_swap_b32 v160, v162
    v_permlane32_swap_b32 v161, v163
    v_permlane32_swap_b32 v164, v166
    v_permlane32_swap_b32 v165, v167
    buffer_store_dwordx4 v[160:163], v3, s[4:7], s64 offen offset:1024 sc1
    buffer_store_dwordx4 v[164:167], v3, s[4:7], s64 offen offset:1536 sc1
    v_pk_mul_f32 v[32:33], v[32:33], v[6:7] op_sel_hi:[1,0]
    v_pk_mul_f32 v[34:35], v[34:35], v[6:7] op_sel_hi:[1,0]
    v_pk_mul_f32 v[36:37], v[36:37], v[6:7] op_sel_hi:[1,0]
    v_pk_mul_f32 v[38:39], v[38:39], v[6:7] op_sel_hi:[1,0]
    v_pk_mul_f32 v[40:41], v[40:41], v[6:7] op_sel_hi:[1,0]
    v_pk_mul_f32 v[42:43], v[42:43], v[6:7] op_sel_hi:[1,0]
    v_pk_mul_f32 v[44:45], v[44:45], v[6:7] op_sel_hi:[1,0]
    v_pk_mul_f32 v[46:47], v[46:47], v[6:7] op_sel_hi:[1,0]
    v_cvt_pk_bf16_f32 v168, v32, v33
    v_cvt_pk_bf16_f32 v169, v34, v35
    v_cvt_pk_bf16_f32 v170, v36, v37
    v_cvt_pk_bf16_f32 v171, v38, v39
    v_cvt_pk_bf16_f32 v172, v40, v41
    v_cvt_pk_bf16_f32 v173, v42, v43
    v_cvt_pk_bf16_f32 v174, v44, v45
    v_cvt_pk_bf16_f32 v175, v46, v47
    v_permlane32_swap_b32 v168, v170
    v_permlane32_swap_b32 v169, v171
    v_permlane32_swap_b32 v172, v174
    v_permlane32_swap_b32 v173, v175
    buffer_store_dwordx4 v[168:171], v24, s[4:7], s65 offen offset:0 sc1
    buffer_store_dwordx4 v[172:175], v24, s[4:7], s65 offen offset:1024 sc1
    s_waitcnt lgkmcnt(0)
    v_readfirstlane_b32 s45, v30
    s_nop 0
    s_lshl_b32 s50, s45, 10
    s_add_u32 s47, s47, s50
    s_add_u32 s48, s48, s50
    v_pk_mul_f32 v[48:49], v[48:49], v[48:49]
    v_pk_mul_f32 v[52:53], v[52:53], v[52:53]
    v_pk_mul_f32 v[56:57], v[56:57], v[56:57]
    v_pk_mul_f32 v[60:61], v[60:61], v[60:61]
    v_pk_fma_f32 v[48:49], v[50:51], v[50:51], v[48:49]
    v_pk_fma_f32 v[52:53], v[54:55], v[54:55], v[52:53]
    v_pk_fma_f32 v[56:57], v[58:59], v[58:59], v[56:57]
    v_pk_fma_f32 v[60:61], v[62:63], v[62:63], v[60:61]
    v_add_f32 v48, v48, v49
    v_add_f32 v52, v52, v53
    v_add_f32 v56, v56, v57
    v_add_f32 v60, v60, v61
    s_nop 0
    v_permlane32_swap_b32 v48, v56
    v_permlane32_swap_b32 v52, v60
    v_add_f32 v48, v48, v56
    v_add_f32 v52, v52, v60
    s_nop 1
    v_permlane16_swap_b32 v48, v52
    v_add_f32 v26, v48, v52
    s_nop 1
    v_max_u32_dpp v26, v26, v26 quad_perm:[1,0,3,2] row_mask:0xf bank_mask:0xf
    s_nop 1
    v_max_u32_dpp v26, v26, v26 quad_perm:[2,3,0,1] row_mask:0xf bank_mask:0xf
    s_nop 1
    v_max_u32_dpp v26, v26, v26 row_half_mirror row_mask:0xf bank_mask:0xf
    s_nop 1
    v_max_u32_dpp v26, v26, v26 row_mirror row_mask:0xf bank_mask:0xf
    v_mov_b32 v28, v26
    s_nop 1
    v_permlane16_swap_b32 v26, v28
    v_max_u32 v26, v26, v28
    v_or_b32 v26, 1, v26
    ds_write_b32 v5, v26
    v_lshrrev_b32 v29, 5, v0
    v_and_b32 v30, 0xf0, v1
    v_lshl_add_u32 v30, v29, 8, v30
    v_add_u32 v16, 114176, v1
    v_and_b32 v31, 15, v0
    v_min_u32 v31, 1, v31
    v_mov_b32 v28, 116224
    v_lshl_add_u32 v28, v31, 16, v28
    v_add_u32 v30, 115200, v30
    v_cndmask_b32 v17, v30, v28, s[82:83]
    v_add_u32 v30, 512, v30
    v_cndmask_b32 v20, v30, v28, s[82:83]
    v_mov_b32 v21, 0xdddddddd
    s_lshl_b32 s50, s42, 2
    s_add_u32 s50, s50, 130720
    v_mov_b32 v25, s50
    v_pk_mov_b32 v[96:97], 0, 0
    v_pk_mov_b32 v[98:99], 0, 0
    v_pk_mov_b32 v[100:101], 0, 0
    v_pk_mov_b32 v[102:103], 0, 0
    v_pk_mov_b32 v[104:105], 0, 0
    v_pk_mov_b32 v[106:107], 0, 0
    v_pk_mov_b32 v[108:109], 0, 0
    v_pk_mov_b32 v[110:111], 0, 0
    v_pk_mov_b32 v[112:113], 0, 0
    v_pk_mov_b32 v[114:115], 0, 0
    v_pk_mov_b32 v[116:117], 0, 0
    v_pk_mov_b32 v[118:119], 0, 0
    v_pk_mov_b32 v[120:121], 0, 0
    v_pk_mov_b32 v[122:123], 0, 0
    v_pk_mov_b32 v[124:125], 0, 0
    v_pk_mov_b32 v[126:127], 0, 0
    s_and_b32 s22, s41, 1
    s_xor_b32 s22, s22, 0
    s_add_u32 s22, s22, s40
    s_and_b32 s22, s22, 7
    s_lshl_b32 s22, s22, 12
    s_add_u32 s22, s22, s61
    s_and_b32 s23, s41, 1
    s_xor_b32 s23, s23, 1
    s_add_u32 s23, s23, s40
    s_and_b32 s23, s23, 7
    s_lshl_b32 s23, s23, 12
    s_add_u32 s23, s23, s61
    s_and_b32 s24, s41, 1
    s_xor_b32 s24, s24, 2
    s_add_u32 s24, s24, s40
    s_and_b32 s24, s24, 7
    s_lshl_b32 s24, s24, 12
    s_add_u32 s24, s24, s61
    s_and_b32 s25, s41, 1
    s_xor_b32 s25, s25, 3
    s_add_u32 s25, s25, s40
    s_and_b32 s25, s25, 7
    s_lshl_b32 s25, s25, 12
    s_add_u32 s25, s25, s61
    s_and_b32 s26, s41, 1
    s_xor_b32 s26, s26, 4
    s_add_u32 s26, s26, s40
    s_and_b32 s26, s26, 7
    s_lshl_b32 s26, s26, 12
    s_add_u32 s26, s26, s61
    s_and_b32 s27, s41, 1
    s_xor_b32 s27, s27, 5
    s_add_u32 s27, s27, s40
    s_and_b32 s27, s27, 7
    s_lshl_b32 s27, s27, 12
    s_add_u32 s27, s27, s61
    s_and_b32 s28, s41, 1
    s_xor_b32 s28, s28, 6
    s_add_u32 s28, s28, s40
    s_and_b32 s28, s28, 7
    s_lshl_b32 s28, s28, 12
    s_add_u32 s28, s28, s61
    s_and_b32 s29, s41, 1
    s_xor_b32 s29, s29, 7
    s_add_u32 s29, s29, s40
    s_and_b32 s29, s29, 7
    s_lshl_b32 s29, s29, 12
    s_add_u32 s29, s29, s61
    s_add_u32 s56, s49, 1
    v_mov_b32 v27, s56
    s_mov_b64 exec, 1
    s_cmp_lg_u32 s45, 0
    s_cbranch_scc1 pubs_2
    s_waitcnt vmcnt(0)
    buffer_store_dword v27, off, s[4:7], s48
pubd_3:
    s_mov_b64 exec, -1
    s_waitcnt lgkmcnt(0)
    s_lshl_b32 s53, s41, 7
    s_add_u32 s53, s53, s58
    s_add_u32 s53, s53, 4096
    s_cmp_lg_u32 s42, 0
    s_barrier
    s_cbranch_scc1 nf_1
    v_mov_b32 v32, 130752
    ds_read_b128 v[36:39], v32 offset:16
    ds_read_b128 v[32:35], v32
    s_waitcnt lgkmcnt(0)
    v_max_u32 v32, v32, v34
    v_max_u32 v33, v33, v35
    v_max_u32 v34, v36, v38
    v_max_u32 v35, v37, v39
    s_mov_b64 exec, 1
    buffer_store_dwordx4 v[32:35], off, s[4:7], s53 sc1
    s_mov_b64 exec, -1
nf_1:
L_attn:
    s_lshl_b32 s50, s42, 11
    v_add_u32 v26, s50, v1
    s_waitcnt lgkmcnt(0)
    s_barrier
    ds_read_b128 v[8:11], v26 offset:32768
    ds_read_b128 v[12:15], v26 offset:33792
    ds_read_b128 v[128:131], v16 offset:16640
    ds_read_b128 v[136:139], v17 offset:16640
    ds_read_b128 v[140:143], v20 offset:16640
    s_waitcnt lgkmcnt(3)
    v_dot2_f32_bf16 v22, v8, v8, 0
    v_dot2_f32_bf16 v23, v12, v12, 0
    v_dot2_f32_bf16 v22, v9, v9, v22
    v_dot2_f32_bf16 v23, v13, v13, v23
    v_dot2_f32_bf16 v22, v10, v10, v22
    v_dot2_f32_bf16 v23, v14, v14, v23
    v_dot2_f32_bf16 v22, v11, v11, v22
    v_dot2_f32_bf16 v23, v15, v15, v23
    s_nop 2
    v_permlane32_swap_b32 v22, v23
    v_add_f32 v22, v22, v23
    v_mul_f32 v26, 0xc0317218, v22
    v_max_f32 v26, 0xc2400000, v26
    v_mov_b32 v28, v26
    s_nop 1
    v_permlane32_swap_b32 v26, v28
    v_pk_mov_b32 v[64:65], v[26:27], v[26:27] op_sel:[0,0]
    v_pk_mov_b32 v[66:67], v[26:27], v[26:27] op_sel:[0,0]
    v_pk_mov_b32 v[68:69], v[26:27], v[26:27] op_sel:[0,0]
    v_pk_mov_b32 v[70:71], v[26:27], v[26:27] op_sel:[0,0]
    v_pk_mov_b32 v[72:73], v[26:27], v[26:27] op_sel:[0,0]
    v_pk_mov_b32 v[74:75], v[26:27], v[26:27] op_sel:[0,0]
    v_pk_mov_b32 v[76:77], v[26:27], v[26:27] op_sel:[0,0]
    v_pk_mov_b32 v[78:79], v[26:27], v[26:27] op_sel:[0,0]
    s_waitcnt lgkmcnt(0)
    s_nop 0
    v_mfma_f32_32x32x16_bf16 v[32:47], v[128:131], v[8:11], v[64:79]
    v_pk_mov_b32 v[80:81], v[28:29], v[28:29] op_sel:[0,0]
    v_pk_mov_b32 v[82:83], v[28:29], v[28:29] op_sel:[0,0]
    v_pk_mov_b32 v[84:85], v[28:29], v[28:29] op_sel:[0,0]
    v_pk_mov_b32 v[86:87], v[28:29], v[28:29] op_sel:[0,0]
    v_pk_mov_b32 v[88:89], v[28:29], v[28:29] op_sel:[0,0]
    v_pk_mov_b32 v[90:91], v[28:29], v[28:29] op_sel:[0,0]
    v_pk_mov_b32 v[92:93], v[28:29], v[28:29] op_sel:[0,0]
    v_pk_mov_b32 v[94:95], v[28:29], v[28:29] op_sel:[0,0]
.p2align 3
    s_nop 3
    v_exp_f32 v32, v32
    v_exp_f32_e64 v33, v33
    ds_read_b128 v[132:135], v16 offset:18704
    v_exp_f32 v34, v34
    v_exp_f32 v35, v35
    v_exp_f32_e64 v36, v36
    v_mfma_f32_32x32x16_bf16 v[48:63], v[128:131], v[12:15], v[80:95]
    ds_read_b128 v[144:147], v17 offset:18704
    v_exp_f32 v37, v37
    v_exp_f32 v38, v38
    v_exp_f32 v39, v39
    v_exp_f32 v40, v40
    v_exp_f32 v41, v41
    v_exp_f32 v42, v42
    v_smfmac_f32_32x32x32_bf16 v[96:111], v[136:139], v[32:39], v21
    ds_read_b128 v[148:151], v20 offset:18704
    v_exp_f32 v43, v43
    v_exp_f32 v44, v44
    v_exp_f32 v45, v45
    v_exp_f32 v46, v46
    v_exp_f32 v47, v47
    v_exp_f32 v48, v48
    v_exp_f32_e64 v49, v49
    v_smfmac_f32_32x32x32_bf16 v[96:111], v[140:143], v[40:47], v21
    s_waitcnt lgkmcnt(0)
    v_exp_f32 v50, v50
    v_exp_f32 v51, v51
    v_exp_f32 v52, v52
    v_mfma_f32_32x32x16_bf16 v[32:47], v[132:135], v[8:11], v[64:79]
    v_exp_f32 v53, v53
    v_exp_f32 v54, v54
    v_exp_f32 v55, v55
    v_exp_f32 v56, v56
    v_exp_f32 v57, v57
    v_exp_f32 v58, v58
    v_smfmac_f32_32x32x32_bf16 v[112:127], v[136:139], v[48:55], v21
    s_waitcnt vmcnt(0)
    s_barrier
    v_exp_f32 v59, v59
    v_exp_f32 v60, v60
    v_exp_f32 v61, v61
    v_exp_f32 v62, v62
    v_exp_f32 v63, v63
    v_exp_f32 v32, v32
    v_exp_f32_e64 v33, v33
    v_smfmac_f32_32x32x32_bf16 v[112:127], v[140:143], v[56:63], v21
    ds_read_b128 v[128:131], v16 offset:20768
    v_exp_f32 v34, v34
    v_exp_f32 v35, v35
    v_exp_f32_e64 v36, v36
    v_mfma_f32_32x32x16_bf16 v[48:63], v[132:135], v[12:15], v[80:95]
    ds_read_b128 v[136:139], v17 offset:20768
    v_exp_f32 v37, v37
    v_exp_f32 v38, v38
    v_exp_f32 v39, v39
    v_exp_f32 v40, v40
    v_exp_f32 v41, v41
    v_exp_f32 v42, v42
    v_smfmac_f32_32x32x32_bf16 v[96:111], v[144:147], v[32:39], v21
    ds_read_b128 v[140:143], v20 offset:20768
    v_exp_f32 v43, v43
    v_exp_f32 v44, v44
    v_exp_f32 v45, v45
    v_exp_f32 v46, v46
    v_exp_f32 v47, v47
    v_exp_f32 v48, v48
    v_exp_f32_e64 v49, v49
    v_smfmac_f32_32x32x32_bf16 v[96:111], v[148:151], v[40:47], v21
    s_waitcnt lgkmcnt(0)
    v_exp_f32 v50, v50
    v_exp_f32 v51, v51
    v_exp_f32 v52, v52
    v_mfma_f32_32x32x16_bf16 v[32:47], v[128:131], v[8:11], v[64:79]
    v_exp_f32 v53, v53
    v_exp_f32 v54, v54
    v_exp_f32 v55, v55
    v_exp_f32 v56, v56
    v_exp_f32 v57, v57
    v_exp_f32 v58, v58
    v_smfmac_f32_32x32x32_bf16 v[112:127], v[144:147], v[48:55], v21
    v_exp_f32 v59, v59
    v_exp_f32 v60, v60
    v_exp_f32 v61, v61
    v_exp_f32 v62, v62
    v_exp_f32 v63, v63
    v_exp_f32 v32, v32
    v_exp_f32_e64 v33, v33
    v_smfmac_f32_32x32x32_bf16 v[112:127], v[148:151], v[56:63], v21
    ds_read_b128 v[132:135], v16 offset:22832
    v_exp_f32 v34, v34
    v_exp_f32 v35, v35
    v_exp_f32_e64 v36, v36
    v_mfma_f32_32x32x16_bf16 v[48:63], v[128:131], v[12:15], v[80:95]
    ds_read_b128 v[144:147], v17 offset:22832
    v_exp_f32 v37, v37
    v_exp_f32 v38, v38
    v_exp_f32 v39, v39
    v_exp_f32 v40, v40
    v_exp_f32 v41, v41
    v_exp_f32 v42, v42
    v_smfmac_f32_32x32x32_bf16 v[96:111], v[136:139], v[32:39], v21
    ds_read_b128 v[148:151], v20 offset:22832
    v_exp_f32 v43, v43
    v_exp_f32 v44, v44
    v_exp_f32 v45, v45
    v_exp_f32 v46, v46
    v_exp_f32 v47, v47
    v_exp_f32 v48, v48
    v_exp_f32_e64 v49, v49
    v_smfmac_f32_32x32x32_bf16 v[96:111], v[140:143], v[40:47], v21
    s_waitcnt lgkmcnt(0)
    v_exp_f32 v50, v50
    v_exp_f32 v51, v51
    v_exp_f32 v52, v52
    v_mfma_f32_32x32x16_bf16 v[32:47], v[132:135], v[8:11], v[64:79]
    v_exp_f32 v53, v53
    v_exp_f32 v54, v54
    v_exp_f32 v55, v55
    v_exp_f32 v56, v56
    v_exp_f32 v57, v57
    v_exp_f32 v58, v58
    v_smfmac_f32_32x32x32_bf16 v[112:127], v[136:139], v[48:55], v21
    v_exp_f32 v59, v59
    v_exp_f32 v60, v60
    v_exp_f32 v61, v61
    v_exp_f32 v62, v62
    v_exp_f32 v63, v63
    v_exp_f32 v32, v32
    v_exp_f32_e64 v33, v33
    v_smfmac_f32_32x32x32_bf16 v[112:127], v[140:143], v[56:63], v21
    ds_read_b128 v[128:131], v16 offset:24896
    v_exp_f32 v34, v34
    v_exp_f32 v35, v35
    v_exp_f32_e64 v36, v36
    v_mfma_f32_32x32x16_bf16 v[48:63], v[132:135], v[12:15], v[80:95]
    ds_read_b128 v[136:139], v17 offset:24896
    v_exp_f32 v37, v37
    v_exp_f32 v38, v38
    v_exp_f32 v39, v39
    v_exp_f32 v40, v40
    v_exp_f32 v41, v41
    v_exp_f32 v42, v42
    v_smfmac_f32_32x32x32_bf16 v[96:111], v[144:147], v[32:39], v21
    ds_read_b128 v[140:143], v20 offset:24896
    v_exp_f32 v43, v43
    v_exp_f32 v44, v44
    v_exp_f32 v45, v45
    v_exp_f32 v46, v46
    v_exp_f32 v47, v47
    v_exp_f32 v48, v48
    v_exp_f32_e64 v49, v49
    v_smfmac_f32_32x32x32_bf16 v[96:111], v[148:151], v[40:47], v21
    s_waitcnt lgkmcnt(0)
    v_exp_f32 v50, v50
    v_exp_f32 v51, v51
    v_exp_f32 v52, v52
    v_mfma_f32_32x32x16_bf16 v[32:47], v[128:131], v[8:11], v[64:79]
    v_exp_f32 v53, v53
    v_exp_f32 v54, v54
    v_exp_f32 v55, v55
    v_exp_f32 v56, v56
    v_exp_f32 v57, v57
    v_exp_f32 v58, v58
    v_smfmac_f32_32x32x32_bf16 v[112:127], v[144:147], v[48:55], v21
    v_exp_f32 v59, v59
    v_exp_f32 v60, v60
    v_exp_f32 v61, v61
    v_exp_f32 v62, v62
    v_exp_f32 v63, v63
    v_exp_f32 v32, v32
    v_exp_f32_e64 v33, v33
    v_smfmac_f32_32x32x32_bf16 v[112:127], v[148:151], v[56:63], v21
    ds_read_b128 v[132:135], v16 offset:26960
    v_exp_f32 v34, v34
    v_exp_f32 v35, v35
    v_exp_f32_e64 v36, v36
    v_mfma_f32_32x32x16_bf16 v[48:63], v[128:131], v[12:15], v[80:95]
    ds_read_b128 v[144:147], v17 offset:26960
    v_exp_f32 v37, v37
    v_exp_f32 v38, v38
    v_exp_f32 v39, v39
    v_exp_f32 v40, v40
    v_exp_f32 v41, v41
    v_exp_f32 v42, v42
    v_smfmac_f32_32x32x32_bf16 v[96:111], v[136:139], v[32:39], v21
    ds_read_b128 v[148:151], v20 offset:26960
    v_exp_f32 v43, v43
    v_exp_f32 v44, v44
    v_exp_f32 v45, v45
    v_exp_f32 v46, v46
    v_exp_f32 v47, v47
    v_exp_f32 v48, v48
    v_exp_f32_e64 v49, v49
    v_smfmac_f32_32x32x32_bf16 v[96:111], v[140:143], v[40:47], v21
    s_waitcnt lgkmcnt(0)
    v_exp_f32 v50, v50
    v_exp_f32 v51, v51
    v_exp_f32 v52, v52
    v_mfma_f32_32x32x16_bf16 v[32:47], v[132:135], v[8:11], v[64:79]
    v_exp_f32 v53, v53
    v_exp_f32 v54, v54
    v_exp_f32 v55, v55
    v_exp_f32 v56, v56
    v_exp_f32 v57, v57
    v_exp_f32 v58, v58
    v_smfmac_f32_32x32x32_bf16 v[112:127], v[136:139], v[48:55], v21
    v_exp_f32 v59, v59
    v_exp_f32 v60, v60
    v_exp_f32 v61, v61
    v_exp_f32 v62, v62
    v_exp_f32 v63, v63
    v_exp_f32 v32, v32
    v_exp_f32_e64 v33, v33
    v_smfmac_f32_32x32x32_bf16 v[112:127], v[140:143], v[56:63], v21
    ds_read_b128 v[128:131], v16 offset:29024
    v_exp_f32 v34, v34
    v_exp_f32 v35, v35
    v_exp_f32_e64 v36, v36
    v_mfma_f32_32x32x16_bf16 v[48:63], v[132:135], v[12:15], v[80:95]
    ds_read_b128 v[136:139], v17 offset:29024
    v_exp_f32 v37, v37
    v_exp_f32 v38, v38
    v_exp_f32 v39, v39
    v_exp_f32 v40, v40
    v_exp_f32 v41, v41
    v_exp_f32 v42, v42
    v_smfmac_f32_32x32x32_bf16 v[96:111], v[144:147], v[32:39], v21
    ds_read_b128 v[140:143], v20 offset:29024
    v_exp_f32 v43, v43
    v_exp_f32 v44, v44
    v_exp_f32 v45, v45
    v_exp_f32 v46, v46
    v_exp_f32 v47, v47
    v_exp_f32 v48, v48
    v_exp_f32_e64 v49, v49
    v_smfmac_f32_32x32x32_bf16 v[96:111], v[148:151], v[40:47], v21
    s_waitcnt lgkmcnt(0)
    v_exp_f32 v50, v50
    v_exp_f32 v51, v51
    v_exp_f32 v52, v52
    v_mfma_f32_32x32x16_bf16 v[32:47], v[128:131], v[8:11], v[64:79]
    v_exp_f32 v53, v53
    v_exp_f32 v54, v54
    v_exp_f32 v55, v55
    v_exp_f32 v56, v56
    v_exp_f32 v57, v57
    v_exp_f32 v58, v58
    v_smfmac_f32_32x32x32_bf16 v[112:127], v[144:147], v[48:55], v21
    v_exp_f32 v59, v59
    v_exp_f32 v60, v60
    v_exp_f32 v61, v61
    v_exp_f32 v62, v62
    v_exp_f32 v63, v63
    v_exp_f32 v32, v32
    v_exp_f32_e64 v33, v33
    v_smfmac_f32_32x32x32_bf16 v[112:127], v[148:151], v[56:63], v21
    ds_read_b128 v[132:135], v16 offset:31088
    v_exp_f32 v34, v34
    v_exp_f32 v35, v35
    v_exp_f32_e64 v36, v36
    v_mfma_f32_32x32x16_bf16 v[48:63], v[128:131], v[12:15], v[80:95]
    ds_read_b128 v[144:147], v17 offset:31088
    v_exp_f32 v37, v37
    v_exp_f32 v38, v38
    v_exp_f32 v39, v39
    v_exp_f32 v40, v40
    v_exp_f32 v41, v41
    v_exp_f32 v42, v42
    v_smfmac_f32_32x32x32_bf16 v[96:111], v[136:139], v[32:39], v21
    ds_read_b128 v[148:151], v20 offset:31088
    v_exp_f32 v43, v43
    v_exp_f32 v44, v44
    v_exp_f32 v45, v45
    v_exp_f32 v46, v46
    v_exp_f32 v47, v47
    v_exp_f32 v48, v48
    v_exp_f32_e64 v49, v49
    v_smfmac_f32_32x32x32_bf16 v[96:111], v[140:143], v[40:47], v21
    s_waitcnt lgkmcnt(0)
    v_exp_f32 v50, v50
    v_exp_f32 v51, v51
    v_exp_f32 v52, v52
    v_mfma_f32_32x32x16_bf16 v[32:47], v[132:135], v[8:11], v[64:79]
    v_exp_f32 v53, v53
    v_exp_f32 v54, v54
    v_exp_f32 v55, v55
    v_exp_f32 v56, v56
    v_exp_f32 v57, v57
    v_exp_f32 v58, v58
    v_smfmac_f32_32x32x32_bf16 v[112:127], v[136:139], v[48:55], v21
    v_exp_f32 v59, v59
    v_exp_f32 v60, v60
    v_exp_f32 v61, v61
    v_exp_f32 v62, v62
    v_exp_f32 v63, v63
    v_exp_f32 v32, v32
    v_exp_f32_e64 v33, v33
    v_smfmac_f32_32x32x32_bf16 v[112:127], v[140:143], v[56:63], v21
    s_barrier
    s_nop 0
    ds_read_b128 v[128:131], v16 offset:33152
    v_exp_f32 v34, v34
    v_exp_f32 v35, v35
    v_exp_f32_e64 v36, v36
    v_mfma_f32_32x32x16_bf16 v[48:63], v[132:135], v[12:15], v[80:95]
    ds_read_b128 v[136:139], v17 offset:33152
    v_exp_f32 v37, v37
    v_exp_f32 v38, v38
    v_exp_f32 v39, v39
    v_exp_f32 v40, v40
    v_exp_f32 v41, v41
    v_exp_f32 v42, v42
    v_smfmac_f32_32x32x32_bf16 v[96:111], v[144:147], v[32:39], v21
    ds_read_b128 v[140:143], v20 offset:33152
    v_exp_f32 v43, v43
    v_exp_f32 v44, v44
    v_exp_f32 v45, v45
    v_exp_f32 v46, v46
    v_exp_f32 v47, v47
    v_exp_f32 v48, v48
    v_exp_f32_e64 v49, v49
    v_smfmac_f32_32x32x32_bf16 v[96:111], v[148:151], v[40:47], v21
    s_waitcnt lgkmcnt(0)
    v_exp_f32 v50, v50
    v_exp_f32 v51, v51
    v_exp_f32 v52, v52
    v_mfma_f32_32x32x16_bf16 v[32:47], v[128:131], v[8:11], v[64:79]
    v_exp_f32 v53, v53
    v_exp_f32 v54, v54
    v_exp_f32 v55, v55
    v_exp_f32 v56, v56
    v_exp_f32 v57, v57
    v_exp_f32 v58, v58
    v_smfmac_f32_32x32x32_bf16 v[112:127], v[144:147], v[48:55], v21
    v_exp_f32 v59, v59
    v_exp_f32 v60, v60
    v_exp_f32 v61, v61
    v_exp_f32 v62, v62
    v_exp_f32 v63, v63
    s_mov_b32 s55, 3
L_aloop:
.p2align 3
    v_exp_f32 v32, v32
    v_exp_f32 v33, v33
    v_smfmac_f32_32x32x32_bf16 v[112:127], v[148:151], v[56:63], v21
    ds_read_b128 v[132:135], v16 offset:35216
    v_exp_f32 v34, v34
    v_exp_f32 v35, v35
    v_exp_f32_e64 v36, v36
    v_mfma_f32_32x32x16_bf16 v[48:63], v[128:131], v[12:15], v[80:95]
    ds_read_b128 v[144:147], v17 offset:35216
    v_exp_f32 v37, v37
    v_exp_f32 v38, v38
    v_exp_f32 v39, v39
    v_exp_f32 v40, v40
    v_exp_f32 v41, v41
    v_exp_f32 v42, v42
    v_smfmac_f32_32x32x32_bf16 v[96:111], v[136:139], v[32:39], v21
    ds_read_b128 v[148:151], v20 offset:35216
    v_exp_f32 v43, v43
    v_exp_f32 v44, v44
    v_exp_f32 v45, v45
    v_exp_f32 v46, v46
    v_exp_f32 v47, v47
    v_exp_f32 v48, v48
    v_exp_f32_e64 v49, v49
    v_smfmac_f32_32x32x32_bf16 v[96:111], v[140:143], v[40:47], v21
    s_waitcnt lgkmcnt(0)
    v_exp_f32 v50, v50
    v_exp_f32 v51, v51
    v_exp_f32 v52, v52
    v_mfma_f32_32x32x16_bf16 v[32:47], v[132:135], v[8:11], v[64:79]
    v_exp_f32 v53, v53
    v_exp_f32 v54, v54
    v_exp_f32 v55, v55
    v_exp_f32 v56, v56
    v_exp_f32 v57, v57
    v_exp_f32 v58, v58
    v_smfmac_f32_32x32x32_bf16 v[112:127], v[136:139], v[48:55], v21
    v_exp_f32 v59, v59
    v_exp_f32 v60, v60
    v_exp_f32 v61, v61
    v_exp_f32 v62, v62
    v_exp_f32 v63, v63
    v_exp_f32 v32, v32
    v_exp_f32_e64 v33, v33
    v_smfmac_f32_32x32x32_bf16 v[112:127], v[140:143], v[56:63], v21
    ds_read_b128 v[128:131], v16 offset:37280
    v_exp_f32 v34, v34
    v_exp_f32 v35, v35
    v_exp_f32_e64 v36, v36
    v_mfma_f32_32x32x16_bf16 v[48:63], v[132:135], v[12:15], v[80:95]
    ds_read_b128 v[136:139], v17 offset:37280
    v_exp_f32 v37, v37
    v_exp_f32 v38, v38
    v_exp_f32 v39, v39
    v_exp_f32 v40, v40
    v_exp_f32 v41, v41
    v_exp_f32 v42, v42
    v_smfmac_f32_32x32x32_bf16 v[96:111], v[144:147], v[32:39], v21
    ds_read_b128 v[140:143], v20 offset:37280
    v_exp_f32 v43, v43
    v_exp_f32 v44, v44
    v_exp_f32 v45, v45
    v_exp_f32 v46, v46
    v_exp_f32 v47, v47
    v_exp_f32 v48, v48
    v_exp_f32_e64 v49, v49
    v_smfmac_f32_32x32x32_bf16 v[96:111], v[148:151], v[40:47], v21
    s_waitcnt lgkmcnt(0)
    v_exp_f32 v50, v50
    v_exp_f32 v51, v51
    v_exp_f32 v52, v52
    v_mfma_f32_32x32x16_bf16 v[32:47], v[128:131], v[8:11], v[64:79]
    v_exp_f32 v53, v53
    v_exp_f32 v54, v54
    v_exp_f32 v55, v55
    v_exp_f32 v56, v56
    v_exp_f32 v57, v57
    v_exp_f32 v58, v58
    v_smfmac_f32_32x32x32_bf16 v[112:127], v[144:147], v[48:55], v21
    v_exp_f32 v59, v59
    v_exp_f32 v60, v60
    v_exp_f32 v61, v61
    v_exp_f32 v62, v62
    v_exp_f32 v63, v63
    v_exp_f32 v32, v32
    v_exp_f32_e64 v33, v33
    v_smfmac_f32_32x32x32_bf16 v[112:127], v[148:151], v[56:63], v21
    ds_read_b128 v[132:135], v16 offset:39344
    v_exp_f32 v34, v34
    v_exp_f32 v35, v35
    v_exp_f32_e64 v36, v36
    v_mfma_f32_32x32x16_bf16 v[48:63], v[128:131], v[12:15], v[80:95]
    ds_read_b128 v[144:147], v17 offset:39344
    v_exp_f32 v37, v37
    v_exp_f32 v38, v38
    v_exp_f32 v39, v39
    v_exp_f32 v40, v40
    v_exp_f32 v41, v41
    v_exp_f32 v42, v42
    v_smfmac_f32_32x32x32_bf16 v[96:111], v[136:139], v[32:39], v21
    ds_read_b128 v[148:151], v20 offset:39344
    v_exp_f32 v43, v43
    v_exp_f32 v44, v44
    v_exp_f32 v45, v45
    v_exp_f32 v46, v46
    v_exp_f32 v47, v47
    v_exp_f32 v48, v48
    v_exp_f32_e64 v49, v49
    v_smfmac_f32_32x32x32_bf16 v[96:111], v[140:143], v[40:47], v21
    s_waitcnt lgkmcnt(0)
    v_exp_f32 v50, v50
    v_exp_f32 v51, v51
    v_exp_f32 v52, v52
    v_mfma_f32_32x32x16_bf16 v[32:47], v[132:135], v[8:11], v[64:79]
    v_exp_f32 v53, v53
    v_exp_f32 v54, v54
    v_exp_f32 v55, v55
    v_exp_f32 v56, v56
    v_exp_f32 v57, v57
    v_exp_f32 v58, v58
    v_smfmac_f32_32x32x32_bf16 v[112:127], v[136:139], v[48:55], v21
    v_exp_f32 v59, v59
    v_exp_f32 v60, v60
    v_exp_f32 v61, v61
    v_exp_f32 v62, v62
    v_exp_f32 v63, v63
    v_exp_f32 v32, v32
    v_exp_f32_e64 v33, v33
    v_smfmac_f32_32x32x32_bf16 v[112:127], v[140:143], v[56:63], v21
    ds_read_b128 v[128:131], v16 offset:41408
    v_exp_f32 v34, v34
    v_exp_f32 v35, v35
    v_exp_f32_e64 v36, v36
    v_mfma_f32_32x32x16_bf16 v[48:63], v[132:135], v[12:15], v[80:95]
    ds_read_b128 v[136:139], v17 offset:41408
    v_exp_f32 v37, v37
    v_exp_f32 v38, v38
    v_exp_f32 v39, v39
    v_exp_f32 v40, v40
    v_exp_f32 v41, v41
    v_exp_f32 v42, v42
    v_smfmac_f32_32x32x32_bf16 v[96:111], v[144:147], v[32:39], v21
    ds_read_b128 v[140:143], v20 offset:41408
    v_exp_f32 v43, v43
    v_exp_f32 v44, v44
    v_exp_f32 v45, v45
    v_exp_f32 v46, v46
    v_exp_f32 v47, v47
    v_exp_f32 v48, v48
    v_exp_f32_e64 v49, v49
    v_smfmac_f32_32x32x32_bf16 v[96:111], v[148:151], v[40:47], v21
    s_waitcnt lgkmcnt(0)
    v_exp_f32 v50, v50
    v_exp_f32 v51, v51
    v_exp_f32 v52, v52
    v_mfma_f32_32x32x16_bf16 v[32:47], v[128:131], v[8:11], v[64:79]
    v_exp_f32 v53, v53
    v_exp_f32 v54, v54
    v_exp_f32 v55, v55
    v_exp_f32 v56, v56
    v_exp_f32 v57, v57
    v_exp_f32 v58, v58
    v_smfmac_f32_32x32x32_bf16 v[112:127], v[144:147], v[48:55], v21
    v_exp_f32 v59, v59
    v_exp_f32 v60, v60
    v_exp_f32 v61, v61
    v_exp_f32 v62, v62
    v_exp_f32 v63, v63
    v_exp_f32 v32, v32
    v_exp_f32_e64 v33, v33
    v_smfmac_f32_32x32x32_bf16 v[112:127], v[148:151], v[56:63], v21
    ds_read_b128 v[132:135], v16 offset:43472
    v_exp_f32 v34, v34
    v_exp_f32 v35, v35
    v_exp_f32_e64 v36, v36
    v_mfma_f32_32x32x16_bf16 v[48:63], v[128:131], v[12:15], v[80:95]
    ds_read_b128 v[144:147], v17 offset:43472
    v_exp_f32 v37, v37
    v_exp_f32 v38, v38
    v_exp_f32 v39, v39
    v_exp_f32 v40, v40
    v_exp_f32 v41, v41
    v_exp_f32 v42, v42
    v_smfmac_f32_32x32x32_bf16 v[96:111], v[136:139], v[32:39], v21
    ds_read_b128 v[148:151], v20 offset:43472
    v_exp_f32 v43, v43
    v_exp_f32 v44, v44
    v_exp_f32 v45, v45
    v_exp_f32 v46, v46
    v_exp_f32 v47, v47
    v_exp_f32 v48, v48
    v_exp_f32_e64 v49, v49
    v_smfmac_f32_32x32x32_bf16 v[96:111], v[140:143], v[40:47], v21
    s_waitcnt lgkmcnt(0)
    v_exp_f32 v50, v50
    v_exp_f32 v51, v51
    v_exp_f32 v52, v52
    v_mfma_f32_32x32x16_bf16 v[32:47], v[132:135], v[8:11], v[64:79]
    v_exp_f32 v53, v53
    v_exp_f32 v54, v54
    v_exp_f32 v55, v55
    v_exp_f32 v56, v56
    v_exp_f32 v57, v57
    v_exp_f32 v58, v58
    v_smfmac_f32_32x32x32_bf16 v[112:127], v[136:139], v[48:55], v21
    v_exp_f32 v59, v59
    v_exp_f32 v60, v60
    v_exp_f32 v61, v61
    v_exp_f32 v62, v62
    v_exp_f32 v63, v63
    v_exp_f32 v32, v32
    v_exp_f32_e64 v33, v33
    v_smfmac_f32_32x32x32_bf16 v[112:127], v[140:143], v[56:63], v21
    ds_read_b128 v[128:131], v16 offset:45536
    v_exp_f32 v34, v34
    v_exp_f32 v35, v35
    v_exp_f32_e64 v36, v36
    v_mfma_f32_32x32x16_bf16 v[48:63], v[132:135], v[12:15], v[80:95]
    ds_read_b128 v[136:139], v17 offset:45536
    v_exp_f32 v37, v37
    v_exp_f32 v38, v38
    v_exp_f32 v39, v39
    v_exp_f32 v40, v40
    v_exp_f32 v41, v41
    v_exp_f32 v42, v42
    v_smfmac_f32_32x32x32_bf16 v[96:111], v[144:147], v[32:39], v21
    ds_read_b128 v[140:143], v20 offset:45536
    v_exp_f32 v43, v43
    v_exp_f32 v44, v44
    v_exp_f32 v45, v45
    v_exp_f32 v46, v46
    v_exp_f32 v47, v47
    v_exp_f32 v48, v48
    v_exp_f32_e64 v49, v49
    v_smfmac_f32_32x32x32_bf16 v[96:111], v[148:151], v[40:47], v21
    s_waitcnt lgkmcnt(0)
    v_exp_f32 v50, v50
    v_exp_f32 v51, v51
    v_exp_f32 v52, v52
    v_mfma_f32_32x32x16_bf16 v[32:47], v[128:131], v[8:11], v[64:79]
    v_exp_f32 v53, v53
    v_exp_f32 v54, v54
    v_exp_f32 v55, v55
    v_exp_f32 v56, v56
    v_exp_f32 v57, v57
    v_exp_f32 v58, v58
    v_smfmac_f32_32x32x32_bf16 v[112:127], v[144:147], v[48:55], v21
    v_exp_f32 v59, v59
    v_exp_f32 v60, v60
    v_exp_f32 v61, v61
    v_exp_f32 v62, v62
    v_exp_f32 v63, v63
    v_exp_f32 v32, v32
    v_exp_f32_e64 v33, v33
    v_smfmac_f32_32x32x32_bf16 v[112:127], v[148:151], v[56:63], v21
    ds_read_b128 v[132:135], v16 offset:47600
    v_exp_f32 v34, v34
    v_exp_f32 v35, v35
    v_exp_f32_e64 v36, v36
    v_mfma_f32_32x32x16_bf16 v[48:63], v[128:131], v[12:15], v[80:95]
    ds_read_b128 v[144:147], v17 offset:47600
    v_exp_f32 v37, v37
    v_exp_f32 v38, v38
    v_exp_f32 v39, v39
    v_exp_f32 v40, v40
    v_exp_f32 v41, v41
    v_exp_f32 v42, v42
    v_smfmac_f32_32x32x32_bf16 v[96:111], v[136:139], v[32:39], v21
    ds_read_b128 v[148:151], v20 offset:47600
    v_exp_f32 v43, v43
    v_exp_f32 v44, v44
    v_exp_f32 v45, v45
    v_exp_f32 v46, v46
    v_exp_f32 v47, v47
    v_exp_f32 v48, v48
    v_exp_f32_e64 v49, v49
    v_smfmac_f32_32x32x32_bf16 v[96:111], v[140:143], v[40:47], v21
    s_waitcnt lgkmcnt(0)
    v_exp_f32 v50, v50
    v_exp_f32 v51, v51
    v_exp_f32 v52, v52
    v_mfma_f32_32x32x16_bf16 v[32:47], v[132:135], v[8:11], v[64:79]
    v_exp_f32 v53, v53
    v_exp_f32 v54, v54
    v_exp_f32 v55, v55
    v_exp_f32 v56, v56
    v_exp_f32 v57, v57
    v_exp_f32 v58, v58
    v_smfmac_f32_32x32x32_bf16 v[112:127], v[136:139], v[48:55], v21
    v_exp_f32 v59, v59
    v_exp_f32 v60, v60
    v_exp_f32 v61, v61
    v_exp_f32 v62, v62
    v_exp_f32 v63, v63
    v_exp_f32 v32, v32
    v_exp_f32_e64 v33, v33
    v_smfmac_f32_32x32x32_bf16 v[112:127], v[140:143], v[56:63], v21
    s_barrier
    s_nop 0
    ds_read_b128 v[128:131], v16 offset:16640
    v_exp_f32 v34, v34
    v_exp_f32 v35, v35
    v_exp_f32_e64 v36, v36
    v_mfma_f32_32x32x16_bf16 v[48:63], v[132:135], v[12:15], v[80:95]
    ds_read_b128 v[136:139], v17 offset:16640
    v_exp_f32 v37, v37
    v_exp_f32 v38, v38
    v_exp_f32 v39, v39
    v_exp_f32 v40, v40
    v_exp_f32 v41, v41
    v_exp_f32 v42, v42
    v_smfmac_f32_32x32x32_bf16 v[96:111], v[144:147], v[32:39], v21
    ds_read_b128 v[140:143], v20 offset:16640
    v_exp_f32 v43, v43
    v_exp_f32 v44, v44
    v_exp_f32 v45, v45
    v_exp_f32 v46, v46
    v_exp_f32 v47, v47
    v_exp_f32 v48, v48
    v_exp_f32_e64 v49, v49
    v_smfmac_f32_32x32x32_bf16 v[96:111], v[148:151], v[40:47], v21
    s_waitcnt lgkmcnt(0)
    v_exp_f32 v50, v50
    v_exp_f32 v51, v51
    v_exp_f32 v52, v52
    v_mfma_f32_32x32x16_bf16 v[32:47], v[128:131], v[8:11], v[64:79]
    v_exp_f32 v53, v53
    v_exp_f32 v54, v54
    v_exp_f32 v55, v55
    v_exp_f32 v56, v56
    v_exp_f32 v57, v57
    v_exp_f32 v58, v58
    v_smfmac_f32_32x32x32_bf16 v[112:127], v[144:147], v[48:55], v21
    v_exp_f32 v59, v59
    v_exp_f32 v60, v60
    v_exp_f32 v61, v61
    v_exp_f32 v62, v62
    v_exp_f32 v63, v63
    v_exp_f32 v32, v32
    v_exp_f32_e64 v33, v33
    v_smfmac_f32_32x32x32_bf16 v[112:127], v[148:151], v[56:63], v21
    ds_read_b128 v[132:135], v16 offset:18704
    v_exp_f32 v34, v34
    v_exp_f32 v35, v35
    v_exp_f32_e64 v36, v36
    v_mfma_f32_32x32x16_bf16 v[48:63], v[128:131], v[12:15], v[80:95]
    ds_read_b128 v[144:147], v17 offset:18704
    v_exp_f32 v37, v37
    v_exp_f32 v38, v38
    v_exp_f32 v39, v39
    v_exp_f32 v40, v40
    v_exp_f32 v41, v41
    v_exp_f32 v42, v42
    v_smfmac_f32_32x32x32_bf16 v[96:111], v[136:139], v[32:39], v21
    ds_read_b128 v[148:151], v20 offset:18704
    v_exp_f32 v43, v43
    v_exp_f32 v44, v44
    v_exp_f32 v45, v45
    v_exp_f32 v46, v46
    v_exp_f32 v47, v47
    v_exp_f32 v48, v48
    v_exp_f32_e64 v49, v49
    v_smfmac_f32_32x32x32_bf16 v[96:111], v[140:143], v[40:47], v21
    s_waitcnt lgkmcnt(0)
    v_exp_f32 v50, v50
    v_exp_f32 v51, v51
    v_exp_f32 v52, v52
    v_mfma_f32_32x32x16_bf16 v[32:47], v[132:135], v[8:11], v[64:79]
    v_exp_f32 v53, v53
    v_exp_f32 v54, v54
    v_exp_f32 v55, v55
    v_exp_f32 v56, v56
    v_exp_f32 v57, v57
    v_exp_f32 v58, v58
    v_smfmac_f32_32x32x32_bf16 v[112:127], v[136:139], v[48:55], v21
    v_exp_f32 v59, v59
    v_exp_f32 v60, v60
    v_exp_f32 v61, v61
    v_exp_f32 v62, v62
    v_exp_f32 v63, v63
    v_exp_f32 v32, v32
    v_exp_f32_e64 v33, v33
    v_smfmac_f32_32x32x32_bf16 v[112:127], v[140:143], v[56:63], v21
    ds_read_b128 v[128:131], v16 offset:20768
    v_exp_f32 v34, v34
    v_exp_f32 v35, v35
    v_exp_f32_e64 v36, v36
    v_mfma_f32_32x32x16_bf16 v[48:63], v[132:135], v[12:15], v[80:95]
    ds_read_b128 v[136:139], v17 offset:20768
    v_exp_f32 v37, v37
    v_exp_f32 v38, v38
    v_exp_f32 v39, v39
    v_exp_f32 v40, v40
    v_exp_f32 v41, v41
    v_exp_f32 v42, v42
    v_smfmac_f32_32x32x32_bf16 v[96:111], v[144:147], v[32:39], v21
    ds_read_b128 v[140:143], v20 offset:20768
    v_exp_f32 v43, v43
    v_exp_f32 v44, v44
    v_exp_f32 v45, v45
    v_exp_f32 v46, v46
    v_exp_f32 v47, v47
    v_exp_f32 v48, v48
    v_exp_f32_e64 v49, v49
    v_smfmac_f32_32x32x32_bf16 v[96:111], v[148:151], v[40:47], v21
    s_waitcnt lgkmcnt(0)
    v_exp_f32 v50, v50
    v_exp_f32 v51, v51
    v_exp_f32 v52, v52
    v_mfma_f32_32x32x16_bf16 v[32:47], v[128:131], v[8:11], v[64:79]
    v_exp_f32 v53, v53
    v_exp_f32 v54, v54
    v_exp_f32 v55, v55
    v_exp_f32 v56, v56
    v_exp_f32 v57, v57
    v_exp_f32 v58, v58
    v_smfmac_f32_32x32x32_bf16 v[112:127], v[144:147], v[48:55], v21
    v_exp_f32 v59, v59
    v_exp_f32 v60, v60
    v_exp_f32 v61, v61
    v_exp_f32 v62, v62
    v_exp_f32 v63, v63
    v_exp_f32 v32, v32
    v_exp_f32_e64 v33, v33
    v_smfmac_f32_32x32x32_bf16 v[112:127], v[148:151], v[56:63], v21
    ds_read_b128 v[132:135], v16 offset:22832
    v_exp_f32 v34, v34
    v_exp_f32 v35, v35
    v_exp_f32_e64 v36, v36
    v_mfma_f32_32x32x16_bf16 v[48:63], v[128:131], v[12:15], v[80:95]
    ds_read_b128 v[144:147], v17 offset:22832
    v_exp_f32 v37, v37
    v_exp_f32 v38, v38
    v_exp_f32 v39, v39
    v_exp_f32 v40, v40
    v_exp_f32 v41, v41
    v_exp_f32 v42, v42
    v_smfmac_f32_32x32x32_bf16 v[96:111], v[136:139], v[32:39], v21
    ds_read_b128 v[148:151], v20 offset:22832
    v_exp_f32 v43, v43
    v_exp_f32 v44, v44
    v_exp_f32 v45, v45
    v_exp_f32 v46, v46
    v_exp_f32 v47, v47
    v_exp_f32 v48, v48
    v_exp_f32_e64 v49, v49
    v_smfmac_f32_32x32x32_bf16 v[96:111], v[140:143], v[40:47], v21
    s_waitcnt lgkmcnt(0)
    v_exp_f32 v50, v50
    v_exp_f32 v51, v51
    v_exp_f32 v52, v52
    v_mfma_f32_32x32x16_bf16 v[32:47], v[132:135], v[8:11], v[64:79]
    v_exp_f32 v53, v53
    v_exp_f32 v54, v54
    v_exp_f32 v55, v55
    v_exp_f32 v56, v56
    v_exp_f32 v57, v57
    v_exp_f32 v58, v58
    v_smfmac_f32_32x32x32_bf16 v[112:127], v[136:139], v[48:55], v21
    v_exp_f32 v59, v59
    v_exp_f32 v60, v60
    v_exp_f32 v61, v61
    v_exp_f32 v62, v62
    v_exp_f32 v63, v63
    v_exp_f32 v32, v32
    v_exp_f32_e64 v33, v33
    v_smfmac_f32_32x32x32_bf16 v[112:127], v[140:143], v[56:63], v21
    ds_read_b128 v[128:131], v16 offset:24896
    v_exp_f32 v34, v34
    v_exp_f32 v35, v35
    v_exp_f32_e64 v36, v36
    v_mfma_f32_32x32x16_bf16 v[48:63], v[132:135], v[12:15], v[80:95]
    ds_read_b128 v[136:139], v17 offset:24896
    v_exp_f32 v37, v37
    v_exp_f32 v38, v38
    v_exp_f32 v39, v39
    v_exp_f32 v40, v40
    v_exp_f32 v41, v41
    v_exp_f32 v42, v42
    v_smfmac_f32_32x32x32_bf16 v[96:111], v[144:147], v[32:39], v21
    ds_read_b128 v[140:143], v20 offset:24896
    v_exp_f32 v43, v43
    v_exp_f32 v44, v44
    v_exp_f32 v45, v45
    v_exp_f32 v46, v46
    v_exp_f32 v47, v47
    v_exp_f32 v48, v48
    v_exp_f32_e64 v49, v49
    v_smfmac_f32_32x32x32_bf16 v[96:111], v[148:151], v[40:47], v21
    s_waitcnt lgkmcnt(0)
    v_exp_f32 v50, v50
    v_exp_f32 v51, v51
    v_exp_f32 v52, v52
    v_mfma_f32_32x32x16_bf16 v[32:47], v[128:131], v[8:11], v[64:79]
    v_exp_f32 v53, v53
    v_exp_f32 v54, v54
    v_exp_f32 v55, v55
    v_exp_f32 v56, v56
    v_exp_f32 v57, v57
    v_exp_f32 v58, v58
    v_smfmac_f32_32x32x32_bf16 v[112:127], v[144:147], v[48:55], v21
    v_exp_f32 v59, v59
    v_exp_f32 v60, v60
    v_exp_f32 v61, v61
    v_exp_f32 v62, v62
    v_exp_f32 v63, v63
    v_exp_f32 v32, v32
    v_exp_f32_e64 v33, v33
    v_smfmac_f32_32x32x32_bf16 v[112:127], v[148:151], v[56:63], v21
    ds_read_b128 v[132:135], v16 offset:26960
    v_exp_f32 v34, v34
    v_exp_f32 v35, v35
    v_exp_f32_e64 v36, v36
    v_mfma_f32_32x32x16_bf16 v[48:63], v[128:131], v[12:15], v[80:95]
    ds_read_b128 v[144:147], v17 offset:26960
    v_exp_f32 v37, v37
    v_exp_f32 v38, v38
    v_exp_f32 v39, v39
    v_exp_f32 v40, v40
    v_exp_f32 v41, v41
    v_exp_f32 v42, v42
    v_smfmac_f32_32x32x32_bf16 v[96:111], v[136:139], v[32:39], v21
    ds_read_b128 v[148:151], v20 offset:26960
    v_exp_f32 v43, v43
    v_exp_f32 v44, v44
    v_exp_f32 v45, v45
    v_exp_f32 v46, v46
    v_exp_f32 v47, v47
    v_exp_f32 v48, v48
    v_exp_f32_e64 v49, v49
    v_smfmac_f32_32x32x32_bf16 v[96:111], v[140:143], v[40:47], v21
    s_waitcnt lgkmcnt(0)
    v_exp_f32 v50, v50
    v_exp_f32 v51, v51
    v_exp_f32 v52, v52
    v_mfma_f32_32x32x16_bf16 v[32:47], v[132:135], v[8:11], v[64:79]
    v_exp_f32 v53, v53
    v_exp_f32 v54, v54
    v_exp_f32 v55, v55
    v_exp_f32 v56, v56
    v_exp_f32 v57, v57
    v_exp_f32 v58, v58
    v_smfmac_f32_32x32x32_bf16 v[112:127], v[136:139], v[48:55], v21
    v_exp_f32 v59, v59
    v_exp_f32 v60, v60
    v_exp_f32 v61, v61
    v_exp_f32 v62, v62
    v_exp_f32 v63, v63
    v_exp_f32 v32, v32
    v_exp_f32_e64 v33, v33
    v_smfmac_f32_32x32x32_bf16 v[112:127], v[140:143], v[56:63], v21
    ds_read_b128 v[128:131], v16 offset:29024
    v_exp_f32 v34, v34
    v_exp_f32 v35, v35
    v_exp_f32_e64 v36, v36
    v_mfma_f32_32x32x16_bf16 v[48:63], v[132:135], v[12:15], v[80:95]
    ds_read_b128 v[136:139], v17 offset:29024
    v_exp_f32 v37, v37
    v_exp_f32 v38, v38
    v_exp_f32 v39, v39
    v_exp_f32 v40, v40
    v_exp_f32 v41, v41
    v_exp_f32 v42, v42
    v_smfmac_f32_32x32x32_bf16 v[96:111], v[144:147], v[32:39], v21
    ds_read_b128 v[140:143], v20 offset:29024
    v_exp_f32 v43, v43
    v_exp_f32 v44, v44
    v_exp_f32 v45, v45
    v_exp_f32 v46, v46
    v_exp_f32 v47, v47
    v_exp_f32 v48, v48
    v_exp_f32_e64 v49, v49
    v_smfmac_f32_32x32x32_bf16 v[96:111], v[148:151], v[40:47], v21
    s_waitcnt lgkmcnt(0)
    v_exp_f32 v50, v50
    v_exp_f32 v51, v51
    v_exp_f32 v52, v52
    v_mfma_f32_32x32x16_bf16 v[32:47], v[128:131], v[8:11], v[64:79]
    v_exp_f32 v53, v53
    v_exp_f32 v54, v54
    v_exp_f32 v55, v55
    v_exp_f32 v56, v56
    v_exp_f32 v57, v57
    v_exp_f32 v58, v58
    v_smfmac_f32_32x32x32_bf16 v[112:127], v[144:147], v[48:55], v21
    v_exp_f32 v59, v59
    v_exp_f32 v60, v60
    v_exp_f32 v61, v61
    v_exp_f32 v62, v62
    v_exp_f32 v63, v63
    v_exp_f32 v32, v32
    v_exp_f32_e64 v33, v33
    v_smfmac_f32_32x32x32_bf16 v[112:127], v[148:151], v[56:63], v21
    ds_read_b128 v[132:135], v16 offset:31088
    v_exp_f32 v34, v34
    v_exp_f32 v35, v35
    v_exp_f32_e64 v36, v36
    v_mfma_f32_32x32x16_bf16 v[48:63], v[128:131], v[12:15], v[80:95]
    ds_read_b128 v[144:147], v17 offset:31088
    v_exp_f32 v37, v37
    v_exp_f32 v38, v38
    v_exp_f32 v39, v39
    v_exp_f32 v40, v40
    v_exp_f32 v41, v41
    v_exp_f32 v42, v42
    v_smfmac_f32_32x32x32_bf16 v[96:111], v[136:139], v[32:39], v21
    ds_read_b128 v[148:151], v20 offset:31088
    v_exp_f32 v43, v43
    v_exp_f32 v44, v44
    v_exp_f32 v45, v45
    v_exp_f32 v46, v46
    v_exp_f32 v47, v47
    v_exp_f32 v48, v48
    v_exp_f32_e64 v49, v49
    v_smfmac_f32_32x32x32_bf16 v[96:111], v[140:143], v[40:47], v21
    s_waitcnt lgkmcnt(0)
    v_exp_f32 v50, v50
    v_exp_f32 v51, v51
    v_exp_f32 v52, v52
    v_mfma_f32_32x32x16_bf16 v[32:47], v[132:135], v[8:11], v[64:79]
    v_exp_f32 v53, v53
    v_exp_f32 v54, v54
    v_exp_f32 v55, v55
    v_exp_f32 v56, v56
    v_exp_f32 v57, v57
    v_exp_f32 v58, v58
    v_smfmac_f32_32x32x32_bf16 v[112:127], v[136:139], v[48:55], v21
    v_exp_f32 v59, v59
    v_exp_f32 v60, v60
    v_exp_f32 v61, v61
    v_exp_f32 v62, v62
    v_exp_f32 v63, v63
    v_exp_f32 v32, v32
    v_exp_f32_e64 v33, v33
    v_smfmac_f32_32x32x32_bf16 v[112:127], v[140:143], v[56:63], v21
    s_barrier
    s_nop 0
    ds_read_b128 v[128:131], v16 offset:33152
    v_exp_f32 v34, v34
    v_exp_f32 v35, v35
    v_exp_f32_e64 v36, v36
    v_mfma_f32_32x32x16_bf16 v[48:63], v[132:135], v[12:15], v[80:95]
    ds_read_b128 v[136:139], v17 offset:33152
    v_exp_f32 v37, v37
    v_exp_f32 v38, v38
    v_exp_f32 v39, v39
    v_exp_f32 v40, v40
    v_exp_f32 v41, v41
    v_exp_f32 v42, v42
    v_smfmac_f32_32x32x32_bf16 v[96:111], v[144:147], v[32:39], v21
    ds_read_b128 v[140:143], v20 offset:33152
    v_exp_f32 v43, v43
    v_exp_f32 v44, v44
    v_exp_f32 v45, v45
    v_exp_f32 v46, v46
    v_exp_f32 v47, v47
    v_exp_f32 v48, v48
    v_exp_f32_e64 v49, v49
    v_smfmac_f32_32x32x32_bf16 v[96:111], v[148:151], v[40:47], v21
    s_waitcnt lgkmcnt(0)
    v_exp_f32 v50, v50
    v_exp_f32 v51, v51
    v_exp_f32 v52, v52
    v_mfma_f32_32x32x16_bf16 v[32:47], v[128:131], v[8:11], v[64:79]
    v_exp_f32 v53, v53
    v_exp_f32 v54, v54
    v_exp_f32 v55, v55
    v_exp_f32 v56, v56
    v_exp_f32 v57, v57
    v_exp_f32 v58, v58
    v_smfmac_f32_32x32x32_bf16 v[112:127], v[144:147], v[48:55], v21
    v_exp_f32 v59, v59
    v_exp_f32 v60, v60
    v_exp_f32 v61, v61
    v_exp_f32 v62, v62
    v_exp_f32 v63, v63
    s_sub_u32 s55, s55, 1
    s_cmp_lg_u32 s55, 0
    s_cbranch_scc1 L_aloop
.p2align 3
    v_exp_f32 v32, v32
    v_exp_f32 v33, v33
    v_smfmac_f32_32x32x32_bf16 v[112:127], v[148:151], v[56:63], v21
    ds_read_b128 v[132:135], v16 offset:35216
    v_exp_f32 v34, v34
    v_exp_f32 v35, v35
    v_exp_f32_e64 v36, v36
    v_mfma_f32_32x32x16_bf16 v[48:63], v[128:131], v[12:15], v[80:95]
    ds_read_b128 v[144:147], v17 offset:35216
    v_exp_f32 v37, v37
    v_exp_f32 v38, v38
    v_exp_f32 v39, v39
    v_exp_f32 v40, v40
    v_exp_f32 v41, v41
    v_exp_f32 v42, v42
    v_smfmac_f32_32x32x32_bf16 v[96:111], v[136:139], v[32:39], v21
    ds_read_b128 v[148:151], v20 offset:35216
    v_exp_f32 v43, v43
    v_exp_f32 v44, v44
    v_exp_f32 v45, v45
    v_exp_f32 v46, v46
    v_exp_f32 v47, v47
    v_exp_f32 v48, v48
    v_exp_f32_e64 v49, v49
    v_smfmac_f32_32x32x32_bf16 v[96:111], v[140:143], v[40:47], v21
    s_waitcnt lgkmcnt(0)
    v_exp_f32 v50, v50
    v_exp_f32 v51, v51
    v_exp_f32 v52, v52
    v_mfma_f32_32x32x16_bf16 v[32:47], v[132:135], v[8:11], v[64:79]
    v_exp_f32 v53, v53
    v_exp_f32 v54, v54
    v_exp_f32 v55, v55
    v_exp_f32 v56, v56
    v_exp_f32 v57, v57
    v_exp_f32 v58, v58
    v_smfmac_f32_32x32x32_bf16 v[112:127], v[136:139], v[48:55], v21
    v_exp_f32 v59, v59
    v_exp_f32 v60, v60
    v_exp_f32 v61, v61
    v_exp_f32 v62, v62
    v_exp_f32 v63, v63
    v_exp_f32 v32, v32
    v_exp_f32_e64 v33, v33
    v_smfmac_f32_32x32x32_bf16 v[112:127], v[140:143], v[56:63], v21
    ds_read_b128 v[128:131], v16 offset:37280
    v_exp_f32 v34, v34
    v_exp_f32 v35, v35
    v_exp_f32_e64 v36, v36
    v_mfma_f32_32x32x16_bf16 v[48:63], v[132:135], v[12:15], v[80:95]
    ds_read_b128 v[136:139], v17 offset:37280
    v_exp_f32 v37, v37
    v_exp_f32 v38, v38
    v_exp_f32 v39, v39
    v_exp_f32 v40, v40
    v_exp_f32 v41, v41
    v_exp_f32 v42, v42
    v_smfmac_f32_32x32x32_bf16 v[96:111], v[144:147], v[32:39], v21
    ds_read_b128 v[140:143], v20 offset:37280
    v_exp_f32 v43, v43
    v_exp_f32 v44, v44
    v_exp_f32 v45, v45
    v_exp_f32 v46, v46
    v_exp_f32 v47, v47
    v_exp_f32 v48, v48
    v_exp_f32_e64 v49, v49
    v_smfmac_f32_32x32x32_bf16 v[96:111], v[148:151], v[40:47], v21
    s_waitcnt lgkmcnt(0)
    v_exp_f32 v50, v50
    v_exp_f32 v51, v51
    v_exp_f32 v52, v52
    v_mfma_f32_32x32x16_bf16 v[32:47], v[128:131], v[8:11], v[64:79]
    v_exp_f32 v53, v53
    v_exp_f32 v54, v54
    v_exp_f32 v55, v55
    v_exp_f32 v56, v56
    v_exp_f32 v57, v57
    v_exp_f32 v58, v58
    v_smfmac_f32_32x32x32_bf16 v[112:127], v[144:147], v[48:55], v21
    v_exp_f32 v59, v59
    v_exp_f32 v60, v60
    v_exp_f32 v61, v61
    v_exp_f32 v62, v62
    v_exp_f32 v63, v63
    v_exp_f32 v32, v32
    v_exp_f32_e64 v33, v33
    v_smfmac_f32_32x32x32_bf16 v[112:127], v[148:151], v[56:63], v21
    ds_read_b128 v[132:135], v16 offset:39344
    v_exp_f32 v34, v34
    v_exp_f32 v35, v35
    v_exp_f32_e64 v36, v36
    v_mfma_f32_32x32x16_bf16 v[48:63], v[128:131], v[12:15], v[80:95]
    ds_read_b128 v[144:147], v17 offset:39344
    v_exp_f32 v37, v37
    v_exp_f32 v38, v38
    v_exp_f32 v39, v39
    v_exp_f32 v40, v40
    v_exp_f32 v41, v41
    v_exp_f32 v42, v42
    v_smfmac_f32_32x32x32_bf16 v[96:111], v[136:139], v[32:39], v21
    ds_read_b128 v[148:151], v20 offset:39344
    v_exp_f32 v43, v43
    v_exp_f32 v44, v44
    v_exp_f32 v45, v45
    v_exp_f32 v46, v46
    v_exp_f32 v47, v47
    v_exp_f32 v48, v48
    v_exp_f32_e64 v49, v49
    v_smfmac_f32_32x32x32_bf16 v[96:111], v[140:143], v[40:47], v21
    s_waitcnt lgkmcnt(0)
    v_exp_f32 v50, v50
    v_exp_f32 v51, v51
    v_exp_f32 v52, v52
    v_mfma_f32_32x32x16_bf16 v[32:47], v[132:135], v[8:11], v[64:79]
    v_exp_f32 v53, v53
    v_exp_f32 v54, v54
    v_exp_f32 v55, v55
    v_exp_f32 v56, v56
    v_exp_f32 v57, v57
    v_exp_f32 v58, v58
    v_smfmac_f32_32x32x32_bf16 v[112:127], v[136:139], v[48:55], v21
    v_exp_f32 v59, v59
    v_exp_f32 v60, v60
    v_exp_f32 v61, v61
    v_exp_f32 v62, v62
    v_exp_f32 v63, v63
    v_exp_f32 v32, v32
    v_exp_f32_e64 v33, v33
    v_smfmac_f32_32x32x32_bf16 v[112:127], v[140:143], v[56:63], v21
    ds_read_b128 v[128:131], v16 offset:41408
    v_exp_f32 v34, v34
    v_exp_f32 v35, v35
    v_exp_f32_e64 v36, v36
    v_mfma_f32_32x32x16_bf16 v[48:63], v[132:135], v[12:15], v[80:95]
    ds_read_b128 v[136:139], v17 offset:41408
    v_exp_f32 v37, v37
    v_exp_f32 v38, v38
    v_exp_f32 v39, v39
    v_exp_f32 v40, v40
    v_exp_f32 v41, v41
    v_exp_f32 v42, v42
    v_smfmac_f32_32x32x32_bf16 v[96:111], v[144:147], v[32:39], v21
    ds_read_b128 v[140:143], v20 offset:41408
    v_exp_f32 v43, v43
    v_exp_f32 v44, v44
    v_exp_f32 v45, v45
    v_exp_f32 v46, v46
    v_exp_f32 v47, v47
    v_exp_f32 v48, v48
    v_exp_f32_e64 v49, v49
    v_smfmac_f32_32x32x32_bf16 v[96:111], v[148:151], v[40:47], v21
    s_waitcnt lgkmcnt(0)
    v_exp_f32 v50, v50
    v_exp_f32 v51, v51
    v_exp_f32 v52, v52
    v_mfma_f32_32x32x16_bf16 v[32:47], v[128:131], v[8:11], v[64:79]
    v_exp_f32 v53, v53
    v_exp_f32 v54, v54
    v_exp_f32 v55, v55
    v_exp_f32 v56, v56
    v_exp_f32 v57, v57
    v_exp_f32 v58, v58
    v_smfmac_f32_32x32x32_bf16 v[112:127], v[144:147], v[48:55], v21
    v_exp_f32 v59, v59
    v_exp_f32 v60, v60
    v_exp_f32 v61, v61
    v_exp_f32 v62, v62
    v_exp_f32 v63, v63
    v_exp_f32 v32, v32
    v_exp_f32_e64 v33, v33
    v_smfmac_f32_32x32x32_bf16 v[112:127], v[148:151], v[56:63], v21
    ds_read_b128 v[132:135], v16 offset:43472
    v_exp_f32 v34, v34
    v_exp_f32 v35, v35
    v_exp_f32_e64 v36, v36
    v_mfma_f32_32x32x16_bf16 v[48:63], v[128:131], v[12:15], v[80:95]
    ds_read_b128 v[144:147], v17 offset:43472
    v_exp_f32 v37, v37
    v_exp_f32 v38, v38
    v_exp_f32 v39, v39
    v_exp_f32 v40, v40
    v_exp_f32 v41, v41
    v_exp_f32 v42, v42
    v_smfmac_f32_32x32x32_bf16 v[96:111], v[136:139], v[32:39], v21
    ds_read_b128 v[148:151], v20 offset:43472
    v_exp_f32 v43, v43
    v_exp_f32 v44, v44
    v_exp_f32 v45, v45
    v_exp_f32 v46, v46
    v_exp_f32 v47, v47
    v_exp_f32 v48, v48
    v_exp_f32_e64 v49, v49
    v_smfmac_f32_32x32x32_bf16 v[96:111], v[140:143], v[40:47], v21
    s_waitcnt lgkmcnt(0)
    v_exp_f32 v50, v50
    v_exp_f32 v51, v51
    v_exp_f32 v52, v52
    v_mfma_f32_32x32x16_bf16 v[32:47], v[132:135], v[8:11], v[64:79]
    v_exp_f32 v53, v53
    v_exp_f32 v54, v54
    v_exp_f32 v55, v55
    v_exp_f32 v56, v56
    v_exp_f32 v57, v57
    v_exp_f32 v58, v58
    v_smfmac_f32_32x32x32_bf16 v[112:127], v[136:139], v[48:55], v21
    ds_read_b32 v24, v25
    v_exp_f32 v59, v59
    v_exp_f32 v60, v60
    v_exp_f32 v61, v61
    v_exp_f32 v62, v62
    v_exp_f32 v63, v63
    v_exp_f32 v32, v32
    v_exp_f32_e64 v33, v33
    v_smfmac_f32_32x32x32_bf16 v[112:127], v[140:143], v[56:63], v21
    ds_read_b128 v[128:131], v16 offset:45536
    v_exp_f32 v34, v34
    v_exp_f32 v35, v35
    v_exp_f32_e64 v36, v36
    v_mfma_f32_32x32x16_bf16 v[48:63], v[132:135], v[12:15], v[80:95]
    ds_read_b128 v[136:139], v17 offset:45536
    v_exp_f32 v37, v37
    v_exp_f32 v38, v38
    v_exp_f32 v39, v39
    v_exp_f32 v40, v40
    v_exp_f32 v41, v41
    v_exp_f32 v42, v42
    v_smfmac_f32_32x32x32_bf16 v[96:111], v[144:147], v[32:39], v21
    ds_read_b128 v[140:143], v20 offset:45536
    v_exp_f32 v43, v43
    v_exp_f32 v44, v44
    v_exp_f32 v45, v45
    v_exp_f32 v46, v46
    v_exp_f32 v47, v47
    v_exp_f32 v48, v48
    v_exp_f32_e64 v49, v49
    v_smfmac_f32_32x32x32_bf16 v[96:111], v[148:151], v[40:47], v21
    s_waitcnt lgkmcnt(0)
    v_exp_f32 v50, v50
    v_exp_f32 v51, v51
    v_exp_f32 v52, v52
    v_mfma_f32_32x32x16_bf16 v[32:47], v[128:131], v[8:11], v[64:79]
    v_exp_f32 v53, v53
    v_exp_f32 v54, v54
    v_exp_f32 v55, v55
    v_exp_f32 v56, v56
    v_exp_f32 v57, v57
    v_exp_f32 v58, v58
    v_smfmac_f32_32x32x32_bf16 v[112:127], v[144:147], v[48:55], v21
    v_exp_f32 v59, v59
    v_exp_f32 v60, v60
    v_exp_f32 v61, v61
    v_exp_f32 v62, v62
    v_exp_f32 v63, v63
    v_exp_f32 v32, v32
    v_exp_f32_e64 v33, v33
    v_smfmac_f32_32x32x32_bf16 v[112:127], v[148:151], v[56:63], v21
    ds_read_b128 v[132:135], v16 offset:47600
    v_exp_f32 v34, v34
    v_exp_f32 v35, v35
    v_exp_f32_e64 v36, v36
    v_mfma_f32_32x32x16_bf16 v[48:63], v[128:131], v[12:15], v[80:95]
    ds_read_b128 v[144:147], v17 offset:47600
    v_exp_f32 v37, v37
    v_exp_f32 v38, v38
    v_exp_f32 v39, v39
    v_exp_f32 v40, v40
    v_exp_f32 v41, v41
    v_exp_f32 v42, v42
    v_smfmac_f32_32x32x32_bf16 v[96:111], v[136:139], v[32:39], v21
    ds_read_b128 v[148:151], v20 offset:47600
    v_exp_f32 v43, v43
    v_exp_f32 v44, v44
    v_exp_f32 v45, v45
    v_exp_f32 v46, v46
    v_exp_f32 v47, v47
    v_exp_f32 v48, v48
    v_exp_f32_e64 v49, v49
    v_smfmac_f32_32x32x32_bf16 v[96:111], v[140:143], v[40:47], v21
    s_waitcnt lgkmcnt(0)
    v_exp_f32 v50, v50
    v_exp_f32 v51, v51
    v_exp_f32 v52, v52
    v_mfma_f32_32x32x16_bf16 v[32:47], v[132:135], v[8:11], v[64:79]
    v_exp_f32 v53, v53
    v_exp_f32 v54, v54
    v_exp_f32 v55, v55
    v_exp_f32 v56, v56
    v_exp_f32 v57, v57
    v_exp_f32 v58, v58
    v_smfmac_f32_32x32x32_bf16 v[112:127], v[136:139], v[48:55], v21
    v_readfirstlane_b32 s86, v24
.p2align 3
    v_exp_f32 v59, v59
    v_exp_f32 v60, v60
    v_exp_f32 v61, v61
    v_exp_f32 v62, v62
    v_exp_f32 v63, v63
    v_exp_f32 v32, v32
    v_exp_f32_e64 v33, v33
    v_smfmac_f32_32x32x32_bf16 v[112:127], v[140:143], v[56:63], v21
    v_exp_f32 v34, v34
    v_exp_f32 v35, v35
    v_exp_f32_e64 v36, v36
    v_mfma_f32_32x32x16_bf16 v[48:63], v[132:135], v[12:15], v[80:95]
    v_exp_f32 v37, v37
    v_exp_f32 v38, v38
    v_exp_f32 v39, v39
    v_exp_f32 v40, v40
    v_exp_f32 v41, v41
    v_exp_f32 v42, v42
    v_smfmac_f32_32x32x32_bf16 v[96:111], v[144:147], v[32:39], v21
    v_exp_f32 v43, v43
    v_exp_f32 v44, v44
    v_exp_f32 v45, v45
    v_exp_f32 v46, v46
    v_exp_f32 v47, v47
    v_exp_f32 v48, v48
    v_exp_f32_e64 v49, v49
    v_smfmac_f32_32x32x32_bf16 v[96:111], v[148:151], v[40:47], v21
    s_waitcnt lgkmcnt(0)
    v_exp_f32 v50, v50
    v_exp_f32 v51, v51
    v_exp_f32 v52, v52
    v_exp_f32 v53, v53
    v_exp_f32 v54, v54
    v_exp_f32 v55, v55
    v_exp_f32 v56, v56
    v_exp_f32 v57, v57
    v_exp_f32 v58, v58
    v_smfmac_f32_32x32x32_bf16 v[112:127], v[144:147], v[48:55], v21
    v_exp_f32 v59, v59
    v_exp_f32 v60, v60
    v_exp_f32 v61, v61
    v_exp_f32 v62, v62
    v_exp_f32 v63, v63
    s_nop 1
    v_smfmac_f32_32x32x32_bf16 v[112:127], v[148:151], v[56:63], v21
    s_cmp_lg_u32 s86, 0
    s_cbranch_scc1 L_fallback
L_attn_fin:
    s_add_u32 s50, s63, 114688
    v_mov_b32 v26, v104
    s_nop 1
    v_permlane32_swap_b32 v26, v104
    v_rcp_f32 v26, v26
    s_nop 0
    v_pk_mul_f32 v[96:97], v[96:97], v[26:27] op_sel_hi:[1,0]
    v_pk_mul_f32 v[98:99], v[98:99], v[26:27] op_sel_hi:[1,0]
    v_pk_mul_f32 v[100:101], v[100:101], v[26:27] op_sel_hi:[1,0]
    v_pk_mul_f32 v[102:103], v[102:103], v[26:27] op_sel_hi:[1,0]
    v_cvt_pk_bf16_f32 v244, v96, v97
    v_cvt_pk_bf16_f32 v245, v98, v99
    v_cvt_pk_bf16_f32 v246, v100, v101
    v_cvt_pk_bf16_f32 v247, v102, v103
    buffer_store_dwordx4 v[244:247], v1, s[4:7], s63 offen
    v_mov_b32 v26, v120
    s_nop 1
    v_permlane32_swap_b32 v26, v120
    v_rcp_f32 v26, v26
    s_nop 0
    v_pk_mul_f32 v[112:113], v[112:113], v[26:27] op_sel_hi:[1,0]
    v_pk_mul_f32 v[114:115], v[114:115], v[26:27] op_sel_hi:[1,0]
    v_pk_mul_f32 v[116:117], v[116:117], v[26:27] op_sel_hi:[1,0]
    v_pk_mul_f32 v[118:119], v[118:119], v[26:27] op_sel_hi:[1,0]
    v_cvt_pk_bf16_f32 v248, v112, v113
    v_cvt_pk_bf16_f32 v249, v114, v115
    v_cvt_pk_bf16_f32 v250, v116, v117
    v_cvt_pk_bf16_f32 v251, v118, v119
    buffer_store_dwordx4 v[248:251], v1, s[4:7], s50 offen
    v_and_b32 v12, 0x300, v1
    v_add_u32 v124, v12, v1
    v_and_b32 v125, 0x2f0, v124
    v_lshrrev_b32 v12, 5, v0
    v_lshl_add_u32 v125, v12, 8, v125
    s_mul_i32 s50, s75, 12288
    s_lshl_b32 s51, s75, 12
    s_add_u32 s51, s51, 4096
    v_add_u32 v2, s50, v124
    v_add_u32 v5, s51, v124
    v_add_u32 v3, 65536, v2
    v_add_u32 v6, 65536, v5
    v_add_u32 v4, 131072, v2
    v_add_u32 v7, 131072, v5
    s_lshl_b32 s50, s42, 12
    s_add_u32 s50, s50, 147456
    v_add_u32 v14, s50, v1
    v_xor_b32 v15, 8192, v14
    v_and_b32 v12, 15, v0
    s_lshl_b32 s50, s75, 6
    s_lshr_b32 s57, s76, 1
    s_lshl_b32 s57, s57, 7
    s_add_u32 s50, s50, s57
    v_lshl_add_u32 v12, v12, 2, s50
    v_add_u32 v16, 131072, v1
    v_add_u32 v17, 131072, v125
    v_lshl_add_u32 v17, s42, 11, v17
    s_add_u32 s56, s49, 2
    v_mov_b32 v26, s56
    s_mov_b64 exec, 1
    s_cmp_lg_u32 s45, 0
    s_cbranch_scc1 pubs_4
    s_waitcnt vmcnt(0)
    buffer_store_dword v26, off, s[4:7], s48
pubd_5:
    s_mov_b64 exec, -1
    s_barrier
    ds_read_b128 v[192:195], v17 offset:5120
    ds_read_b128 v[196:199], v17 offset:6144
    ds_read_b128 v[80:83], v16 offset:0
    ds_read_b128 v[84:87], v16 offset:1024
    ds_read_b128 v[88:91], v16 offset:2048
    ds_read_b128 v[8:11], v16 offset:3072
    ds_read_b128 v[120:123], v16 offset:4096
    ds_read_b128 v[208:211], v5 offset:0
    ds_read_b128 v[212:215], v5 offset:256
    ds_read_b128 v[216:219], v2 offset:0
    ds_read_b128 v[220:223], v2 offset:256
    ds_read_b128 v[224:227], v5 offset:2048
    ds_read_b128 v[228:231], v5 offset:2304
    ds_read_b128 v[232:235], v2 offset:2048
    ds_read_b128 v[236:239], v2 offset:2304
    s_waitcnt lgkmcnt(13)
    v_permlane32_swap_b32 v192, v194
    v_permlane32_swap_b32 v193, v195
    v_permlane32_swap_b32 v196, v198
    v_permlane32_swap_b32 v197, v199
    v_lshlrev_b32 v32, 16, v192
    v_and_b32 v33, 0xffff0000, v192
    v_lshlrev_b32 v34, 16, v193
    v_and_b32 v35, 0xffff0000, v193
    v_lshlrev_b32 v36, 16, v194
    v_and_b32 v37, 0xffff0000, v194
    v_lshlrev_b32 v38, 16, v195
    v_and_b32 v39, 0xffff0000, v195
    v_lshlrev_b32 v40, 16, v196
    v_and_b32 v41, 0xffff0000, v196
    v_lshlrev_b32 v42, 16, v197
    v_and_b32 v43, 0xffff0000, v197
    v_lshlrev_b32 v44, 16, v198
    v_and_b32 v45, 0xffff0000, v198
    v_lshlrev_b32 v46, 16, v199
    v_and_b32 v47, 0xffff0000, v199
    s_waitcnt lgkmcnt(8)
    s_barrier
    s_mov_b32 s55, s68
    s_add_u32 s56, s49, 2
pl_6:
    buffer_load_dword v13, v12, s[4:7], s47 offen sc1
    s_sub_u32 s46, s46, 1
    s_cbranch_scc1 pt_7
    s_cmp_lg_u32 s45, 0
    s_waitcnt vmcnt(0)
    v_cmp_gt_u32 vcc, s56, v13
    s_cbranch_vccnz pl_6
    s_cbranch_scc1 pa_8
pd_9:
    buffer_load_dwordx4 v[128:131], v124, s[4:7], s55 offen offset:0 sc1
    buffer_load_dwordx4 v[132:135], v124, s[4:7], s55 offen offset:256 sc1
    buffer_load_dwordx4 v[136:139], v124, s[4:7], s55 offen offset:2048 sc1
    buffer_load_dwordx4 v[140:143], v124, s[4:7], s55 offen offset:2304 sc1
    s_add_u32 s55, s68, 4096
    buffer_load_dwordx4 v[144:147], v124, s[4:7], s55 offen offset:0 sc1
    buffer_load_dwordx4 v[148:151], v124, s[4:7], s55 offen offset:256 sc1
    s_waitcnt vmcnt(5) lgkmcnt(6)
    v_mfma_f32_16x16x32_bf16 v[48:51], v[208:211], v[128:131], 0
    s_waitcnt vmcnt(4)
    v_mfma_f32_16x16x32_bf16 v[52:55], v[208:211], v[132:135], 0
    buffer_load_dwordx4 v[152:155], v124, s[4:7], s55 offen offset:2048 sc1
    v_mfma_f32_16x16x32_bf16 v[56:59], v[212:215], v[128:131], 0
    ds_read_b128 v[208:211], v5 offset:16384
    v_mfma_f32_16x16x32_bf16 v[60:63], v[212:215], v[132:135], 0
    buffer_load_dwordx4 v[156:159], v124, s[4:7], s55 offen offset:2304 sc1
    s_waitcnt lgkmcnt(5)
    v_mfma_f32_16x16x32_bf16 v[32:35], v[216:219], v[128:131], v[32:35]
    ds_read_b128 v[212:215], v5 offset:16640
    v_mfma_f32_16x16x32_bf16 v[36:39], v[216:219], v[132:135], v[36:39]
    s_add_u32 s55, s68, 8192
    buffer_load_dwordx4 v[160:163], v124, s[4:7], s55 offen offset:0 sc1
    v_mfma_f32_16x16x32_bf16 v[40:43], v[220:223], v[128:131], v[40:43]
    ds_read_b128 v[216:219], v2 offset:16384
    v_mfma_f32_16x16x32_bf16 v[44:47], v[220:223], v[132:135], v[44:47]
    buffer_load_dwordx4 v[164:167], v124, s[4:7], s55 offen offset:256 sc1
    s_waitcnt vmcnt(7) lgkmcnt(5)
    v_mfma_f32_16x16x32_bf16 v[48:51], v[224:227], v[136:139], v[48:51]
    ds_read_b128 v[220:223], v2 offset:16640
    s_waitcnt vmcnt(6)
    v_mfma_f32_16x16x32_bf16 v[52:55], v[224:227], v[140:143], v[52:55]
    buffer_load_dwordx4 v[168:171], v124, s[4:7], s55 offen offset:2048 sc1
    v_mfma_f32_16x16x32_bf16 v[56:59], v[228:231], v[136:139], v[56:59]
    ds_read_b128 v[224:227], v5 offset:18432
    v_mfma_f32_16x16x32_bf16 v[60:63], v[228:231], v[140:143], v[60:63]
    buffer_load_dwordx4 v[172:175], v124, s[4:7], s55 offen offset:2304 sc1
    s_waitcnt lgkmcnt(5)
    v_mfma_f32_16x16x32_bf16 v[32:35], v[232:235], v[136:139], v[32:35]
    ds_read_b128 v[228:231], v5 offset:18688
    v_mfma_f32_16x16x32_bf16 v[36:39], v[232:235], v[140:143], v[36:39]
    s_add_u32 s55, s68, 12288
    buffer_load_dwordx4 v[176:179], v124, s[4:7], s55 offen offset:0 sc1
    v_mfma_f32_16x16x32_bf16 v[40:43], v[236:239], v[136:139], v[40:43]
    ds_read_b128 v[232:235], v2 offset:18432
    v_mfma_f32_16x16x32_bf16 v[44:47], v[236:239], v[140:143], v[44:47]
    buffer_load_dwordx4 v[180:183], v124, s[4:7], s55 offen offset:256 sc1
    s_waitcnt vmcnt(9) lgkmcnt(5)
    v_mfma_f32_16x16x32_bf16 v[48:51], v[208:211], v[144:147], v[48:51]
    ds_read_b128 v[236:239], v2 offset:18688
    s_waitcnt vmcnt(8)
    v_mfma_f32_16x16x32_bf16 v[52:55], v[208:211], v[148:151], v[52:55]
    buffer_load_dwordx4 v[184:187], v124, s[4:7], s55 offen offset:2048 sc1
    v_mfma_f32_16x16x32_bf16 v[56:59], v[212:215], v[144:147], v[56:59]
    ds_read_b128 v[208:211], v5 offset:32768
    v_mfma_f32_16x16x32_bf16 v[60:63], v[212:215], v[148:151], v[60:63]
    buffer_load_dwordx4 v[188:191], v124, s[4:7], s55 offen offset:2304 sc1
    s_waitcnt lgkmcnt(5)
    v_mfma_f32_16x16x32_bf16 v[32:35], v[216:219], v[144:147], v[32:35]
    ds_read_b128 v[212:215], v5 offset:33024
    v_mfma_f32_16x16x32_bf16 v[36:39], v[216:219], v[148:151], v[36:39]
    v_mfma_f32_16x16x32_bf16 v[40:43], v[220:223], v[144:147], v[40:43]
    ds_read_b128 v[216:219], v5 offset:34816
    v_mfma_f32_16x16x32_bf16 v[44:47], v[220:223], v[148:151], v[44:47]
    s_waitcnt vmcnt(9) lgkmcnt(5)
    v_mfma_f32_16x16x32_bf16 v[48:51], v[224:227], v[152:155], v[48:51]
    ds_read_b128 v[220:223], v5 offset:35072
    s_waitcnt vmcnt(8)
    v_mfma_f32_16x16x32_bf16 v[52:55], v[224:227], v[156:159], v[52:55]
    v_mfma_f32_16x16x32_bf16 v[56:59], v[228:231], v[152:155], v[56:59]
    ds_read_b128 v[224:227], v5 offset:49152
    v_mfma_f32_16x16x32_bf16 v[60:63], v[228:231], v[156:159], v[60:63]
    s_waitcnt lgkmcnt(5)
    v_mfma_f32_16x16x32_bf16 v[32:35], v[232:235], v[152:155], v[32:35]
    ds_read_b128 v[228:231], v5 offset:49408
    v_mfma_f32_16x16x32_bf16 v[36:39], v[232:235], v[156:159], v[36:39]
    v_mfma_f32_16x16x32_bf16 v[40:43], v[236:239], v[152:155], v[40:43]
    ds_read_b128 v[232:235], v5 offset:51200
    v_mfma_f32_16x16x32_bf16 v[44:47], v[236:239], v[156:159], v[44:47]
    s_waitcnt vmcnt(7) lgkmcnt(5)
    v_mfma_f32_16x16x32_bf16 v[48:51], v[208:211], v[160:163], v[48:51]
    ds_read_b128 v[236:239], v5 offset:51456
    s_waitcnt vmcnt(6)
    v_mfma_f32_16x16x32_bf16 v[52:55], v[208:211], v[164:167], v[52:55]
    v_mfma_f32_16x16x32_bf16 v[56:59], v[212:215], v[160:163], v[56:59]
    ds_read_b128 v[208:211], v2 offset:32768
    v_mfma_f32_16x16x32_bf16 v[60:63], v[212:215], v[164:167], v[60:63]
    s_waitcnt vmcnt(5) lgkmcnt(5)
    v_mfma_f32_16x16x32_bf16 v[48:51], v[216:219], v[168:171], v[48:51]
    ds_read_b128 v[212:215], v2 offset:33024
    s_waitcnt vmcnt(4)
    v_mfma_f32_16x16x32_bf16 v[52:55], v[216:219], v[172:175], v[52:55]
    v_mfma_f32_16x16x32_bf16 v[56:59], v[220:223], v[168:171], v[56:59]
    ds_read_b128 v[216:219], v2 offset:34816
    v_mfma_f32_16x16x32_bf16 v[60:63], v[220:223], v[172:175], v[60:63]
    s_waitcnt vmcnt(3) lgkmcnt(5)
    v_mfma_f32_16x16x32_bf16 v[48:51], v[224:227], v[176:179], v[48:51]
    ds_read_b128 v[220:223], v2 offset:35072
    s_waitcnt vmcnt(2)
    v_mfma_f32_16x16x32_bf16 v[52:55], v[224:227], v[180:183], v[52:55]
    v_mfma_f32_16x16x32_bf16 v[56:59], v[228:231], v[176:179], v[56:59]
    ds_read_b128 v[224:227], v2 offset:49152
    v_mfma_f32_16x16x32_bf16 v[60:63], v[228:231], v[180:183], v[60:63]
    s_waitcnt vmcnt(1) lgkmcnt(5)
    v_mfma_f32_16x16x32_bf16 v[48:51], v[232:235], v[184:187], v[48:51]
    ds_read_b128 v[228:231], v2 offset:49408
    s_waitcnt vmcnt(0)
    v_mfma_f32_16x16x32_bf16 v[52:55], v[232:235], v[188:191], v[52:55]
    v_mfma_f32_16x16x32_bf16 v[56:59], v[236:239], v[184:187], v[56:59]
    ds_read_b128 v[232:235], v2 offset:51200
    v_mfma_f32_16x16x32_bf16 v[60:63], v[236:239], v[188:191], v[60:63]
    s_waitcnt lgkmcnt(5)
    v_mfma_f32_16x16x32_bf16 v[32:35], v[208:211], v[160:163], v[32:35]
    ds_read_b128 v[236:239], v2 offset:51456
    v_mfma_f32_16x16x32_bf16 v[36:39], v[208:211], v[164:167], v[36:39]
    v_mfma_f32_16x16x32_bf16 v[40:43], v[212:215], v[160:163], v[40:43]
    ds_write_b128 v14, v[48:51] offset:0
    v_mfma_f32_16x16x32_bf16 v[44:47], v[212:215], v[164:167], v[44:47]
    ds_write_b128 v14, v[52:55] offset:1024
    s_waitcnt lgkmcnt(6)
    v_mfma_f32_16x16x32_bf16 v[32:35], v[216:219], v[168:171], v[32:35]
    ds_write_b128 v14, v[56:59] offset:2048
    v_mfma_f32_16x16x32_bf16 v[36:39], v[216:219], v[172:175], v[36:39]
    ds_write_b128 v14, v[60:63] offset:3072
    v_mfma_f32_16x16x32_bf16 v[40:43], v[220:223], v[168:171], v[40:43]
    v_mfma_f32_16x16x32_bf16 v[44:47], v[220:223], v[172:175], v[44:47]
    s_waitcnt lgkmcnt(6)
    v_mfma_f32_16x16x32_bf16 v[32:35], v[224:227], v[176:179], v[32:35]
    v_mfma_f32_16x16x32_bf16 v[36:39], v[224:227], v[180:183], v[36:39]
    s_waitcnt lgkmcnt(0)
    s_barrier
    ds_read_b128 v[48:51], v15 offset:0
    ds_read_b128 v[52:55], v15 offset:1024
    ds_read_b128 v[56:59], v15 offset:2048
    ds_read_b128 v[60:63], v15 offset:3072
    v_mfma_f32_16x16x32_bf16 v[40:43], v[228:231], v[176:179], v[40:43]
    v_mfma_f32_16x16x32_bf16 v[44:47], v[228:231], v[180:183], v[44:47]
    v_mfma_f32_16x16x32_bf16 v[32:35], v[232:235], v[184:187], v[32:35]
    v_mfma_f32_16x16x32_bf16 v[36:39], v[232:235], v[188:191], v[36:39]
    v_mfma_f32_16x16x32_bf16 v[40:43], v[236:239], v[184:187], v[40:43]
    v_mfma_f32_16x16x32_bf16 v[44:47], v[236:239], v[188:191], v[44:47]
    s_waitcnt lgkmcnt(3)
    s_nop 3
    v_pk_add_f32 v[32:33], v[32:33], v[48:49]
    v_pk_add_f32 v[34:35], v[34:35], v[50:51]
    v_cvt_pk_bf16_f32 v20, v32, v33
    v_cvt_pk_bf16_f32 v21, v34, v35
    s_waitcnt lgkmcnt(2)
    v_pk_add_f32 v[36:37], v[36:37], v[52:53]
    v_pk_add_f32 v[38:39], v[38:39], v[54:55]
    v_cvt_pk_bf16_f32 v22, v36, v37
    v_cvt_pk_bf16_f32 v23, v38, v39
    s_waitcnt lgkmcnt(1)
    v_pk_add_f32 v[40:41], v[40:41], v[56:57]
    v_pk_add_f32 v[42:43], v[42:43], v[58:59]
    v_cvt_pk_bf16_f32 v24, v40, v41
    v_cvt_pk_bf16_f32 v25, v42, v43
    v_permlane32_swap_b32 v20, v22
    v_permlane32_swap_b32 v21, v23
    buffer_store_dwordx4 v[20:23], v125, s[4:7], s66 offen offset:0
    s_waitcnt lgkmcnt(0)
    v_pk_add_f32 v[44:45], v[44:45], v[60:61]
    v_pk_add_f32 v[46:47], v[46:47], v[62:63]
    v_cvt_pk_bf16_f32 v26, v44, v45
    v_cvt_pk_bf16_f32 v27, v46, v47
    s_nop 0
    v_permlane32_swap_b32 v24, v26
    v_permlane32_swap_b32 v25, v27
    buffer_store_dwordx4 v[24:27], v125, s[4:7], s66 offen offset:1024
    v_pk_add_f32 v[48:49], v[32:33], v[34:35]
    v_pk_mul_f32 v[50:51], v[32:33], v[32:33]
    v_pk_fma_f32 v[50:51], v[34:35], v[34:35], v[50:51]
    v_pk_add_f32 v[48:49], v[48:49], v[40:41]
    v_pk_fma_f32 v[50:51], v[40:41], v[40:41], v[50:51]
    v_pk_add_f32 v[48:49], v[48:49], v[42:43]
    v_pk_fma_f32 v[50:51], v[42:43], v[42:43], v[50:51]
    v_add_f32 v48, v48, v49
    v_add_f32 v50, v50, v51
    v_pk_add_f32 v[52:53], v[36:37], v[38:39]
    v_pk_mul_f32 v[54:55], v[36:37], v[36:37]
    v_pk_fma_f32 v[54:55], v[38:39], v[38:39], v[54:55]
    v_pk_add_f32 v[52:53], v[52:53], v[44:45]
    v_pk_fma_f32 v[54:55], v[44:45], v[44:45], v[54:55]
    v_pk_add_f32 v[52:53], v[52:53], v[46:47]
    v_pk_fma_f32 v[54:55], v[46:47], v[46:47], v[54:55]
    v_add_f32 v52, v52, v53
    v_add_f32 v54, v54, v55
    v_permlane32_swap_b32 v48, v50
    s_nop 0
    v_permlane32_swap_b32 v52, v54
    v_add_f32 v48, v48, v50
    v_add_f32 v52, v52, v54
    s_nop 1
    v_permlane16_swap_b32 v48, v52
    v_add_f32 v48, v48, v52
    buffer_store_dword v48, v1, s[4:7], s67 offen
    s_lshr_b32 s51, s41, 4
    s_lshl_b32 s51, s51, 2
    s_add_u32 s51, s51, s42
    v_and_b32 v14, 7, v0
    v_lshlrev_b32 v14, 2, v14
    v_and_b32 v15, 8, v0
    v_lshlrev_b32 v15, 5, v15
    s_lshr_b32 s50, s51, 1
    s_lshl_b32 s50, s50, 5
    s_and_b32 s57, s51, 1
    s_lshl_b32 s57, s57, 7
    s_add_u32 s50, s50, s57
    v_add3_u32 v14, v14, v15, s50
    v_add_u32 v2, 0x10000, v124
    v_add_u32 v3, 0x20000, v124
    s_add_u32 s56, s49, 3
    v_mov_b32 v15, s56
    s_mov_b64 exec, 1
    s_cmp_lg_u32 s45, 0
    s_cbranch_scc1 pubs_10
    s_waitcnt vmcnt(0)
    buffer_store_dword v15, off, s[4:7], s48
pubd_11:
    s_mov_b64 exec, -1
    s_waitcnt lgkmcnt(0)
    s_barrier
    ds_read_b128 v[96:99], v2 offset:0
    ds_read_b128 v[100:103], v2 offset:32768
    ds_read_b128 v[104:107], v3 offset:0
    ds_read_b128 v[108:111], v2 offset:256
    ds_read_b128 v[112:115], v2 offset:33024
    ds_read_b128 v[116:119], v3 offset:256
    s_mov_b32 s55, s71
    s_add_u32 s56, s49, 3
pl_12:
    buffer_load_dword v15, v14, s[4:7], s47 offen sc1
    s_sub_u32 s46, s46, 1
    s_cbranch_scc1 pt_13
    s_cmp_lg_u32 s45, 0
    s_waitcnt vmcnt(0)
    v_cmp_gt_u32 vcc, s56, v15
    s_cbranch_vccnz pl_12
    s_cbranch_scc1 pa_14
pd_15:
    buffer_load_dwordx4 v[128:131], v124, s[4:7], s55 offen offset:0 sc1
    buffer_load_dwordx4 v[132:135], v124, s[4:7], s55 offen offset:256 sc1
    buffer_load_dwordx4 v[136:139], v124, s[4:7], s55 offen offset:2048 sc1
    buffer_load_dwordx4 v[140:143], v124, s[4:7], s55 offen offset:2304 sc1
    s_add_u32 s55, s71, 4096
    buffer_load_dwordx4 v[144:147], v124, s[4:7], s55 offen offset:0 sc1
    buffer_load_dwordx4 v[148:151], v124, s[4:7], s55 offen offset:256 sc1
    s_waitcnt vmcnt(5) lgkmcnt(4)
    v_mfma_f32_16x16x32_bf16 v[16:19], v[96:99], v[128:131], 0
    s_waitcnt vmcnt(4)
    v_mfma_f32_16x16x32_bf16 v[20:23], v[96:99], v[132:135], 0
    buffer_load_dwordx4 v[152:155], v124, s[4:7], s55 offen offset:2048 sc1
    v_mfma_f32_16x16x32_bf16 v[32:35], v[100:103], v[128:131], 0
    ds_read_b128 v[96:99], v2 offset:2048
    v_mfma_f32_16x16x32_bf16 v[36:39], v[100:103], v[132:135], 0
    s_waitcnt lgkmcnt(3)
    v_mfma_f32_16x16x32_bf16 v[48:51], v[104:107], v[128:131], 0
    ds_read_b128 v[100:103], v2 offset:34816
    v_mfma_f32_16x16x32_bf16 v[52:55], v[104:107], v[132:135], 0
    buffer_load_dwordx4 v[156:159], v124, s[4:7], s55 offen offset:2304 sc1
    v_mfma_f32_16x16x32_bf16 v[24:27], v[108:111], v[128:131], 0
    ds_read_b128 v[104:107], v3 offset:2048
    v_mfma_f32_16x16x32_bf16 v[28:31], v[108:111], v[132:135], 0
    s_add_u32 s55, s71, 8192
    buffer_load_dwordx4 v[160:163], v124, s[4:7], s55 offen offset:0 sc1
    s_waitcnt lgkmcnt(3)
    v_mfma_f32_16x16x32_bf16 v[40:43], v[112:115], v[128:131], 0
    ds_read_b128 v[108:111], v2 offset:2304
    v_mfma_f32_16x16x32_bf16 v[44:47], v[112:115], v[132:135], 0
    buffer_load_dwordx4 v[164:167], v124, s[4:7], s55 offen offset:256 sc1
    v_mfma_f32_16x16x32_bf16 v[56:59], v[116:119], v[128:131], 0
    ds_read_b128 v[112:115], v2 offset:35072
    v_mfma_f32_16x16x32_bf16 v[60:63], v[116:119], v[132:135], 0
    s_waitcnt vmcnt(7) lgkmcnt(3)
    v_mfma_f32_16x16x32_bf16 v[16:19], v[96:99], v[136:139], v[16:19]
    ds_read_b128 v[116:119], v3 offset:2304
    s_waitcnt vmcnt(6)
    v_mfma_f32_16x16x32_bf16 v[20:23], v[96:99], v[140:143], v[20:23]
    s_add_u32 s52, s72, 0
    buffer_load_dwordx4 v[64:67], v1, s[4:7], s52 offen offset:0 sc1
    v_mfma_f32_16x16x32_bf16 v[32:35], v[100:103], v[136:139], v[32:35]
    ds_read_b128 v[96:99], v2 offset:4096
    v_mfma_f32_16x16x32_bf16 v[36:39], v[100:103], v[140:143], v[36:39]
    s_waitcnt lgkmcnt(3)
    v_mfma_f32_16x16x32_bf16 v[48:51], v[104:107], v[136:139], v[48:51]
    ds_read_b128 v[100:103], v2 offset:36864
    v_mfma_f32_16x16x32_bf16 v[52:55], v[104:107], v[140:143], v[52:55]
    buffer_load_dwordx4 v[168:171], v124, s[4:7], s55 offen offset:2048 sc1
    v_mfma_f32_16x16x32_bf16 v[24:27], v[108:111], v[136:139], v[24:27]
    ds_read_b128 v[104:107], v3 offset:4096
    v_mfma_f32_16x16x32_bf16 v[28:31], v[108:111], v[140:143], v[28:31]
    buffer_load_dwordx4 v[68:71], v1, s[4:7], s52 offen offset:1024 sc1
    s_waitcnt lgkmcnt(3)
    v_mfma_f32_16x16x32_bf16 v[40:43], v[112:115], v[136:139], v[40:43]
    ds_read_b128 v[108:111], v2 offset:4352
    v_mfma_f32_16x16x32_bf16 v[44:47], v[112:115], v[140:143], v[44:47]
    buffer_load_dwordx4 v[172:175], v124, s[4:7], s55 offen offset:2304 sc1
    v_mfma_f32_16x16x32_bf16 v[56:59], v[116:119], v[136:139], v[56:59]
    ds_read_b128 v[112:115], v2 offset:37120
    v_mfma_f32_16x16x32_bf16 v[60:63], v[116:119], v[140:143], v[60:63]
    s_waitcnt vmcnt(9) lgkmcnt(3)
    v_mfma_f32_16x16x32_bf16 v[16:19], v[96:99], v[144:147], v[16:19]
    ds_read_b128 v[116:119], v3 offset:4352
    s_waitcnt vmcnt(8)
    v_mfma_f32_16x16x32_bf16 v[20:23], v[96:99], v[148:151], v[20:23]
    buffer_load_dwordx4 v[72:75], v1, s[4:7], s52 offen offset:2048 sc1
    v_mfma_f32_16x16x32_bf16 v[32:35], v[100:103], v[144:147], v[32:35]
    ds_read_b128 v[96:99], v2 offset:6144
    v_mfma_f32_16x16x32_bf16 v[36:39], v[100:103], v[148:151], v[36:39]
    s_waitcnt lgkmcnt(3)
    v_mfma_f32_16x16x32_bf16 v[48:51], v[104:107], v[144:147], v[48:51]
    ds_read_b128 v[100:103], v2 offset:38912
    v_mfma_f32_16x16x32_bf16 v[52:55], v[104:107], v[148:151], v[52:55]
    s_add_u32 s55, s71, 12288
    buffer_load_dwordx4 v[176:179], v124, s[4:7], s55 offen offset:0 sc1
    v_mfma_f32_16x16x32_bf16 v[24:27], v[108:111], v[144:147], v[24:27]
    ds_read_b128 v[104:107], v3 offset:6144
    v_mfma_f32_16x16x32_bf16 v[28:31], v[108:111], v[148:151], v[28:31]
    buffer_load_dwordx4 v[76:79], v1, s[4:7], s52 offen offset:3072 sc1
    s_waitcnt lgkmcnt(3)
    v_mfma_f32_16x16x32_bf16 v[40:43], v[112:115], v[144:147], v[40:43]
    ds_read_b128 v[108:111], v2 offset:6400
    v_mfma_f32_16x16x32_bf16 v[44:47], v[112:115], v[148:151], v[44:47]
    buffer_load_dwordx4 v[180:183], v124, s[4:7], s55 offen offset:256 sc1
    v_mfma_f32_16x16x32_bf16 v[56:59], v[116:119], v[144:147], v[56:59]
    ds_read_b128 v[112:115], v2 offset:39168
    v_mfma_f32_16x16x32_bf16 v[60:63], v[116:119], v[148:151], v[60:63]
    s_waitcnt vmcnt(11) lgkmcnt(3)
    v_mfma_f32_16x16x32_bf16 v[16:19], v[96:99], v[152:155], v[16:19]
    ds_read_b128 v[116:119], v3 offset:6400
    s_waitcnt vmcnt(10)
    v_mfma_f32_16x16x32_bf16 v[20:23], v[96:99], v[156:159], v[20:23]
    buffer_load_dwordx4 v[184:187], v124, s[4:7], s55 offen offset:2048 sc1
    v_mfma_f32_16x16x32_bf16 v[32:35], v[100:103], v[152:155], v[32:35]
    ds_read_b128 v[96:99], v2 offset:8192
    v_mfma_f32_16x16x32_bf16 v[36:39], v[100:103], v[156:159], v[36:39]
    s_waitcnt lgkmcnt(3)
    v_mfma_f32_16x16x32_bf16 v[48:51], v[104:107], v[152:155], v[48:51]
    ds_read_b128 v[100:103], v2 offset:40960
    v_mfma_f32_16x16x32_bf16 v[52:55], v[104:107], v[156:159], v[52:55]
    buffer_load_dwordx4 v[188:191], v124, s[4:7], s55 offen offset:2304 sc1
    v_mfma_f32_16x16x32_bf16 v[24:27], v[108:111], v[152:155], v[24:27]
    ds_read_b128 v[104:107], v3 offset:8192
    v_mfma_f32_16x16x32_bf16 v[28:31], v[108:111], v[156:159], v[28:31]
    s_waitcnt lgkmcnt(3)
    v_mfma_f32_16x16x32_bf16 v[40:43], v[112:115], v[152:155], v[40:43]
    ds_read_b128 v[108:111], v2 offset:8448
    v_mfma_f32_16x16x32_bf16 v[44:47], v[112:115], v[156:159], v[44:47]
    v_mfma_f32_16x16x32_bf16 v[56:59], v[116:119], v[152:155], v[56:59]
    ds_read_b128 v[112:115], v2 offset:41216
    v_mfma_f32_16x16x32_bf16 v[60:63], v[116:119], v[156:159], v[60:63]
    s_waitcnt vmcnt(11) lgkmcnt(3)
    v_mfma_f32_16x16x32_bf16 v[16:19], v[96:99], v[160:163], v[16:19]
    ds_read_b128 v[116:119], v3 offset:8448
    s_waitcnt vmcnt(10)
    v_mfma_f32_16x16x32_bf16 v[20:23], v[96:99], v[164:167], v[20:23]
    s_add_u32 s55, s71, 16384
    buffer_load_dwordx4 v[192:195], v124, s[4:7], s55 offen offset:0 sc1
    v_mfma_f32_16x16x32_bf16 v[32:35], v[100:103], v[160:163], v[32:35]
    ds_read_b128 v[96:99], v2 offset:10240
    v_mfma_f32_16x16x32_bf16 v[36:39], v[100:103], v[164:167], v[36:39]
    s_waitcnt lgkmcnt(3)
    v_mfma_f32_16x16x32_bf16 v[48:51], v[104:107], v[160:163], v[48:51]
    ds_read_b128 v[100:103], v2 offset:43008
    v_mfma_f32_16x16x32_bf16 v[52:55], v[104:107], v[164:167], v[52:55]
    buffer_load_dwordx4 v[196:199], v124, s[4:7], s55 offen offset:256 sc1
    v_mfma_f32_16x16x32_bf16 v[24:27], v[108:111], v[160:163], v[24:27]
    ds_read_b128 v[104:107], v3 offset:10240
    v_mfma_f32_16x16x32_bf16 v[28:31], v[108:111], v[164:167], v[28:31]
    s_waitcnt lgkmcnt(3)
    v_mfma_f32_16x16x32_bf16 v[40:43], v[112:115], v[160:163], v[40:43]
    ds_read_b128 v[108:111], v2 offset:10496
    v_mfma_f32_16x16x32_bf16 v[44:47], v[112:115], v[164:167], v[44:47]
    v_mfma_f32_16x16x32_bf16 v[56:59], v[116:119], v[160:163], v[56:59]
    ds_read_b128 v[112:115], v2 offset:43264
    v_mfma_f32_16x16x32_bf16 v[60:63], v[116:119], v[164:167], v[60:63]
    s_waitcnt vmcnt(10) lgkmcnt(3)
    v_mfma_f32_16x16x32_bf16 v[16:19], v[96:99], v[168:171], v[16:19]
    ds_read_b128 v[116:119], v3 offset:10496
    s_waitcnt vmcnt(8)
    v_mfma_f32_16x16x32_bf16 v[20:23], v[96:99], v[172:175], v[20:23]
    buffer_load_dwordx4 v[200:203], v124, s[4:7], s55 offen offset:2048 sc1
    v_mfma_f32_16x16x32_bf16 v[32:35], v[100:103], v[168:171], v[32:35]
    ds_read_b128 v[96:99], v2 offset:12288
    v_mfma_f32_16x16x32_bf16 v[36:39], v[100:103], v[172:175], v[36:39]
    s_waitcnt lgkmcnt(3)
    v_mfma_f32_16x16x32_bf16 v[48:51], v[104:107], v[168:171], v[48:51]
    ds_read_b128 v[100:103], v2 offset:45056
    v_mfma_f32_16x16x32_bf16 v[52:55], v[104:107], v[172:175], v[52:55]
    buffer_load_dwordx4 v[204:207], v124, s[4:7], s55 offen offset:2304 sc1
    v_mfma_f32_16x16x32_bf16 v[24:27], v[108:111], v[168:171], v[24:27]
    ds_read_b128 v[104:107], v3 offset:12288
    v_mfma_f32_16x16x32_bf16 v[28:31], v[108:111], v[172:175], v[28:31]
    s_add_u32 s55, s71, 20480
    buffer_load_dwordx4 v[208:211], v124, s[4:7], s55 offen offset:0 sc1
    s_waitcnt lgkmcnt(3)
    v_mfma_f32_16x16x32_bf16 v[40:43], v[112:115], v[168:171], v[40:43]
    ds_read_b128 v[108:111], v2 offset:12544
    v_mfma_f32_16x16x32_bf16 v[44:47], v[112:115], v[172:175], v[44:47]
    buffer_load_dwordx4 v[212:215], v124, s[4:7], s55 offen offset:256 sc1
    v_mfma_f32_16x16x32_bf16 v[56:59], v[116:119], v[168:171], v[56:59]
    ds_read_b128 v[112:115], v2 offset:45312
    v_mfma_f32_16x16x32_bf16 v[60:63], v[116:119], v[172:175], v[60:63]
    s_waitcnt vmcnt(10) lgkmcnt(3)
    v_mfma_f32_16x16x32_bf16 v[16:19], v[96:99], v[176:179], v[16:19]
    ds_read_b128 v[116:119], v3 offset:12544
    s_waitcnt vmcnt(8)
    v_mfma_f32_16x16x32_bf16 v[20:23], v[96:99], v[180:183], v[20:23]
    buffer_load_dwordx4 v[216:219], v124, s[4:7], s55 offen offset:2048 sc1
    v_mfma_f32_16x16x32_bf16 v[32:35], v[100:103], v[176:179], v[32:35]
    ds_read_b128 v[96:99], v2 offset:14336
    v_mfma_f32_16x16x32_bf16 v[36:39], v[100:103], v[180:183], v[36:39]
    s_waitcnt lgkmcnt(3)
    v_mfma_f32_16x16x32_bf16 v[48:51], v[104:107], v[176:179], v[48:51]
    ds_read_b128 v[100:103], v2 offset:47104
    v_mfma_f32_16x16x32_bf16 v[52:55], v[104:107], v[180:183], v[52:55]
    buffer_load_dwordx4 v[220:223], v124, s[4:7], s55 offen offset:2304 sc1
    v_mfma_f32_16x16x32_bf16 v[24:27], v[108:111], v[176:179], v[24:27]
    ds_read_b128 v[104:107], v3 offset:14336
    v_mfma_f32_16x16x32_bf16 v[28:31], v[108:111], v[180:183], v[28:31]
    s_add_u32 s55, s71, 24576
    buffer_load_dwordx4 v[224:227], v124, s[4:7], s55 offen offset:0 sc1
    s_waitcnt lgkmcnt(3)
    v_mfma_f32_16x16x32_bf16 v[40:43], v[112:115], v[176:179], v[40:43]
    ds_read_b128 v[108:111], v2 offset:14592
    v_mfma_f32_16x16x32_bf16 v[44:47], v[112:115], v[180:183], v[44:47]
    buffer_load_dwordx4 v[228:231], v124, s[4:7], s55 offen offset:256 sc1
    v_mfma_f32_16x16x32_bf16 v[56:59], v[116:119], v[176:179], v[56:59]
    ds_read_b128 v[112:115], v2 offset:47360
    v_mfma_f32_16x16x32_bf16 v[60:63], v[116:119], v[180:183], v[60:63]
    s_waitcnt vmcnt(11) lgkmcnt(3)
    v_mfma_f32_16x16x32_bf16 v[16:19], v[96:99], v[184:187], v[16:19]
    ds_read_b128 v[116:119], v3 offset:14592
    s_waitcnt vmcnt(10)
    v_mfma_f32_16x16x32_bf16 v[20:23], v[96:99], v[188:191], v[20:23]
    buffer_load_dwordx4 v[232:235], v124, s[4:7], s55 offen offset:2048 sc1
    v_mfma_f32_16x16x32_bf16 v[32:35], v[100:103], v[184:187], v[32:35]
    ds_read_b128 v[96:99], v2 offset:16384
    v_mfma_f32_16x16x32_bf16 v[36:39], v[100:103], v[188:191], v[36:39]
    s_waitcnt lgkmcnt(3)
    v_mfma_f32_16x16x32_bf16 v[48:51], v[104:107], v[184:187], v[48:51]
    ds_read_b128 v[100:103], v2 offset:49152
    v_mfma_f32_16x16x32_bf16 v[52:55], v[104:107], v[188:191], v[52:55]
    buffer_load_dwordx4 v[236:239], v124, s[4:7], s55 offen offset:2304 sc1
    v_mfma_f32_16x16x32_bf16 v[24:27], v[108:111], v[184:187], v[24:27]
    ds_read_b128 v[104:107], v124 offset:0
    v_mfma_f32_16x16x32_bf16 v[28:31], v[108:111], v[188:191], v[28:31]
    v_add_f32 v64, v64, v72
    s_waitcnt lgkmcnt(3)
    v_mfma_f32_16x16x32_bf16 v[40:43], v[112:115], v[184:187], v[40:43]
    ds_read_b128 v[108:111], v2 offset:16640
    v_mfma_f32_16x16x32_bf16 v[44:47], v[112:115], v[188:191], v[44:47]
    v_add_f32 v65, v65, v73
    v_mfma_f32_16x16x32_bf16 v[56:59], v[116:119], v[184:187], v[56:59]
    ds_read_b128 v[112:115], v2 offset:49408
    v_mfma_f32_16x16x32_bf16 v[60:63], v[116:119], v[188:191], v[60:63]
    v_add_f32 v66, v66, v74
    s_barrier
    s_waitcnt vmcnt(11) lgkmcnt(3)
    v_mfma_f32_16x16x32_bf16 v[16:19], v[96:99], v[192:195], v[16:19]
    ds_read_b128 v[116:119], v124 offset:256
    s_waitcnt vmcnt(10)
    v_mfma_f32_16x16x32_bf16 v[20:23], v[96:99], v[196:199], v[20:23]
    s_add_u32 s55, s71, 28672
    buffer_load_dwordx4 v[240:243], v124, s[4:7], s55 offen offset:0 sc1
    v_add_f32 v67, v67, v75
    v_mfma_f32_16x16x32_bf16 v[32:35], v[100:103], v[192:195], v[32:35]
    ds_read_b128 v[96:99], v2 offset:18432
    v_add_f32 v68, v68, v76
    v_mfma_f32_16x16x32_bf16 v[36:39], v[100:103], v[196:199], v[36:39]
    v_add_f32 v69, v69, v77
    s_waitcnt lgkmcnt(3)
    v_mfma_f32_16x16x32_bf16 v[48:51], v[104:107], v[192:195], v[48:51]
    ds_read_b128 v[100:103], v2 offset:51200
    v_mfma_f32_16x16x32_bf16 v[52:55], v[104:107], v[196:199], v[52:55]
    buffer_load_dwordx4 v[244:247], v124, s[4:7], s55 offen offset:256 sc1
    v_add_f32 v70, v70, v78
    v_mfma_f32_16x16x32_bf16 v[24:27], v[108:111], v[192:195], v[24:27]
    ds_read_b128 v[104:107], v124 offset:2048
    v_mfma_f32_16x16x32_bf16 v[28:31], v[108:111], v[196:199], v[28:31]
    v_add_f32 v71, v71, v79
    s_waitcnt lgkmcnt(3)
    v_mfma_f32_16x16x32_bf16 v[40:43], v[112:115], v[192:195], v[40:43]
    ds_read_b128 v[108:111], v2 offset:18688
    v_mfma_f32_16x16x32_bf16 v[44:47], v[112:115], v[196:199], v[44:47]
    v_add_f32 v64, v64, v68
    v_mfma_f32_16x16x32_bf16 v[56:59], v[116:119], v[192:195], v[56:59]
    ds_read_b128 v[112:115], v2 offset:51456
    v_mfma_f32_16x16x32_bf16 v[60:63], v[116:119], v[196:199], v[60:63]
    v_add_f32 v65, v65, v69
    s_waitcnt vmcnt(11) lgkmcnt(3)
    v_mfma_f32_16x16x32_bf16 v[16:19], v[96:99], v[200:203], v[16:19]
    ds_read_b128 v[116:119], v124 offset:2304
    s_waitcnt vmcnt(10)
    v_mfma_f32_16x16x32_bf16 v[20:23], v[96:99], v[204:207], v[20:23]
    buffer_load_dwordx4 v[248:251], v124, s[4:7], s55 offen offset:2048 sc1
    v_add_f32 v66, v66, v70
    v_mfma_f32_16x16x32_bf16 v[32:35], v[100:103], v[200:203], v[32:35]
    ds_read_b128 v[96:99], v2 offset:20480
    v_mfma_f32_16x16x32_bf16 v[36:39], v[100:103], v[204:207], v[36:39]
    v_add_f32 v67, v67, v71
    s_waitcnt lgkmcnt(3)
    v_mfma_f32_16x16x32_bf16 v[48:51], v[104:107], v[200:203], v[48:51]
    ds_read_b128 v[100:103], v2 offset:53248
    v_mfma_f32_16x16x32_bf16 v[52:55], v[104:107], v[204:207], v[52:55]
    buffer_load_dwordx4 v[252:255], v124, s[4:7], s55 offen offset:2304 sc1
    v_add_f32 v64, v64, v66
    v_mfma_f32_16x16x32_bf16 v[24:27], v[108:111], v[200:203], v[24:27]
    ds_read_b128 v[104:107], v124 offset:4096
    v_mfma_f32_16x16x32_bf16 v[28:31], v[108:111], v[204:207], v[28:31]
    v_add_f32 v65, v65, v67
    s_waitcnt lgkmcnt(3)
    v_mfma_f32_16x16x32_bf16 v[40:43], v[112:115], v[200:203], v[40:43]
    ds_read_b128 v[108:111], v2 offset:20736
    v_mfma_f32_16x16x32_bf16 v[44:47], v[112:115], v[204:207], v[44:47]
    v_add_f32 v64, v64, v65
    v_mov_b32 v65, v64
    v_mfma_f32_16x16x32_bf16 v[56:59], v[116:119], v[200:203], v[56:59]
    ds_read_b128 v[112:115], v2 offset:53504
    v_mfma_f32_16x16x32_bf16 v[60:63], v[116:119], v[204:207], v[60:63]
    v_mov_b32 v66, 0x3b000000
    s_waitcnt vmcnt(11) lgkmcnt(3)
    v_mfma_f32_16x16x32_bf16 v[16:19], v[96:99], v[208:211], v[16:19]
    ds_read_b128 v[116:119], v124 offset:4352
    s_waitcnt vmcnt(10)
    v_mfma_f32_16x16x32_bf16 v[20:23], v[96:99], v[212:215], v[20:23]
    v_permlane32_swap_b32 v64, v65
    v_mfma_f32_16x16x32_bf16 v[32:35], v[100:103], v[208:211], v[32:35]
    ds_read_b128 v[96:99], v2 offset:22528
    v_mfma_f32_16x16x32_bf16 v[36:39], v[100:103], v[212:215], v[36:39]
    v_mul_f32 v64, 0xbb000000, v64
    s_waitcnt lgkmcnt(3)
    v_mfma_f32_16x16x32_bf16 v[48:51], v[104:107], v[208:211], v[48:51]
    ds_read_b128 v[100:103], v2 offset:55296
    v_mfma_f32_16x16x32_bf16 v[52:55], v[104:107], v[212:215], v[52:55]
    v_mul_f32 v67, v64, v64
    v_mfma_f32_16x16x32_bf16 v[24:27], v[108:111], v[208:211], v[24:27]
    ds_read_b128 v[104:107], v124 offset:6144
    v_mfma_f32_16x16x32_bf16 v[28:31], v[108:111], v[212:215], v[28:31]
    v_fma_f32 v13, v65, v66, -v67
    s_waitcnt lgkmcnt(3)
    v_mfma_f32_16x16x32_bf16 v[40:43], v[112:115], v[208:211], v[40:43]
    ds_read_b128 v[108:111], v2 offset:22784
    v_mfma_f32_16x16x32_bf16 v[44:47], v[112:115], v[212:215], v[44:47]
    v_cvt_pk_bf16_f32 v67, v64, v64
    v_mfma_f32_16x16x32_bf16 v[56:59], v[116:119], v[208:211], v[56:59]
    ds_read_b128 v[112:115], v2 offset:55552
    v_mfma_f32_16x16x32_bf16 v[60:63], v[116:119], v[212:215], v[60:63]
    v_max_f32 v13, 0, v13
    s_waitcnt vmcnt(9) lgkmcnt(3)
    v_mfma_f32_16x16x32_bf16 v[16:19], v[96:99], v[216:219], v[16:19]
    ds_read_b128 v[116:119], v124 offset:6400
    s_waitcnt vmcnt(8)
    v_mfma_f32_16x16x32_bf16 v[20:23], v[96:99], v[220:223], v[20:23]
    v_and_b32 v67, 0xffff0000, v67
    v_add_f32 v13, 0x3727c5ac, v13
    v_mfma_f32_16x16x32_bf16 v[32:35], v[100:103], v[216:219], v[32:35]
    ds_read_b128 v[96:99], v2 offset:24576
    v_mfma_f32_16x16x32_bf16 v[36:39], v[100:103], v[220:223], v[36:39]
    v_sub_f32 v67, v64, v67
    s_waitcnt lgkmcnt(3)
    v_mfma_f32_16x16x32_bf16 v[48:51], v[104:107], v[216:219], v[48:51]
    ds_read_b128 v[100:103], v2 offset:57344
    v_mfma_f32_16x16x32_bf16 v[52:55], v[104:107], v[220:223], v[52:55]
    v_mfma_f32_16x16x32_bf16 v[24:27], v[108:111], v[216:219], v[24:27]
    ds_read_b128 v[104:107], v124 offset:8192
    v_mfma_f32_16x16x32_bf16 v[28:31], v[108:111], v[220:223], v[28:31]
    v_rsq_f32 v12, v13
    s_waitcnt lgkmcnt(3)
    v_mfma_f32_16x16x32_bf16 v[40:43], v[112:115], v[216:219], v[40:43]
    ds_read_b128 v[108:111], v2 offset:24832
    v_mfma_f32_16x16x32_bf16 v[44:47], v[112:115], v[220:223], v[44:47]
    v_cvt_pk_bf16_f32 v4, v64, v67
    v_mfma_f32_16x16x32_bf16 v[56:59], v[116:119], v[216:219], v[56:59]
    ds_read_b128 v[112:115], v2 offset:57600
    v_mfma_f32_16x16x32_bf16 v[60:63], v[116:119], v[220:223], v[60:63]
    v_cvt_pk_bf16_f32 v5, v64, v67
    s_waitcnt vmcnt(7) lgkmcnt(3)
    v_mfma_f32_16x16x32_bf16 v[16:19], v[96:99], v[224:227], v[16:19]
    ds_read_b128 v[116:119], v124 offset:8448
    s_waitcnt vmcnt(6)
    v_mfma_f32_16x16x32_bf16 v[20:23], v[96:99], v[228:231], v[20:23]
    v_cvt_pk_bf16_f32 v6, v64, v67
    v_mfma_f32_16x16x32_bf16 v[32:35], v[100:103], v[224:227], v[32:35]
    ds_read_b128 v[96:99], v2 offset:26624
    v_mfma_f32_16x16x32_bf16 v[36:39], v[100:103], v[228:231], v[36:39]
    v_cvt_pk_bf16_f32 v7, v64, v67
    s_waitcnt lgkmcnt(3)
    v_mfma_f32_16x16x32_bf16 v[48:51], v[104:107], v[224:227], v[48:51]
    ds_read_b128 v[100:103], v2 offset:59392
    v_mfma_f32_16x16x32_bf16 v[52:55], v[104:107], v[228:231], v[52:55]
    v_mul_f32 v12, 0xbfb8aa3b, v12
    v_mfma_f32_16x16x32_bf16 v[24:27], v[108:111], v[224:227], v[24:27]
    ds_read_b128 v[104:107], v124 offset:10240
    v_mov_b32 v127, v13
    v_mfma_f32_16x16x32_bf16 v[28:31], v[108:111], v[228:231], v[28:31]
    v_mov_b32 v126, v12
    s_waitcnt lgkmcnt(3)
    v_mfma_f32_16x16x32_bf16 v[40:43], v[112:115], v[224:227], v[40:43]
    ds_read_b128 v[108:111], v2 offset:26880
    v_mfma_f32_16x16x32_bf16 v[44:47], v[112:115], v[228:231], v[44:47]
    v_permlane16_swap_b32 v4, v6
    v_mfma_f32_16x16x32_bf16 v[56:59], v[116:119], v[224:227], v[56:59]
    ds_read_b128 v[112:115], v2 offset:59648
    v_mfma_f32_16x16x32_bf16 v[60:63], v[116:119], v[228:231], v[60:63]
    v_permlane16_swap_b32 v5, v7
    s_waitcnt vmcnt(5) lgkmcnt(3)
    v_mfma_f32_16x16x32_bf16 v[16:19], v[96:99], v[232:235], v[16:19]
    ds_read_b128 v[116:119], v124 offset:10496
    s_waitcnt vmcnt(4)
    v_mfma_f32_16x16x32_bf16 v[20:23], v[96:99], v[236:239], v[20:23]
    v_permlane16_swap_b32 v13, v127
    v_mfma_f32_16x16x32_bf16 v[32:35], v[100:103], v[232:235], v[32:35]
    ds_read_b128 v[96:99], v2 offset:28672
    v_mfma_f32_16x16x32_bf16 v[36:39], v[100:103], v[236:239], v[36:39]
    v_permlane16_swap_b32 v12, v126
    s_waitcnt lgkmcnt(3)
    v_mfma_f32_16x16x32_bf16 v[48:51], v[104:107], v[232:235], v[48:51]
    ds_read_b128 v[100:103], v2 offset:61440
    v_mfma_f32_16x16x32_bf16 v[52:55], v[104:107], v[236:239], v[52:55]
    v_mfma_f32_16x16x32_bf16 v[24:27], v[108:111], v[232:235], v[24:27]
    ds_read_b128 v[104:107], v124 offset:12288
    v_mfma_f32_16x16x32_bf16 v[28:31], v[108:111], v[236:239], v[28:31]
    s_waitcnt lgkmcnt(3)
    v_mfma_f32_16x16x32_bf16 v[40:43], v[112:115], v[232:235], v[40:43]
    ds_read_b128 v[108:111], v2 offset:28928
    v_mfma_f32_16x16x32_bf16 v[44:47], v[112:115], v[236:239], v[44:47]
    v_mfma_f32_16x16x32_bf16 v[56:59], v[116:119], v[232:235], v[56:59]
    ds_read_b128 v[112:115], v2 offset:61696
    v_mfma_f32_16x16x32_bf16 v[60:63], v[116:119], v[236:239], v[60:63]
    v_mfma_f32_16x16x16_bf16 v[16:19], v[80:81], v[4:5], v[16:19]
    v_mfma_f32_16x16x16_bf16 v[20:23], v[80:81], v[6:7], v[20:23]
    v_mfma_f32_16x16x16_bf16 v[24:27], v[82:83], v[4:5], v[24:27]
    v_mfma_f32_16x16x16_bf16 v[28:31], v[82:83], v[6:7], v[28:31]
    v_mfma_f32_16x16x16_bf16 v[32:35], v[84:85], v[4:5], v[32:35]
    v_mfma_f32_16x16x16_bf16 v[36:39], v[84:85], v[6:7], v[36:39]
    v_mfma_f32_16x16x16_bf16 v[40:43], v[86:87], v[4:5], v[40:43]
    v_mfma_f32_16x16x16_bf16 v[44:47], v[86:87], v[6:7], v[44:47]
    v_mfma_f32_16x16x16_bf16 v[48:51], v[88:89], v[4:5], v[48:51]
    v_mfma_f32_16x16x16_bf16 v[52:55], v[88:89], v[6:7], v[52:55]
    v_mfma_f32_16x16x16_bf16 v[56:59], v[90:91], v[4:5], v[56:59]
    v_mfma_f32_16x16x16_bf16 v[60:63], v[90:91], v[6:7], v[60:63]
    s_waitcnt vmcnt(3) lgkmcnt(3)
    v_mfma_f32_16x16x32_bf16 v[16:19], v[96:99], v[240:243], v[16:19]
    ds_read_b128 v[116:119], v124 offset:12544
    s_waitcnt vmcnt(2)
    v_mfma_f32_16x16x32_bf16 v[20:23], v[96:99], v[244:247], v[20:23]
    v_mfma_f32_16x16x32_bf16 v[32:35], v[100:103], v[240:243], v[32:35]
    ds_read_b128 v[96:99], v2 offset:30720
    v_mfma_f32_16x16x32_bf16 v[36:39], v[100:103], v[244:247], v[36:39]
    s_waitcnt lgkmcnt(3)
    v_mfma_f32_16x16x32_bf16 v[48:51], v[104:107], v[240:243], v[48:51]
    ds_read_b128 v[100:103], v2 offset:63488
    v_mfma_f32_16x16x32_bf16 v[52:55], v[104:107], v[244:247], v[52:55]
    v_mfma_f32_16x16x32_bf16 v[24:27], v[108:111], v[240:243], v[24:27]
    ds_read_b128 v[104:107], v124 offset:14336
    v_mfma_f32_16x16x32_bf16 v[28:31], v[108:111], v[244:247], v[28:31]
    s_waitcnt lgkmcnt(3)
    v_mfma_f32_16x16x32_bf16 v[40:43], v[112:115], v[240:243], v[40:43]
    ds_read_b128 v[108:111], v2 offset:30976
    v_mfma_f32_16x16x32_bf16 v[44:47], v[112:115], v[244:247], v[44:47]
    v_mfma_f32_16x16x32_bf16 v[56:59], v[116:119], v[240:243], v[56:59]
    ds_read_b128 v[112:115], v2 offset:63744
    v_mfma_f32_16x16x32_bf16 v[60:63], v[116:119], v[244:247], v[60:63]
    s_waitcnt vmcnt(1) lgkmcnt(3)
    v_mfma_f32_16x16x32_bf16 v[16:19], v[96:99], v[248:251], v[16:19]
    ds_read_b128 v[116:119], v124 offset:14592
    s_waitcnt vmcnt(0)
    v_mfma_f32_16x16x32_bf16 v[20:23], v[96:99], v[252:255], v[20:23]
    v_mfma_f32_16x16x32_bf16 v[32:35], v[100:103], v[248:251], v[32:35]
    ds_read_b128 v[96:99], v124 offset:16384
    v_mfma_f32_16x16x32_bf16 v[36:39], v[100:103], v[252:255], v[36:39]
    s_waitcnt lgkmcnt(3)
    v_mfma_f32_16x16x32_bf16 v[48:51], v[104:107], v[248:251], v[48:51]
    ds_read_b128 v[100:103], v124 offset:49152
    v_mfma_f32_16x16x32_bf16 v[52:55], v[104:107], v[252:255], v[52:55]
    v_mfma_f32_16x16x32_bf16 v[24:27], v[108:111], v[248:251], v[24:27]
    ds_read_b128 v[104:107], v124 offset:16640
    v_mfma_f32_16x16x32_bf16 v[28:31], v[108:111], v[252:255], v[28:31]
    s_waitcnt lgkmcnt(3)
    v_mfma_f32_16x16x32_bf16 v[40:43], v[112:115], v[248:251], v[40:43]
    ds_read_b128 v[108:111], v124 offset:49408
    v_mfma_f32_16x16x32_bf16 v[44:47], v[112:115], v[252:255], v[44:47]
    v_mfma_f32_16x16x32_bf16 v[56:59], v[116:119], v[248:251], v[56:59]
    ds_read_b128 v[112:115], v124 offset:18432
    v_mfma_f32_16x16x32_bf16 v[60:63], v[116:119], v[252:255], v[60:63]
    v_mfma_f32_16x16x16_bf16 v[80:83], v[120:121], v[4:5], 0
    v_mfma_f32_16x16x16_bf16 v[84:87], v[120:121], v[6:7], 0
    v_mfma_f32_16x16x16_bf16 v[88:91], v[122:123], v[4:5], 0
    v_mfma_f32_16x16x16_bf16 v[92:95], v[122:123], v[6:7], 0
    v_mfma_f32_16x16x16_bf16 v[64:67], v[8:9], v[4:5], 0
    v_mul_f32 v120, v12, v16
    v_exp_f32 v120, v120
    v_mfma_f32_16x16x16_bf16 v[68:71], v[8:9], v[6:7], 0
    v_mul_f32 v24, v16, v24
    v_mul_f32 v121, v12, v17
    v_mfma_f32_16x16x16_bf16 v[72:75], v[10:11], v[4:5], 0
    v_exp_f32 v121, v121
    v_mul_f32 v25, v17, v25
    v_mfma_f32_16x16x16_bf16 v[76:79], v[10:11], v[6:7], 0
    v_mul_f32 v122, v12, v18
    v_exp_f32 v122, v122
    v_mul_f32 v26, v18, v26
    v_mul_f32 v123, v12, v19
    s_barrier
    s_waitcnt lgkmcnt(3)
    v_mfma_f32_16x16x32_bf16 v[64:67], v[96:99], v[128:131], v[64:67]
    ds_read_b128 v[116:119], v124 offset:51200
    v_exp_f32 v123, v123
    v_mfma_f32_16x16x32_bf16 v[68:71], v[96:99], v[132:135], v[68:71]
    v_mul_f32 v27, v19, v27
    v_and_b32 v14, 7, v0
    s_lshr_b32 s50, s41, 4
    s_lshl_b32 s50, s50, 6
    s_lshl_b32 s57, s75, 5
    s_add_u32 s50, s50, s57
    s_add_u32 s50, s50, 512
    v_lshl_add_u32 v14, v14, 2, s50
    v_mfma_f32_16x16x32_bf16 v[80:83], v[100:103], v[128:131], v[80:83]
    ds_read_b128 v[96:99], v124 offset:18688
    s_add_u32 s54, s73, 4096
    buffer_load_dwordx4 v[8:11], v1, s[4:7], s54 offen offset:1024 sc1
    v_mfma_f32_16x16x32_bf16 v[84:87], v[100:103], v[132:135], v[84:87]
    v_fma_f32 v120, v120, v13, v13
    v_rcp_f32 v120, v120
    s_waitcnt lgkmcnt(3)
    v_mfma_f32_16x16x32_bf16 v[72:75], v[104:107], v[128:131], v[72:75]
    ds_read_b128 v[100:103], v124 offset:51456
    v_fma_f32 v121, v121, v13, v13
    v_mfma_f32_16x16x32_bf16 v[76:79], v[104:107], v[132:135], v[76:79]
    v_rcp_f32 v121, v121
    v_mfma_f32_16x16x32_bf16 v[88:91], v[108:111], v[128:131], v[88:91]
    ds_read_b128 v[104:107], v124 offset:20480
    v_mul_f32 v24, v120, v24
    v_mfma_f32_16x16x32_bf16 v[92:95], v[108:111], v[132:135], v[92:95]
    v_fma_f32 v122, v122, v13, v13
    s_waitcnt lgkmcnt(3)
    v_mfma_f32_16x16x32_bf16 v[64:67], v[112:115], v[136:139], v[64:67]
    ds_read_b128 v[108:111], v124 offset:53248
    v_mfma_f32_16x16x32_bf16 v[68:71], v[112:115], v[140:143], v[68:71]
    v_rcp_f32 v122, v122
    v_mul_f32 v25, v121, v25
    v_mfma_f32_16x16x32_bf16 v[80:83], v[116:119], v[136:139], v[80:83]
    ds_read_b128 v[112:115], v124 offset:20736
    v_fma_f32 v123, v123, v13, v13
    v_mfma_f32_16x16x32_bf16 v[84:87], v[116:119], v[140:143], v[84:87]
    v_rcp_f32 v123, v123
    s_waitcnt lgkmcnt(3)
    v_mfma_f32_16x16x32_bf16 v[72:75], v[96:99], v[136:139], v[72:75]
    ds_read_b128 v[116:119], v124 offset:53504
    v_mul_f32 v26, v122, v26
    v_mfma_f32_16x16x32_bf16 v[76:79], v[96:99], v[140:143], v[76:79]
    v_cvt_pk_bf16_f32 v16, v24, v25
    v_mul_f32 v27, v123, v27
    v_mfma_f32_16x16x32_bf16 v[88:91], v[100:103], v[136:139], v[88:91]
    ds_read_b128 v[96:99], v124 offset:22528
    v_cvt_pk_bf16_f32 v17, v26, v27
    v_mfma_f32_16x16x32_bf16 v[92:95], v[100:103], v[140:143], v[92:95]
    v_mul_f32 v120, v126, v20
    s_waitcnt lgkmcnt(3)
    v_mfma_f32_16x16x32_bf16 v[64:67], v[104:107], v[144:147], v[64:67]
    ds_read_b128 v[100:103], v124 offset:55296
    v_mfma_f32_16x16x32_bf16 v[68:71], v[104:107], v[148:151], v[68:71]
    v_exp_f32 v120, v120
    v_mul_f32 v28, v20, v28
    v_mfma_f32_16x16x32_bf16 v[80:83], v[108:111], v[144:147], v[80:83]
    ds_read_b128 v[104:107], v124 offset:22784
    v_mul_f32 v121, v126, v21
    v_mfma_f32_16x16x32_bf16 v[84:87], v[108:111], v[148:151], v[84:87]
    v_exp_f32 v121, v121
    s_waitcnt lgkmcnt(3)
    v_mfma_f32_16x16x32_bf16 v[72:75], v[112:115], v[144:147], v[72:75]
    ds_read_b128 v[108:111], v124 offset:55552
    v_mul_f32 v29, v21, v29
    v_mfma_f32_16x16x32_bf16 v[76:79], v[112:115], v[148:151], v[76:79]
    v_mul_f32 v122, v126, v22
    v_exp_f32 v122, v122
    v_mfma_f32_16x16x32_bf16 v[88:91], v[116:119], v[144:147], v[88:91]
    ds_read_b128 v[112:115], v124 offset:24576
    v_mul_f32 v30, v22, v30
    v_mfma_f32_16x16x32_bf16 v[92:95], v[116:119], v[148:151], v[92:95]
    v_mul_f32 v123, v126, v23
    s_waitcnt lgkmcnt(3)
    v_mfma_f32_16x16x32_bf16 v[64:67], v[96:99], v[152:155], v[64:67]
    ds_read_b128 v[116:119], v124 offset:57344
    v_mfma_f32_16x16x32_bf16 v[68:71], v[96:99], v[156:159], v[68:71]
    v_exp_f32 v123, v123
    v_mul_f32 v31, v23, v31
    v_mfma_f32_16x16x32_bf16 v[80:83], v[100:103], v[152:155], v[80:83]
    ds_read_b128 v[96:99], v124 offset:24832
    v_fma_f32 v120, v120, v127, v127
    v_mfma_f32_16x16x32_bf16 v[84:87], v[100:103], v[156:159], v[84:87]
    v_rcp_f32 v120, v120
    s_waitcnt lgkmcnt(3)
    v_mfma_f32_16x16x32_bf16 v[72:75], v[104:107], v[152:155], v[72:75]
    ds_read_b128 v[100:103], v124 offset:57600
    v_fma_f32 v121, v121, v127, v127
    v_mfma_f32_16x16x32_bf16 v[76:79], v[104:107], v[156:159], v[76:79]
    v_rcp_f32 v121, v121
    v_mfma_f32_16x16x32_bf16 v[88:91], v[108:111], v[152:155], v[88:91]
    ds_read_b128 v[104:107], v124 offset:26624
    v_mul_f32 v28, v120, v28
    v_mfma_f32_16x16x32_bf16 v[92:95], v[108:111], v[156:159], v[92:95]
    v_fma_f32 v122, v122, v127, v127
    s_waitcnt lgkmcnt(3)
    v_mfma_f32_16x16x32_bf16 v[64:67], v[112:115], v[160:163], v[64:67]
    ds_read_b128 v[108:111], v124 offset:59392
    v_mfma_f32_16x16x32_bf16 v[68:71], v[112:115], v[164:167], v[68:71]
    v_rcp_f32 v122, v122
    v_mul_f32 v29, v121, v29
    v_mfma_f32_16x16x32_bf16 v[80:83], v[116:119], v[160:163], v[80:83]
    ds_read_b128 v[112:115], v124 offset:26880
    v_fma_f32 v123, v123, v127, v127
    v_mfma_f32_16x16x32_bf16 v[84:87], v[116:119], v[164:167], v[84:87]
    v_rcp_f32 v123, v123
    s_waitcnt lgkmcnt(3)
    v_mfma_f32_16x16x32_bf16 v[72:75], v[96:99], v[160:163], v[72:75]
    ds_read_b128 v[116:119], v124 offset:59648
    v_mul_f32 v30, v122, v30
    v_mfma_f32_16x16x32_bf16 v[76:79], v[96:99], v[164:167], v[76:79]
    v_cvt_pk_bf16_f32 v18, v28, v29
    v_mul_f32 v31, v123, v31
    v_mfma_f32_16x16x32_bf16 v[88:91], v[100:103], v[160:163], v[88:91]
    ds_read_b128 v[96:99], v124 offset:28672
    v_cvt_pk_bf16_f32 v19, v30, v31
    v_mfma_f32_16x16x32_bf16 v[92:95], v[100:103], v[164:167], v[92:95]
    s_add_u32 s53, s74, 0
    v_permlane32_swap_b32 v16, v18
    s_waitcnt lgkmcnt(3)
    v_mfma_f32_16x16x32_bf16 v[64:67], v[104:107], v[168:171], v[64:67]
    ds_read_b128 v[100:103], v124 offset:61440
    v_permlane32_swap_b32 v17, v19
    v_mfma_f32_16x16x32_bf16 v[68:71], v[104:107], v[172:175], v[68:71]
    buffer_store_dwordx4 v[16:19], v125, s[4:7], s53 offen
    v_mul_f32 v120, v12, v32
    v_mfma_f32_16x16x32_bf16 v[80:83], v[108:111], v[168:171], v[80:83]
    ds_read_b128 v[104:107], v124 offset:28928
    v_exp_f32 v120, v120
    v_mfma_f32_16x16x32_bf16 v[84:87], v[108:111], v[172:175], v[84:87]
    v_mul_f32 v40, v32, v40
    s_waitcnt lgkmcnt(3)
    v_mfma_f32_16x16x32_bf16 v[72:75], v[112:115], v[168:171], v[72:75]
    ds_read_b128 v[108:111], v124 offset:61696
    v_mul_f32 v121, v12, v33
    v_mfma_f32_16x16x32_bf16 v[76:79], v[112:115], v[172:175], v[76:79]
    v_exp_f32 v121, v121
    v_mfma_f32_16x16x32_bf16 v[88:91], v[116:119], v[168:171], v[88:91]
    ds_read_b128 v[112:115], v124 offset:30720
    v_mul_f32 v41, v33, v41
    v_mfma_f32_16x16x32_bf16 v[92:95], v[116:119], v[172:175], v[92:95]
    v_mul_f32 v122, v12, v34
    s_waitcnt lgkmcnt(3)
    v_mfma_f32_16x16x32_bf16 v[64:67], v[96:99], v[176:179], v[64:67]
    ds_read_b128 v[116:119], v124 offset:63488
    v_exp_f32 v122, v122
    v_mfma_f32_16x16x32_bf16 v[68:71], v[96:99], v[180:183], v[68:71]
    v_mul_f32 v42, v34, v42
    v_mul_f32 v123, v12, v35
    v_mfma_f32_16x16x32_bf16 v[80:83], v[100:103], v[176:179], v[80:83]
    ds_read_b128 v[96:99], v124 offset:30976
    v_exp_f32 v123, v123
    v_mfma_f32_16x16x32_bf16 v[84:87], v[100:103], v[180:183], v[84:87]
    v_mul_f32 v43, v35, v43
    s_waitcnt lgkmcnt(3)
    v_mfma_f32_16x16x32_bf16 v[72:75], v[104:107], v[176:179], v[72:75]
    ds_read_b128 v[100:103], v124 offset:63744
    v_fma_f32 v120, v120, v13, v13
    v_mfma_f32_16x16x32_bf16 v[76:79], v[104:107], v[180:183], v[76:79]
    v_rcp_f32 v120, v120
    v_mfma_f32_16x16x32_bf16 v[88:91], v[108:111], v[176:179], v[88:91]
    ds_read_b128 v[104:107], v124 offset:32768
    v_fma_f32 v121, v121, v13, v13
    v_mfma_f32_16x16x32_bf16 v[92:95], v[108:111], v[180:183], v[92:95]
    v_rcp_f32 v121, v121
    s_waitcnt lgkmcnt(3)
    v_mfma_f32_16x16x32_bf16 v[64:67], v[112:115], v[184:187], v[64:67]
    ds_read_b128 v[108:111], v3 offset:16384
    v_mfma_f32_16x16x32_bf16 v[68:71], v[112:115], v[188:191], v[68:71]
    v_mul_f32 v40, v120, v40
    v_fma_f32 v122, v122, v13, v13
    v_mfma_f32_16x16x32_bf16 v[80:83], v[116:119], v[184:187], v[80:83]
    ds_read_b128 v[112:115], v124 offset:33024
    v_rcp_f32 v122, v122
    v_mfma_f32_16x16x32_bf16 v[84:87], v[116:119], v[188:191], v[84:87]
    v_mul_f32 v41, v121, v41
    s_waitcnt lgkmcnt(3)
    v_mfma_f32_16x16x32_bf16 v[72:75], v[96:99], v[184:187], v[72:75]
    ds_read_b128 v[116:119], v3 offset:16640
    v_fma_f32 v123, v123, v13, v13
    v_mfma_f32_16x16x32_bf16 v[76:79], v[96:99], v[188:191], v[76:79]
    v_rcp_f32 v123, v123
    v_mfma_f32_16x16x32_bf16 v[88:91], v[100:103], v[184:187], v[88:91]
    ds_read_b128 v[96:99], v124 offset:34816
    v_mul_f32 v42, v122, v42
    v_mfma_f32_16x16x32_bf16 v[92:95], v[100:103], v[188:191], v[92:95]
    v_cvt_pk_bf16_f32 v32, v40, v41
    v_mul_f32 v43, v123, v43
    s_barrier
    s_waitcnt lgkmcnt(3)
    v_mfma_f32_16x16x32_bf16 v[64:67], v[104:107], v[192:195], v[64:67]
    ds_read_b128 v[100:103], v3 offset:18432
    v_mfma_f32_16x16x32_bf16 v[68:71], v[104:107], v[196:199], v[68:71]
    v_cvt_pk_bf16_f32 v33, v42, v43
    v_mul_f32 v120, v126, v36
    v_mfma_f32_16x16x32_bf16 v[80:83], v[108:111], v[192:195], v[80:83]
    ds_read_b128 v[104:107], v124 offset:35072
    v_exp_f32 v120, v120
    v_mfma_f32_16x16x32_bf16 v[84:87], v[108:111], v[196:199], v[84:87]
    v_mul_f32 v44, v36, v44
    s_waitcnt lgkmcnt(3)
    v_mfma_f32_16x16x32_bf16 v[72:75], v[112:115], v[192:195], v[72:75]
    ds_read_b128 v[108:111], v3 offset:18688
    v_mul_f32 v121, v126, v37
    v_mfma_f32_16x16x32_bf16 v[76:79], v[112:115], v[196:199], v[76:79]
    v_exp_f32 v121, v121
    v_mfma_f32_16x16x32_bf16 v[88:91], v[116:119], v[192:195], v[88:91]
    ds_read_b128 v[112:115], v124 offset:36864
    v_mul_f32 v45, v37, v45
    v_mfma_f32_16x16x32_bf16 v[92:95], v[116:119], v[196:199], v[92:95]
    v_mul_f32 v122, v126, v38
    v_exp_f32 v122, v122
    s_waitcnt lgkmcnt(3)
    v_mfma_f32_16x16x32_bf16 v[64:67], v[96:99], v[200:203], v[64:67]
    ds_read_b128 v[116:119], v3 offset:20480
    v_mfma_f32_16x16x32_bf16 v[68:71], v[96:99], v[204:207], v[68:71]
    v_mul_f32 v46, v38, v46
    v_mul_f32 v123, v126, v39
    v_mfma_f32_16x16x32_bf16 v[80:83], v[100:103], v[200:203], v[80:83]
    ds_read_b128 v[96:99], v124 offset:37120
    v_exp_f32 v123, v123
    v_mfma_f32_16x16x32_bf16 v[84:87], v[100:103], v[204:207], v[84:87]
    v_mul_f32 v47, v39, v47
    s_waitcnt lgkmcnt(3)
    v_mfma_f32_16x16x32_bf16 v[72:75], v[104:107], v[200:203], v[72:75]
    ds_read_b128 v[100:103], v3 offset:20736
    v_fma_f32 v120, v120, v127, v127
    v_mfma_f32_16x16x32_bf16 v[76:79], v[104:107], v[204:207], v[76:79]
    v_rcp_f32 v120, v120
    v_mfma_f32_16x16x32_bf16 v[88:91], v[108:111], v[200:203], v[88:91]
    ds_read_b128 v[104:107], v124 offset:38912
    v_fma_f32 v121, v121, v127, v127
    v_mfma_f32_16x16x32_bf16 v[92:95], v[108:111], v[204:207], v[92:95]
    v_rcp_f32 v121, v121
    s_waitcnt lgkmcnt(3)
    v_mfma_f32_16x16x32_bf16 v[64:67], v[112:115], v[208:211], v[64:67]
    ds_read_b128 v[108:111], v3 offset:22528
    v_mfma_f32_16x16x32_bf16 v[68:71], v[112:115], v[212:215], v[68:71]
    v_mul_f32 v44, v120, v44
    v_fma_f32 v122, v122, v127, v127
    v_mfma_f32_16x16x32_bf16 v[80:83], v[116:119], v[208:211], v[80:83]
    ds_read_b128 v[112:115], v124 offset:39168
    v_rcp_f32 v122, v122
    v_mfma_f32_16x16x32_bf16 v[84:87], v[116:119], v[212:215], v[84:87]
    v_mul_f32 v45, v121, v45
    s_waitcnt lgkmcnt(3)
    v_mfma_f32_16x16x32_bf16 v[72:75], v[96:99], v[208:211], v[72:75]
    ds_read_b128 v[116:119], v3 offset:22784
    v_fma_f32 v123, v123, v127, v127
    v_mfma_f32_16x16x32_bf16 v[76:79], v[96:99], v[212:215], v[76:79]
    v_rcp_f32 v123, v123
    v_mfma_f32_16x16x32_bf16 v[88:91], v[100:103], v[208:211], v[88:91]
    ds_read_b128 v[96:99], v124 offset:40960
    v_mul_f32 v46, v122, v46
    v_mfma_f32_16x16x32_bf16 v[92:95], v[100:103], v[212:215], v[92:95]
    v_cvt_pk_bf16_f32 v34, v44, v45
    v_mul_f32 v47, v123, v47
    s_waitcnt lgkmcnt(3)
    v_mfma_f32_16x16x32_bf16 v[64:67], v[104:107], v[216:219], v[64:67]
    ds_read_b128 v[100:103], v3 offset:24576
    v_cvt_pk_bf16_f32 v35, v46, v47
    v_mfma_f32_16x16x32_bf16 v[68:71], v[104:107], v[220:223], v[68:71]
    s_add_u32 s53, s74, 16384
    v_permlane32_swap_b32 v32, v34
    v_mfma_f32_16x16x32_bf16 v[80:83], v[108:111], v[216:219], v[80:83]
    ds_read_b128 v[104:107], v124 offset:41216
    v_permlane32_swap_b32 v33, v35
    v_mfma_f32_16x16x32_bf16 v[84:87], v[108:111], v[220:223], v[84:87]
    buffer_store_dwordx4 v[32:35], v125, s[4:7], s53 offen
    v_mul_f32 v120, v12, v48
    s_waitcnt lgkmcnt(3)
    v_mfma_f32_16x16x32_bf16 v[72:75], v[112:115], v[216:219], v[72:75]
    ds_read_b128 v[108:111], v3 offset:24832
    v_mfma_f32_16x16x32_bf16 v[76:79], v[112:115], v[220:223], v[76:79]
    v_exp_f32 v120, v120
    v_mul_f32 v56, v48, v56
    v_mfma_f32_16x16x32_bf16 v[88:91], v[116:119], v[216:219], v[88:91]
    ds_read_b128 v[112:115], v124 offset:43008
    v_mul_f32 v121, v12, v49
    v_mfma_f32_16x16x32_bf16 v[92:95], v[116:119], v[220:223], v[92:95]
    v_exp_f32 v121, v121
    s_waitcnt lgkmcnt(3)
    v_mfma_f32_16x16x32_bf16 v[64:67], v[96:99], v[224:227], v[64:67]
    ds_read_b128 v[116:119], v3 offset:26624
    v_mfma_f32_16x16x32_bf16 v[68:71], v[96:99], v[228:231], v[68:71]
    v_mul_f32 v57, v49, v57
    v_mul_f32 v122, v12, v50
    v_mfma_f32_16x16x32_bf16 v[80:83], v[100:103], v[224:227], v[80:83]
    ds_read_b128 v[96:99], v124 offset:43264
    v_exp_f32 v122, v122
    v_mfma_f32_16x16x32_bf16 v[84:87], v[100:103], v[228:231], v[84:87]
    v_mul_f32 v58, v50, v58
    v_mul_f32 v123, v12, v51
    s_waitcnt lgkmcnt(3)
    v_mfma_f32_16x16x32_bf16 v[72:75], v[104:107], v[224:227], v[72:75]
    ds_read_b128 v[100:103], v3 offset:26880
    v_mfma_f32_16x16x32_bf16 v[76:79], v[104:107], v[228:231], v[76:79]
    v_exp_f32 v123, v123
    v_mul_f32 v59, v51, v59
    v_mfma_f32_16x16x32_bf16 v[88:91], v[108:111], v[224:227], v[88:91]
    ds_read_b128 v[104:107], v124 offset:45056
    v_fma_f32 v120, v120, v13, v13
    v_mfma_f32_16x16x32_bf16 v[92:95], v[108:111], v[228:231], v[92:95]
    v_rcp_f32 v120, v120
    s_waitcnt lgkmcnt(3)
    v_mfma_f32_16x16x32_bf16 v[64:67], v[112:115], v[232:235], v[64:67]
    ds_read_b128 v[108:111], v3 offset:28672
    v_fma_f32 v121, v121, v13, v13
    v_mfma_f32_16x16x32_bf16 v[68:71], v[112:115], v[236:239], v[68:71]
    v_rcp_f32 v121, v121
    v_mfma_f32_16x16x32_bf16 v[80:83], v[116:119], v[232:235], v[80:83]
    ds_read_b128 v[112:115], v124 offset:45312
    v_mul_f32 v56, v120, v56
    v_mfma_f32_16x16x32_bf16 v[84:87], v[116:119], v[236:239], v[84:87]
    v_fma_f32 v122, v122, v13, v13
    s_waitcnt lgkmcnt(3)
    v_mfma_f32_16x16x32_bf16 v[72:75], v[96:99], v[232:235], v[72:75]
    ds_read_b128 v[116:119], v3 offset:28928
    v_mfma_f32_16x16x32_bf16 v[76:79], v[96:99], v[236:239], v[76:79]
    v_rcp_f32 v122, v122
    v_mul_f32 v57, v121, v57
    v_mfma_f32_16x16x32_bf16 v[88:91], v[100:103], v[232:235], v[88:91]
    ds_read_b128 v[96:99], v124 offset:47104
    v_fma_f32 v123, v123, v13, v13
    v_mfma_f32_16x16x32_bf16 v[92:95], v[100:103], v[236:239], v[92:95]
    v_rcp_f32 v123, v123
    s_waitcnt lgkmcnt(3)
    v_mfma_f32_16x16x32_bf16 v[64:67], v[104:107], v[240:243], v[64:67]
    ds_read_b128 v[100:103], v3 offset:30720
    v_mul_f32 v58, v122, v58
    v_mfma_f32_16x16x32_bf16 v[68:71], v[104:107], v[244:247], v[68:71]
    v_cvt_pk_bf16_f32 v48, v56, v57
    v_mul_f32 v59, v123, v59
    v_mfma_f32_16x16x32_bf16 v[80:83], v[108:111], v[240:243], v[80:83]
    ds_read_b128 v[104:107], v124 offset:47360
    v_cvt_pk_bf16_f32 v49, v58, v59
    v_mfma_f32_16x16x32_bf16 v[84:87], v[108:111], v[244:247], v[84:87]
    v_mul_f32 v120, v126, v52
    s_waitcnt lgkmcnt(3)
    v_mfma_f32_16x16x32_bf16 v[72:75], v[112:115], v[240:243], v[72:75]
    ds_read_b128 v[108:111], v3 offset:30976
    v_mfma_f32_16x16x32_bf16 v[76:79], v[112:115], v[244:247], v[76:79]
    v_exp_f32 v120, v120
    v_mul_f32 v60, v52, v60
    v_mfma_f32_16x16x32_bf16 v[88:91], v[116:119], v[240:243], v[88:91]
    ds_read_b128 v[112:115], v2 offset:0
    v_mul_f32 v121, v126, v53
    v_mfma_f32_16x16x32_bf16 v[92:95], v[116:119], v[244:247], v[92:95]
    v_exp_f32 v121, v121
    s_waitcnt lgkmcnt(3)
    v_mfma_f32_16x16x32_bf16 v[64:67], v[96:99], v[248:251], v[64:67]
    ds_read_b128 v[116:119], v2 offset:256
    v_mul_f32 v61, v53, v61
    v_mfma_f32_16x16x32_bf16 v[68:71], v[96:99], v[252:255], v[68:71]
    v_mul_f32 v122, v126, v54
    v_exp_f32 v122, v122
    v_mfma_f32_16x16x32_bf16 v[80:83], v[100:103], v[248:251], v[80:83]
    ds_read_b128 v[96:99], v2 offset:2048
    v_mul_f32 v62, v54, v62
    v_mfma_f32_16x16x32_bf16 v[84:87], v[100:103], v[252:255], v[84:87]
    v_mul_f32 v123, v126, v55
    s_waitcnt lgkmcnt(3)
    v_mfma_f32_16x16x32_bf16 v[72:75], v[104:107], v[248:251], v[72:75]
    ds_read_b128 v[100:103], v2 offset:2304
    v_mfma_f32_16x16x32_bf16 v[76:79], v[104:107], v[252:255], v[76:79]
    v_exp_f32 v123, v123
    v_mul_f32 v63, v55, v63
    v_mfma_f32_16x16x32_bf16 v[88:91], v[108:111], v[248:251], v[88:91]
    ds_read_b128 v[104:107], v2 offset:4096
    v_fma_f32 v120, v120, v127, v127
    v_mfma_f32_16x16x32_bf16 v[92:95], v[108:111], v[252:255], v[92:95]
    v_rcp_f32 v120, v120
    s_waitcnt vmcnt(2)
    v_mfma_f32_16x16x16_bf16 v[16:19], v[8:9], v[4:5], 0
    v_fma_f32 v121, v121, v127, v127
    v_rcp_f32 v121, v121
    v_mfma_f32_16x16x16_bf16 v[20:23], v[8:9], v[6:7], 0
    v_mul_f32 v60, v120, v60
    v_fma_f32 v122, v122, v127, v127
    v_mfma_f32_16x16x16_bf16 v[24:27], v[10:11], v[4:5], 0
    v_rcp_f32 v122, v122
    v_mul_f32 v61, v121, v61
    v_mfma_f32_16x16x16_bf16 v[28:31], v[10:11], v[6:7], 0
    v_fma_f32 v123, v123, v127, v127
    v_rcp_f32 v123, v123
    v_mul_f32 v62, v122, v62
    s_waitcnt vmcnt(0)
    s_barrier
    s_waitcnt lgkmcnt(3)
    v_mfma_f32_16x16x32_bf16 v[16:19], v[112:115], v[128:131], v[16:19]
    ds_read_b128 v[108:111], v2 offset:4352
    buffer_load_dwordx4 v[8:11], v1, s[4:7], s54 offen offset:2048 sc1
    v_mfma_f32_16x16x32_bf16 v[20:23], v[112:115], v[132:135], v[20:23]
    v_cvt_pk_bf16_f32 v50, v60, v61
    v_mul_f32 v63, v123, v63
    v_cvt_pk_bf16_f32 v51, v62, v63
    v_mfma_f32_16x16x32_bf16 v[24:27], v[116:119], v[128:131], v[24:27]
    ds_read_b128 v[112:115], v2 offset:6144
    s_add_u32 s53, s74, 32768
    v_mfma_f32_16x16x32_bf16 v[28:31], v[116:119], v[132:135], v[28:31]
    v_permlane32_swap_b32 v48, v50
    v_permlane32_swap_b32 v49, v51
    buffer_store_dwordx4 v[48:51], v125, s[4:7], s53 offen
    s_waitcnt lgkmcnt(3)
    v_mfma_f32_16x16x32_bf16 v[16:19], v[96:99], v[136:139], v[16:19]
    ds_read_b128 v[116:119], v2 offset:6400
    v_mul_f32 v120, v12, v64
    v_mfma_f32_16x16x32_bf16 v[20:23], v[96:99], v[140:143], v[20:23]
    v_exp_f32 v120, v120
    v_mfma_f32_16x16x32_bf16 v[24:27], v[100:103], v[136:139], v[24:27]
    ds_read_b128 v[96:99], v2 offset:8192
    v_mul_f32 v72, v64, v72
    v_mfma_f32_16x16x32_bf16 v[28:31], v[100:103], v[140:143], v[28:31]
    v_mul_f32 v121, v12, v65
    v_exp_f32 v121, v121
    s_waitcnt lgkmcnt(3)
    v_mfma_f32_16x16x32_bf16 v[16:19], v[104:107], v[144:147], v[16:19]
    ds_read_b128 v[100:103], v2 offset:8448
    v_mfma_f32_16x16x32_bf16 v[20:23], v[104:107], v[148:151], v[20:23]
    v_mul_f32 v73, v65, v73
    v_mul_f32 v122, v12, v66
    v_mfma_f32_16x16x32_bf16 v[24:27], v[108:111], v[144:147], v[24:27]
    ds_read_b128 v[104:107], v2 offset:10240
    v_exp_f32 v122, v122
    v_mfma_f32_16x16x32_bf16 v[28:31], v[108:111], v[148:151], v[28:31]
    v_mul_f32 v74, v66, v74
    s_waitcnt lgkmcnt(3)
    v_mfma_f32_16x16x32_bf16 v[16:19], v[112:115], v[152:155], v[16:19]
    ds_read_b128 v[108:111], v2 offset:10496
    v_mul_f32 v123, v12, v67
    v_mfma_f32_16x16x32_bf16 v[20:23], v[112:115], v[156:159], v[20:23]
    v_exp_f32 v123, v123
    v_mfma_f32_16x16x32_bf16 v[24:27], v[116:119], v[152:155], v[24:27]
    ds_read_b128 v[112:115], v2 offset:12288
    v_mul_f32 v75, v67, v75
    v_mfma_f32_16x16x32_bf16 v[28:31], v[116:119], v[156:159], v[28:31]
    v_fma_f32 v120, v120, v13, v13
    v_rcp_f32 v120, v120
    s_waitcnt lgkmcnt(3)
    v_mfma_f32_16x16x32_bf16 v[16:19], v[96:99], v[160:163], v[16:19]
    ds_read_b128 v[116:119], v2 offset:12544
    v_fma_f32 v121, v121, v13, v13
    v_mfma_f32_16x16x32_bf16 v[20:23], v[96:99], v[164:167], v[20:23]
    v_rcp_f32 v121, v121
    v_mfma_f32_16x16x32_bf16 v[24:27], v[100:103], v[160:163], v[24:27]
    ds_read_b128 v[96:99], v2 offset:14336
    v_mul_f32 v72, v120, v72
    v_mfma_f32_16x16x32_bf16 v[28:31], v[100:103], v[164:167], v[28:31]
    v_fma_f32 v122, v122, v13, v13
    s_waitcnt lgkmcnt(3)
    v_mfma_f32_16x16x32_bf16 v[16:19], v[104:107], v[168:171], v[16:19]
    ds_read_b128 v[100:103], v2 offset:14592
    v_mfma_f32_16x16x32_bf16 v[20:23], v[104:107], v[172:175], v[20:23]
    v_rcp_f32 v122, v122
    v_mul_f32 v73, v121, v73
    v_mfma_f32_16x16x32_bf16 v[24:27], v[108:111], v[168:171], v[24:27]
    ds_read_b128 v[104:107], v2 offset:16384
    v_fma_f32 v123, v123, v13, v13
    v_mfma_f32_16x16x32_bf16 v[28:31], v[108:111], v[172:175], v[28:31]
    v_rcp_f32 v123, v123
    v_mul_f32 v74, v122, v74
    s_waitcnt lgkmcnt(3)
    v_mfma_f32_16x16x32_bf16 v[16:19], v[112:115], v[176:179], v[16:19]
    ds_read_b128 v[108:111], v2 offset:16640
    v_cvt_pk_bf16_f32 v64, v72, v73
    v_mfma_f32_16x16x32_bf16 v[20:23], v[112:115], v[180:183], v[20:23]
    v_mul_f32 v75, v123, v75
    v_cvt_pk_bf16_f32 v65, v74, v75
    v_mfma_f32_16x16x32_bf16 v[24:27], v[116:119], v[176:179], v[24:27]
    ds_read_b128 v[112:115], v2 offset:18432
    v_mul_f32 v120, v126, v68
    v_mfma_f32_16x16x32_bf16 v[28:31], v[116:119], v[180:183], v[28:31]
    v_exp_f32 v120, v120
    s_waitcnt lgkmcnt(3)
    v_mfma_f32_16x16x32_bf16 v[16:19], v[96:99], v[184:187], v[16:19]
    ds_read_b128 v[116:119], v2 offset:18688
    v_mfma_f32_16x16x32_bf16 v[20:23], v[96:99], v[188:191], v[20:23]
    v_mul_f32 v76, v68, v76
    v_mul_f32 v121, v126, v69
    v_mfma_f32_16x16x32_bf16 v[24:27], v[100:103], v[184:187], v[24:27]
    ds_read_b128 v[96:99], v2 offset:20480
    v_exp_f32 v121, v121
    v_mfma_f32_16x16x32_bf16 v[28:31], v[100:103], v[188:191], v[28:31]
    v_mul_f32 v77, v69, v77
    v_mul_f32 v122, v126, v70
    s_waitcnt lgkmcnt(3)
    v_mfma_f32_16x16x32_bf16 v[16:19], v[104:107], v[192:195], v[16:19]
    ds_read_b128 v[100:103], v2 offset:20736
    v_mfma_f32_16x16x32_bf16 v[20:23], v[104:107], v[196:199], v[20:23]
    v_exp_f32 v122, v122
    v_mul_f32 v78, v70, v78
    v_mfma_f32_16x16x32_bf16 v[24:27], v[108:111], v[192:195], v[24:27]
    ds_read_b128 v[104:107], v2 offset:22528
    v_mul_f32 v123, v126, v71
    v_mfma_f32_16x16x32_bf16 v[28:31], v[108:111], v[196:199], v[28:31]
    v_exp_f32 v123, v123
    s_waitcnt lgkmcnt(3)
    v_mfma_f32_16x16x32_bf16 v[16:19], v[112:115], v[200:203], v[16:19]
    ds_read_b128 v[108:111], v2 offset:22784
    v_mfma_f32_16x16x32_bf16 v[20:23], v[112:115], v[204:207], v[20:23]
    v_mul_f32 v79, v71, v79
    v_fma_f32 v120, v120, v127, v127
    v_mfma_f32_16x16x32_bf16 v[24:27], v[116:119], v[200:203], v[24:27]
    ds_read_b128 v[112:115], v2 offset:24576
    v_rcp_f32 v120, v120
    v_mfma_f32_16x16x32_bf16 v[28:31], v[116:119], v[204:207], v[28:31]
    v_fma_f32 v121, v121, v127, v127
    s_waitcnt lgkmcnt(3)
    v_mfma_f32_16x16x32_bf16 v[16:19], v[96:99], v[208:211], v[16:19]
    ds_read_b128 v[116:119], v2 offset:24832
    v_rcp_f32 v121, v121
    v_mfma_f32_16x16x32_bf16 v[20:23], v[96:99], v[212:215], v[20:23]
    v_mul_f32 v76, v120, v76
    v_fma_f32 v122, v122, v127, v127
    v_mfma_f32_16x16x32_bf16 v[24:27], v[100:103], v[208:211], v[24:27]
    ds_read_b128 v[96:99], v2 offset:26624
    v_rcp_f32 v122, v122
    v_mfma_f32_16x16x32_bf16 v[28:31], v[100:103], v[212:215], v[28:31]
    v_mul_f32 v77, v121, v77
    s_waitcnt lgkmcnt(3)
    v_mfma_f32_16x16x32_bf16 v[16:19], v[104:107], v[216:219], v[16:19]
    ds_read_b128 v[100:103], v2 offset:26880
    v_fma_f32 v123, v123, v127, v127
    v_mfma_f32_16x16x32_bf16 v[20:23], v[104:107], v[220:223], v[20:23]
    v_rcp_f32 v123, v123
    v_mfma_f32_16x16x32_bf16 v[24:27], v[108:111], v[216:219], v[24:27]
    ds_read_b128 v[104:107], v2 offset:28672
    v_mul_f32 v78, v122, v78
    v_mfma_f32_16x16x32_bf16 v[28:31], v[108:111], v[220:223], v[28:31]
    v_cvt_pk_bf16_f32 v66, v76, v77
    v_mul_f32 v79, v123, v79
    s_waitcnt lgkmcnt(3)
    v_mfma_f32_16x16x32_bf16 v[16:19], v[112:115], v[224:227], v[16:19]
    ds_read_b128 v[108:111], v2 offset:28928
    v_cvt_pk_bf16_f32 v67, v78, v79
    v_mfma_f32_16x16x32_bf16 v[20:23], v[112:115], v[228:231], v[20:23]
    s_add_u32 s53, s74, 49152
    v_permlane32_swap_b32 v64, v66
    v_mfma_f32_16x16x32_bf16 v[24:27], v[116:119], v[224:227], v[24:27]
    ds_read_b128 v[112:115], v2 offset:30720
    v_permlane32_swap_b32 v65, v67
    v_mfma_f32_16x16x32_bf16 v[28:31], v[116:119], v[228:231], v[28:31]
    buffer_store_dwordx4 v[64:67], v125, s[4:7], s53 offen
    v_mul_f32 v120, v12, v80
    v_exp_f32 v120, v120
    s_waitcnt lgkmcnt(3)
    v_mfma_f32_16x16x32_bf16 v[16:19], v[96:99], v[232:235], v[16:19]
    ds_read_b128 v[116:119], v2 offset:30976
    v_mfma_f32_16x16x32_bf16 v[20:23], v[96:99], v[236:239], v[20:23]
    v_mul_f32 v88, v80, v88
    v_mul_f32 v121, v12, v81
    v_mfma_f32_16x16x32_bf16 v[24:27], v[100:103], v[232:235], v[24:27]
    ds_read_b128 v[96:99], v2 offset:32768
    v_exp_f32 v121, v121
    v_mfma_f32_16x16x32_bf16 v[28:31], v[100:103], v[236:239], v[28:31]
    v_mul_f32 v89, v81, v89
    s_waitcnt lgkmcnt(3)
    v_mfma_f32_16x16x32_bf16 v[16:19], v[104:107], v[240:243], v[16:19]
    ds_read_b128 v[100:103], v2 offset:33024
    v_mul_f32 v122, v12, v82
    v_mfma_f32_16x16x32_bf16 v[20:23], v[104:107], v[244:247], v[20:23]
    v_exp_f32 v122, v122
    v_mfma_f32_16x16x32_bf16 v[24:27], v[108:111], v[240:243], v[24:27]
    ds_read_b128 v[104:107], v2 offset:34816
    v_mul_f32 v90, v82, v90
    v_mfma_f32_16x16x32_bf16 v[28:31], v[108:111], v[244:247], v[28:31]
    v_mul_f32 v123, v12, v83
    v_exp_f32 v123, v123
    s_waitcnt lgkmcnt(3)
    v_mfma_f32_16x16x32_bf16 v[16:19], v[112:115], v[248:251], v[16:19]
    ds_read_b128 v[108:111], v2 offset:35072
    v_mfma_f32_16x16x32_bf16 v[20:23], v[112:115], v[252:255], v[20:23]
    v_mul_f32 v91, v83, v91
    v_fma_f32 v120, v120, v13, v13
    v_mfma_f32_16x16x32_bf16 v[24:27], v[116:119], v[248:251], v[24:27]
    ds_read_b128 v[112:115], v2 offset:36864
    v_rcp_f32 v120, v120
    v_mfma_f32_16x16x32_bf16 v[28:31], v[116:119], v[252:255], v[28:31]
    v_fma_f32 v121, v121, v13, v13
    s_waitcnt vmcnt(2)
    v_mfma_f32_16x16x16_bf16 v[32:35], v[8:9], v[4:5], 0
    v_rcp_f32 v121, v121
    v_mul_f32 v88, v120, v88
    v_mfma_f32_16x16x16_bf16 v[36:39], v[8:9], v[6:7], 0
    v_fma_f32 v122, v122, v13, v13
    v_rcp_f32 v122, v122
    v_mfma_f32_16x16x16_bf16 v[40:43], v[10:11], v[4:5], 0
    v_mul_f32 v89, v121, v89
    v_fma_f32 v123, v123, v13, v13
    v_mfma_f32_16x16x16_bf16 v[44:47], v[10:11], v[6:7], 0
    v_rcp_f32 v123, v123
    v_mul_f32 v90, v122, v90
    v_cvt_pk_bf16_f32 v80, v88, v89
    v_mul_f32 v91, v123, v91
    v_cvt_pk_bf16_f32 v81, v90, v91
    s_waitcnt vmcnt(1)
    s_barrier
    s_waitcnt lgkmcnt(3)
    v_mfma_f32_16x16x32_bf16 v[32:35], v[96:99], v[128:131], v[32:35]
    ds_read_b128 v[116:119], v2 offset:37120
    v_mul_f32 v120, v126, v84
    v_mfma_f32_16x16x32_bf16 v[36:39], v[96:99], v[132:135], v[36:39]
    v_exp_f32 v120, v120
    v_mfma_f32_16x16x32_bf16 v[40:43], v[100:103], v[128:131], v[40:43]
    ds_read_b128 v[96:99], v2 offset:38912
    v_mul_f32 v92, v84, v92
    v_mfma_f32_16x16x32_bf16 v[44:47], v[100:103], v[132:135], v[44:47]
    v_mul_f32 v121, v126, v85
    v_exp_f32 v121, v121
    s_waitcnt lgkmcnt(3)
    v_mfma_f32_16x16x32_bf16 v[32:35], v[104:107], v[136:139], v[32:35]
    ds_read_b128 v[100:103], v2 offset:39168
    v_mfma_f32_16x16x32_bf16 v[36:39], v[104:107], v[140:143], v[36:39]
    v_mul_f32 v93, v85, v93
    v_mul_f32 v122, v126, v86
    v_mfma_f32_16x16x32_bf16 v[40:43], v[108:111], v[136:139], v[40:43]
    ds_read_b128 v[104:107], v2 offset:40960
    v_exp_f32 v122, v122
    v_mfma_f32_16x16x32_bf16 v[44:47], v[108:111], v[140:143], v[44:47]
    v_mul_f32 v94, v86, v94
    v_mul_f32 v123, v126, v87
    s_waitcnt lgkmcnt(3)
    v_mfma_f32_16x16x32_bf16 v[32:35], v[112:115], v[144:147], v[32:35]
    ds_read_b128 v[108:111], v2 offset:41216
    v_mfma_f32_16x16x32_bf16 v[36:39], v[112:115], v[148:151], v[36:39]
    v_exp_f32 v123, v123
    v_mul_f32 v95, v87, v95
    v_mfma_f32_16x16x32_bf16 v[40:43], v[116:119], v[144:147], v[40:43]
    ds_read_b128 v[112:115], v2 offset:43008
    v_fma_f32 v120, v120, v127, v127
    v_mfma_f32_16x16x32_bf16 v[44:47], v[116:119], v[148:151], v[44:47]
    v_rcp_f32 v120, v120
    s_waitcnt lgkmcnt(3)
    v_mfma_f32_16x16x32_bf16 v[32:35], v[96:99], v[152:155], v[32:35]
    ds_read_b128 v[116:119], v2 offset:43264
    v_fma_f32 v121, v121, v127, v127
    v_mfma_f32_16x16x32_bf16 v[36:39], v[96:99], v[156:159], v[36:39]
    v_rcp_f32 v121, v121
    v_mfma_f32_16x16x32_bf16 v[40:43], v[100:103], v[152:155], v[40:43]
    ds_read_b128 v[96:99], v2 offset:45056
    v_mul_f32 v92, v120, v92
    v_mfma_f32_16x16x32_bf16 v[44:47], v[100:103], v[156:159], v[44:47]
    v_fma_f32 v122, v122, v127, v127
    s_waitcnt lgkmcnt(3)
    v_mfma_f32_16x16x32_bf16 v[32:35], v[104:107], v[160:163], v[32:35]
    ds_read_b128 v[100:103], v2 offset:45312
    v_rcp_f32 v122, v122
    v_mfma_f32_16x16x32_bf16 v[36:39], v[104:107], v[164:167], v[36:39]
    v_mul_f32 v93, v121, v93
    v_fma_f32 v123, v123, v127, v127
    v_mfma_f32_16x16x32_bf16 v[40:43], v[108:111], v[160:163], v[40:43]
    ds_read_b128 v[104:107], v2 offset:47104
    v_rcp_f32 v123, v123
    v_mfma_f32_16x16x32_bf16 v[44:47], v[108:111], v[164:167], v[44:47]
    v_mul_f32 v94, v122, v94
    s_waitcnt lgkmcnt(3)
    v_mfma_f32_16x16x32_bf16 v[32:35], v[112:115], v[168:171], v[32:35]
    ds_read_b128 v[108:111], v2 offset:47360
    buffer_load_dword v15, v14, s[4:7], s47 offen sc1
    v_mfma_f32_16x16x32_bf16 v[36:39], v[112:115], v[172:175], v[36:39]
    v_cvt_pk_bf16_f32 v82, v92, v93
    v_mul_f32 v95, v123, v95
    v_cvt_pk_bf16_f32 v83, v94, v95
    v_mfma_f32_16x16x32_bf16 v[40:43], v[116:119], v[168:171], v[40:43]
    ds_read_b128 v[112:115], v2 offset:49152
    s_add_u32 s53, s74, 65536
    v_mfma_f32_16x16x32_bf16 v[44:47], v[116:119], v[172:175], v[44:47]
    v_permlane32_swap_b32 v80, v82
    v_permlane32_swap_b32 v81, v83
    buffer_store_dwordx4 v[80:83], v125, s[4:7], s53 offen
    s_waitcnt lgkmcnt(3)
    v_mfma_f32_16x16x32_bf16 v[32:35], v[96:99], v[176:179], v[32:35]
    ds_read_b128 v[116:119], v2 offset:49408
    v_mul_f32 v120, v12, v16
    v_mfma_f32_16x16x32_bf16 v[36:39], v[96:99], v[180:183], v[36:39]
    v_exp_f32 v120, v120
    v_mul_f32 v24, v16, v24
    v_mfma_f32_16x16x32_bf16 v[40:43], v[100:103], v[176:179], v[40:43]
    ds_read_b128 v[96:99], v2 offset:51200
    v_mul_f32 v121, v12, v17
    v_mfma_f32_16x16x32_bf16 v[44:47], v[100:103], v[180:183], v[44:47]
    v_exp_f32 v121, v121
    s_waitcnt lgkmcnt(3)
    v_mfma_f32_16x16x32_bf16 v[32:35], v[104:107], v[184:187], v[32:35]
    ds_read_b128 v[100:103], v2 offset:51456
    v_mul_f32 v25, v17, v25
    v_mfma_f32_16x16x32_bf16 v[36:39], v[104:107], v[188:191], v[36:39]
    v_mul_f32 v122, v12, v18
    v_exp_f32 v122, v122
    v_mfma_f32_16x16x32_bf16 v[40:43], v[108:111], v[184:187], v[40:43]
    ds_read_b128 v[104:107], v2 offset:53248
    v_mul_f32 v26, v18, v26
    v_mfma_f32_16x16x32_bf16 v[44:47], v[108:111], v[188:191], v[44:47]
    v_mul_f32 v123, v12, v19
    v_exp_f32 v123, v123
    s_waitcnt lgkmcnt(3)
    v_mfma_f32_16x16x32_bf16 v[32:35], v[112:115], v[192:195], v[32:35]
    ds_read_b128 v[108:111], v2 offset:53504
    v_mfma_f32_16x16x32_bf16 v[36:39], v[112:115], v[196:199], v[36:39]
    v_mul_f32 v27, v19, v27
    v_fma_f32 v120, v120, v13, v13
    v_mfma_f32_16x16x32_bf16 v[40:43], v[116:119], v[192:195], v[40:43]
    ds_read_b128 v[112:115], v2 offset:55296
    v_rcp_f32 v120, v120
    v_mfma_f32_16x16x32_bf16 v[44:47], v[116:119], v[196:199], v[44:47]
    v_fma_f32 v121, v121, v13, v13
    v_rcp_f32 v121, v121
    s_waitcnt lgkmcnt(3)
    v_mfma_f32_16x16x32_bf16 v[32:35], v[96:99], v[200:203], v[32:35]
    ds_read_b128 v[116:119], v2 offset:55552
    v_mfma_f32_16x16x32_bf16 v[36:39], v[96:99], v[204:207], v[36:39]
    v_mul_f32 v24, v120, v24
    v_fma_f32 v122, v122, v13, v13
    v_mfma_f32_16x16x32_bf16 v[40:43], v[100:103], v[200:203], v[40:43]
    ds_read_b128 v[96:99], v2 offset:57344
    s_mul_i32 s50, s75, 12288
    v_mfma_f32_16x16x32_bf16 v[44:47], v[100:103], v[204:207], v[44:47]
    s_lshl_b32 s51, s75, 12
    s_add_u32 s51, s51, 4096
    v_add_u32 v4, s50, v124
    v_add_u32 v7, s51, v124
    v_add_u32 v5, 65536, v4
    v_add_u32 v8, 65536, v7
    v_add_u32 v6, 131072, v4
    v_add_u32 v9, 131072, v7
    v_rcp_f32 v122, v122
    v_mul_f32 v25, v121, v25
    v_fma_f32 v123, v123, v13, v13
    s_waitcnt lgkmcnt(3)
    v_mfma_f32_16x16x32_bf16 v[32:35], v[104:107], v[208:211], v[32:35]
    ds_read_b128 v[100:103], v2 offset:57600
    v_rcp_f32 v123, v123
    v_mfma_f32_16x16x32_bf16 v[36:39], v[104:107], v[212:215], v[36:39]
    v_mul_f32 v26, v122, v26
    v_cvt_pk_bf16_f32 v16, v24, v25
    v_mfma_f32_16x16x32_bf16 v[40:43], v[108:111], v[208:211], v[40:43]
    ds_read_b128 v[104:107], v2 offset:59392
    v_mul_f32 v27, v123, v27
    v_mfma_f32_16x16x32_bf16 v[44:47], v[108:111], v[212:215], v[44:47]
    v_cvt_pk_bf16_f32 v17, v26, v27
    v_mul_f32 v120, v126, v20
    s_waitcnt lgkmcnt(3)
    v_mfma_f32_16x16x32_bf16 v[32:35], v[112:115], v[216:219], v[32:35]
    ds_read_b128 v[108:111], v2 offset:59648
    v_exp_f32 v120, v120
    v_mfma_f32_16x16x32_bf16 v[36:39], v[112:115], v[220:223], v[36:39]
    v_mul_f32 v28, v20, v28
    v_mul_f32 v121, v126, v21
    v_mfma_f32_16x16x32_bf16 v[40:43], v[116:119], v[216:219], v[40:43]
    ds_read_b128 v[112:115], v2 offset:61440
    s_add_u32 s56, s49, 2
    s_waitcnt vmcnt(1)
    v_cmp_gt_u32 vcc, s56, v15
    s_nop 0
    s_or_b32 vcc_lo, vcc_lo, s45
    s_cbranch_scc1 pcs_16
pc_17:
    v_mfma_f32_16x16x32_bf16 v[44:47], v[116:119], v[220:223], v[44:47]
    v_exp_f32 v121, v121
    v_mul_f32 v29, v21, v29
    v_mul_f32 v122, v126, v22
    s_waitcnt lgkmcnt(3)
    v_mfma_f32_16x16x32_bf16 v[32:35], v[96:99], v[224:227], v[32:35]
    ds_read_b128 v[116:119], v2 offset:61696
    s_add_u32 s55, s69, 0
    buffer_load_dwordx4 v[128:131], v124, s[4:7], s55 offen offset:0 sc1
    v_mfma_f32_16x16x32_bf16 v[36:39], v[96:99], v[228:231], v[36:39]
    v_exp_f32 v122, v122
    v_mul_f32 v30, v22, v30
    v_mfma_f32_16x16x32_bf16 v[40:43], v[100:103], v[224:227], v[40:43]
    ds_read_b128 v[96:99], v2 offset:63488
    buffer_load_dwordx4 v[132:135], v124, s[4:7], s55 offen offset:256 sc1
    v_mfma_f32_16x16x32_bf16 v[44:47], v[100:103], v[228:231], v[44:47]
    v_mul_f32 v123, v126, v23
    v_exp_f32 v123, v123
    v_mul_f32 v31, v23, v31
    s_waitcnt lgkmcnt(3)
    v_mfma_f32_16x16x32_bf16 v[32:35], v[104:107], v[232:235], v[32:35]
    ds_read_b128 v[100:103], v2 offset:63744
    buffer_load_dwordx4 v[136:139], v124, s[4:7], s55 offen offset:2048 sc1
    v_mfma_f32_16x16x32_bf16 v[36:39], v[104:107], v[236:239], v[36:39]
    v_fma_f32 v120, v120, v127, v127
    v_rcp_f32 v120, v120
    v_mfma_f32_16x16x32_bf16 v[40:43], v[108:111], v[232:235], v[40:43]
    ds_read_b128 v[104:107], v9 offset:0
    buffer_load_dwordx4 v[140:143], v124, s[4:7], s55 offen offset:2304 sc1
    v_mfma_f32_16x16x32_bf16 v[44:47], v[108:111], v[236:239], v[44:47]
    v_fma_f32 v121, v121, v127, v127
    v_rcp_f32 v121, v121
    v_mul_f32 v28, v120, v28
    s_waitcnt lgkmcnt(3)
    v_mfma_f32_16x16x32_bf16 v[32:35], v[112:115], v[240:243], v[32:35]
    ds_read_b128 v[108:111], v9 offset:256
    s_add_u32 s55, s69, 4096
    buffer_load_dwordx4 v[144:147], v124, s[4:7], s55 offen offset:0 sc1
    v_mfma_f32_16x16x32_bf16 v[36:39], v[112:115], v[244:247], v[36:39]
    v_fma_f32 v122, v122, v127, v127
    v_rcp_f32 v122, v122
    v_mfma_f32_16x16x32_bf16 v[40:43], v[116:119], v[240:243], v[40:43]
    ds_read_b128 v[112:115], v6 offset:0
    buffer_load_dwordx4 v[148:151], v124, s[4:7], s55 offen offset:256 sc1
    v_mfma_f32_16x16x32_bf16 v[44:47], v[116:119], v[244:247], v[44:47]
    v_mul_f32 v29, v121, v29
    v_fma_f32 v123, v123, v127, v127
    v_rcp_f32 v123, v123
    s_waitcnt lgkmcnt(3)
    v_mfma_f32_16x16x32_bf16 v[32:35], v[96:99], v[248:251], v[32:35]
    ds_read_b128 v[116:119], v6 offset:256
    buffer_load_dwordx4 v[152:155], v124, s[4:7], s55 offen offset:2048 sc1
    v_mfma_f32_16x16x32_bf16 v[36:39], v[96:99], v[252:255], v[36:39]
    v_mul_f32 v30, v122, v30
    v_cvt_pk_bf16_f32 v18, v28, v29
    v_mul_f32 v31, v123, v31
    v_mfma_f32_16x16x32_bf16 v[40:43], v[100:103], v[248:251], v[40:43]
    ds_read_b128 v[96:99], v9 offset:2048
    buffer_load_dwordx4 v[156:159], v124, s[4:7], s55 offen offset:2304 sc1
    v_mfma_f32_16x16x32_bf16 v[44:47], v[100:103], v[252:255], v[44:47]
    v_cvt_pk_bf16_f32 v19, v30, v31
    s_add_u32 s53, s74, 81920
    v_permlane32_swap_b32 v16, v18
    v_permlane32_swap_b32 v17, v19
    buffer_store_dwordx4 v[16:19], v125, s[4:7], s53 offen
    s_waitcnt vmcnt(9)
    s_barrier
    s_waitcnt vmcnt(8) lgkmcnt(3)
    v_mfma_f32_16x16x32_bf16 v[64:67], v[104:107], v[128:131], 0
    ds_read_b128 v[100:103], v9 offset:2304
    s_waitcnt vmcnt(7)
    v_mfma_f32_16x16x32_bf16 v[68:71], v[104:107], v[132:135], 0
    buffer_load_dword v15, v14, s[4:7], s47 offen sc1
    s_add_u32 s55, s69, 16384
    buffer_load_dwordx4 v[160:163], v124, s[4:7], s55 offen offset:0 sc1
    v_mfma_f32_16x16x32_bf16 v[72:75], v[108:111], v[128:131], 0
    ds_read_b128 v[104:107], v6 offset:2048
    v_mfma_f32_16x16x32_bf16 v[76:79], v[108:111], v[132:135], 0
    s_waitcnt lgkmcnt(3)
    v_mfma_f32_16x16x32_bf16 v[48:51], v[112:115], v[128:131], 0
    ds_read_b128 v[108:111], v6 offset:2304
    v_mfma_f32_16x16x32_bf16 v[52:55], v[112:115], v[132:135], 0
    buffer_load_dwordx4 v[164:167], v124, s[4:7], s55 offen offset:256 sc1
    v_mfma_f32_16x16x32_bf16 v[56:59], v[116:119], v[128:131], 0
    ds_read_b128 v[112:115], v7 offset:0
    v_mul_f32 v120, v12, v32
    v_mfma_f32_16x16x32_bf16 v[60:63], v[116:119], v[132:135], 0
    v_exp_f32 v120, v120
    v_mul_f32 v40, v32, v40
    v_mul_f32 v121, v12, v33
    s_waitcnt vmcnt(9) lgkmcnt(3)
    v_mfma_f32_16x16x32_bf16 v[64:67], v[96:99], v[136:139], v[64:67]
    ds_read_b128 v[116:119], v7 offset:256
    s_waitcnt vmcnt(8)
    v_mfma_f32_16x16x32_bf16 v[68:71], v[96:99], v[140:143], v[68:71]
    buffer_load_dwordx4 v[168:171], v124, s[4:7], s55 offen offset:2048 sc1
    v_exp_f32 v121, v121
    v_mul_f32 v41, v33, v41
    v_mul_f32 v122, v12, v34
    v_exp_f32 v122, v122
    v_mfma_f32_16x16x32_bf16 v[72:75], v[100:103], v[136:139], v[72:75]
    ds_read_b128 v[96:99], v4 offset:0
    v_mul_f32 v42, v34, v42
    v_mfma_f32_16x16x32_bf16 v[76:79], v[100:103], v[140:143], v[76:79]
    v_mul_f32 v123, v12, v35
    v_exp_f32 v123, v123
    s_waitcnt lgkmcnt(3)
    v_mfma_f32_16x16x32_bf16 v[48:51], v[104:107], v[136:139], v[48:51]
    ds_read_b128 v[100:103], v4 offset:256
    buffer_load_dwordx4 v[172:175], v124, s[4:7], s55 offen offset:2304 sc1
    v_mfma_f32_16x16x32_bf16 v[52:55], v[104:107], v[140:143], v[52:55]
    v_mul_f32 v43, v35, v43
    v_fma_f32 v120, v120, v13, v13
    v_rcp_f32 v120, v120
    v_fma_f32 v121, v121, v13, v13
    v_mfma_f32_16x16x32_bf16 v[56:59], v[108:111], v[136:139], v[56:59]
    ds_read_b128 v[104:107], v7 offset:2048
    v_rcp_f32 v121, v121
    v_mfma_f32_16x16x32_bf16 v[60:63], v[108:111], v[140:143], v[60:63]
    v_mul_f32 v40, v120, v40
    v_fma_f32 v122, v122, v13, v13
    v_rcp_f32 v122, v122
    s_waitcnt vmcnt(9) lgkmcnt(3)
    v_mfma_f32_16x16x32_bf16 v[64:67], v[112:115], v[144:147], v[64:67]
    ds_read_b128 v[108:111], v7 offset:2304
    s_waitcnt vmcnt(8)
    v_mfma_f32_16x16x32_bf16 v[68:71], v[112:115], v[148:151], v[68:71]
    s_add_u32 s55, s69, 20480
    buffer_load_dwordx4 v[176:179], v124, s[4:7], s55 offen offset:0 sc1
    v_mul_f32 v41, v121, v41
    v_fma_f32 v123, v123, v13, v13
    v_rcp_f32 v123, v123
    v_mfma_f32_16x16x32_bf16 v[72:75], v[116:119], v[144:147], v[72:75]
    ds_read_b128 v[112:115], v4 offset:2048
    v_mul_f32 v42, v122, v42
    v_mfma_f32_16x16x32_bf16 v[76:79], v[116:119], v[148:151], v[76:79]
    v_cvt_pk_bf16_f32 v32, v40, v41
    v_mul_f32 v43, v123, v43
    v_cvt_pk_bf16_f32 v33, v42, v43
    v_mul_f32 v120, v126, v36
    s_waitcnt lgkmcnt(3)
    v_mfma_f32_16x16x32_bf16 v[48:51], v[96:99], v[144:147], v[48:51]
    ds_read_b128 v[116:119], v4 offset:2304
    buffer_load_dwordx4 v[180:183], v124, s[4:7], s55 offen offset:256 sc1
    v_mfma_f32_16x16x32_bf16 v[52:55], v[96:99], v[148:151], v[52:55]
    v_exp_f32 v120, v120
    v_mul_f32 v44, v36, v44
    v_mul_f32 v121, v126, v37
    v_exp_f32 v121, v121
    v_mfma_f32_16x16x32_bf16 v[56:59], v[100:103], v[144:147], v[56:59]
    ds_read_b128 v[96:99], v7 offset:16384
    v_mul_f32 v45, v37, v45
    v_mfma_f32_16x16x32_bf16 v[60:63], v[100:103], v[148:151], v[60:63]
    v_mul_f32 v122, v126, v38
    v_exp_f32 v122, v122
    v_mul_f32 v46, v38, v46
    s_waitcnt vmcnt(9) lgkmcnt(3)
    v_mfma_f32_16x16x32_bf16 v[64:67], v[104:107], v[152:155], v[64:67]
    ds_read_b128 v[100:103], v7 offset:16640
    s_waitcnt vmcnt(8)
    v_mfma_f32_16x16x32_bf16 v[68:71], v[104:107], v[156:159], v[68:71]
    buffer_load_dwordx4 v[184:187], v124, s[4:7], s55 offen offset:2048 sc1
    v_mul_f32 v123, v126, v39
    v_exp_f32 v123, v123
    v_mul_f32 v47, v39, v47
    v_fma_f32 v120, v120, v127, v127
    v_mfma_f32_16x16x32_bf16 v[72:75], v[108:111], v[152:155], v[72:75]
    ds_read_b128 v[104:107], v4 offset:16384
    v_rcp_f32 v120, v120
    v_mfma_f32_16x16x32_bf16 v[76:79], v[108:111], v[156:159], v[76:79]
    v_fma_f32 v121, v121, v127, v127
    v_rcp_f32 v121, v121
    s_waitcnt lgkmcnt(3)
    v_mfma_f32_16x16x32_bf16 v[48:51], v[112:115], v[152:155], v[48:51]
    ds_read_b128 v[108:111], v4 offset:16640
    buffer_load_dwordx4 v[188:191], v124, s[4:7], s55 offen offset:2304 sc1
    v_mfma_f32_16x16x32_bf16 v[52:55], v[112:115], v[156:159], v[52:55]
    v_mul_f32 v44, v120, v44
    v_fma_f32 v122, v122, v127, v127
    v_rcp_f32 v122, v122
    v_mul_f32 v45, v121, v45
    v_mfma_f32_16x16x32_bf16 v[56:59], v[116:119], v[152:155], v[56:59]
    ds_read_b128 v[112:115], v7 offset:18432
    v_fma_f32 v123, v123, v127, v127
    v_mfma_f32_16x16x32_bf16 v[60:63], v[116:119], v[156:159], v[60:63]
    v_rcp_f32 v123, v123
    v_mul_f32 v46, v122, v46
    v_cvt_pk_bf16_f32 v34, v44, v45
    s_waitcnt vmcnt(7) lgkmcnt(3)
    v_mfma_f32_16x16x32_bf16 v[64:67], v[96:99], v[160:163], v[64:67]
    ds_read_b128 v[116:119], v7 offset:18688
    s_waitcnt vmcnt(6)
    v_mfma_f32_16x16x32_bf16 v[68:71], v[96:99], v[164:167], v[68:71]
    s_add_u32 s56, s49, 3
    v_cmp_gt_u32 vcc, s56, v15
    s_nop 0
    s_or_b32 vcc_lo, vcc_lo, s45
    s_cbranch_scc1 pcs_18
pc_19:
    buffer_load_dword v15, v14, s[4:7], s47 offen sc1
    s_add_u32 s55, s69, 32768
    buffer_load_dwordx4 v[192:195], v124, s[4:7], s55 offen offset:0 sc1
    v_mul_f32 v47, v123, v47
    v_cvt_pk_bf16_f32 v35, v46, v47
    s_add_u32 s53, s74, 98304
    v_permlane32_swap_b32 v32, v34
    v_permlane32_swap_b32 v33, v35
    buffer_store_dwordx4 v[32:35], v125, s[4:7], s53 offen
    v_mfma_f32_16x16x32_bf16 v[72:75], v[100:103], v[160:163], v[72:75]
    ds_read_b128 v[96:99], v4 offset:18432
    v_mfma_f32_16x16x32_bf16 v[76:79], v[100:103], v[164:167], v[76:79]
    s_waitcnt lgkmcnt(3)
    v_mfma_f32_16x16x32_bf16 v[48:51], v[104:107], v[160:163], v[48:51]
    ds_read_b128 v[100:103], v4 offset:18688
    v_mfma_f32_16x16x32_bf16 v[52:55], v[104:107], v[164:167], v[52:55]
    buffer_load_dwordx4 v[196:199], v124, s[4:7], s55 offen offset:256 sc1
    v_mfma_f32_16x16x32_bf16 v[56:59], v[108:111], v[160:163], v[56:59]
    ds_read_b128 v[104:107], v7 offset:32768
    v_mfma_f32_16x16x32_bf16 v[60:63], v[108:111], v[164:167], v[60:63]
    s_waitcnt vmcnt(9) lgkmcnt(3)
    v_mfma_f32_16x16x32_bf16 v[64:67], v[112:115], v[168:171], v[64:67]
    ds_read_b128 v[108:111], v7 offset:33024
    s_waitcnt vmcnt(8)
    v_mfma_f32_16x16x32_bf16 v[68:71], v[112:115], v[172:175], v[68:71]
    buffer_load_dwordx4 v[200:203], v124, s[4:7], s55 offen offset:2048 sc1
    v_mfma_f32_16x16x32_bf16 v[72:75], v[116:119], v[168:171], v[72:75]
    ds_read_b128 v[112:115], v4 offset:32768
    v_mfma_f32_16x16x32_bf16 v[76:79], v[116:119], v[172:175], v[76:79]
    s_waitcnt lgkmcnt(3)
    v_mfma_f32_16x16x32_bf16 v[48:51], v[96:99], v[168:171], v[48:51]
    ds_read_b128 v[116:119], v4 offset:33024
    v_mfma_f32_16x16x32_bf16 v[52:55], v[96:99], v[172:175], v[52:55]
    buffer_load_dwordx4 v[204:207], v124, s[4:7], s55 offen offset:2304 sc1
    v_mfma_f32_16x16x32_bf16 v[56:59], v[100:103], v[168:171], v[56:59]
    ds_read_b128 v[96:99], v7 offset:34816
    v_mfma_f32_16x16x32_bf16 v[60:63], v[100:103], v[172:175], v[60:63]
    s_waitcnt vmcnt(9) lgkmcnt(3)
    v_mfma_f32_16x16x32_bf16 v[64:67], v[104:107], v[176:179], v[64:67]
    ds_read_b128 v[100:103], v7 offset:35072
    s_waitcnt vmcnt(8)
    v_mfma_f32_16x16x32_bf16 v[68:71], v[104:107], v[180:183], v[68:71]
    s_add_u32 s55, s69, 36864
    buffer_load_dwordx4 v[208:211], v124, s[4:7], s55 offen offset:0 sc1
    v_mfma_f32_16x16x32_bf16 v[72:75], v[108:111], v[176:179], v[72:75]
    ds_read_b128 v[104:107], v4 offset:34816
    v_mfma_f32_16x16x32_bf16 v[76:79], v[108:111], v[180:183], v[76:79]
    s_waitcnt lgkmcnt(3)
    v_mfma_f32_16x16x32_bf16 v[48:51], v[112:115], v[176:179], v[48:51]
    ds_read_b128 v[108:111], v4 offset:35072
    v_mfma_f32_16x16x32_bf16 v[52:55], v[112:115], v[180:183], v[52:55]
    buffer_load_dwordx4 v[212:215], v124, s[4:7], s55 offen offset:256 sc1
    v_mfma_f32_16x16x32_bf16 v[56:59], v[116:119], v[176:179], v[56:59]
    ds_read_b128 v[112:115], v7 offset:49152
    v_mfma_f32_16x16x32_bf16 v[60:63], v[116:119], v[180:183], v[60:63]
    s_waitcnt vmcnt(9) lgkmcnt(3)
    v_mfma_f32_16x16x32_bf16 v[64:67], v[96:99], v[184:187], v[64:67]
    ds_read_b128 v[116:119], v7 offset:49408
    s_waitcnt vmcnt(8)
    v_mfma_f32_16x16x32_bf16 v[68:71], v[96:99], v[188:191], v[68:71]
    buffer_load_dwordx4 v[216:219], v124, s[4:7], s55 offen offset:2048 sc1
    v_mfma_f32_16x16x32_bf16 v[72:75], v[100:103], v[184:187], v[72:75]
    ds_read_b128 v[96:99], v4 offset:49152
    v_mfma_f32_16x16x32_bf16 v[76:79], v[100:103], v[188:191], v[76:79]
    s_waitcnt lgkmcnt(3)
    v_mfma_f32_16x16x32_bf16 v[48:51], v[104:107], v[184:187], v[48:51]
    ds_read_b128 v[100:103], v4 offset:49408
    v_mfma_f32_16x16x32_bf16 v[52:55], v[104:107], v[188:191], v[52:55]
    buffer_load_dwordx4 v[220:223], v124, s[4:7], s55 offen offset:2304 sc1
    v_mfma_f32_16x16x32_bf16 v[56:59], v[108:111], v[184:187], v[56:59]
    ds_read_b128 v[104:107], v7 offset:51200
    v_mfma_f32_16x16x32_bf16 v[60:63], v[108:111], v[188:191], v[60:63]
    s_waitcnt vmcnt(7)
    s_barrier
    s_waitcnt lgkmcnt(3)
    v_mfma_f32_16x16x32_bf16 v[64:67], v[112:115], v[192:195], v[64:67]
    ds_read_b128 v[108:111], v7 offset:51456
    s_waitcnt vmcnt(6)
    v_mfma_f32_16x16x32_bf16 v[68:71], v[112:115], v[196:199], v[68:71]
    s_add_u32 s56, s49, 4
    v_cmp_gt_u32 vcc, s56, v15
    s_nop 0
    s_or_b32 vcc_lo, vcc_lo, s45
    s_cbranch_scc1 pcs_20
pc_21:
    s_add_u32 s55, s69, 49152
    buffer_load_dwordx4 v[224:227], v124, s[4:7], s55 offen offset:0 sc1
    v_mfma_f32_16x16x32_bf16 v[72:75], v[116:119], v[192:195], v[72:75]
    ds_read_b128 v[112:115], v4 offset:51200
    v_mfma_f32_16x16x32_bf16 v[76:79], v[116:119], v[196:199], v[76:79]
    s_waitcnt lgkmcnt(3)
    v_mfma_f32_16x16x32_bf16 v[48:51], v[96:99], v[192:195], v[48:51]
    ds_read_b128 v[116:119], v4 offset:51456
    v_mfma_f32_16x16x32_bf16 v[52:55], v[96:99], v[196:199], v[52:55]
    buffer_load_dwordx4 v[228:231], v124, s[4:7], s55 offen offset:256 sc1
    v_mfma_f32_16x16x32_bf16 v[56:59], v[100:103], v[192:195], v[56:59]
    ds_read_b128 v[96:99], v9 offset:16384
    v_mfma_f32_16x16x32_bf16 v[60:63], v[100:103], v[196:199], v[60:63]
    s_waitcnt vmcnt(7) lgkmcnt(3)
    v_mfma_f32_16x16x32_bf16 v[64:67], v[104:107], v[200:203], v[64:67]
    ds_read_b128 v[100:103], v9 offset:16640
    s_waitcnt vmcnt(6)
    v_mfma_f32_16x16x32_bf16 v[68:71], v[104:107], v[204:207], v[68:71]
    buffer_load_dwordx4 v[232:235], v124, s[4:7], s55 offen offset:2048 sc1
    v_mfma_f32_16x16x32_bf16 v[72:75], v[108:111], v[200:203], v[72:75]
    ds_read_b128 v[104:107], v6 offset:16384
    v_mfma_f32_16x16x32_bf16 v[76:79], v[108:111], v[204:207], v[76:79]
    s_waitcnt lgkmcnt(3)
    v_mfma_f32_16x16x32_bf16 v[48:51], v[112:115], v[200:203], v[48:51]
    ds_read_b128 v[108:111], v6 offset:16640
    v_mfma_f32_16x16x32_bf16 v[52:55], v[112:115], v[204:207], v[52:55]
    buffer_load_dwordx4 v[236:239], v124, s[4:7], s55 offen offset:2304 sc1
    v_mfma_f32_16x16x32_bf16 v[56:59], v[116:119], v[200:203], v[56:59]
    ds_read_b128 v[112:115], v9 offset:18432
    v_mfma_f32_16x16x32_bf16 v[60:63], v[116:119], v[204:207], v[60:63]
    s_waitcnt vmcnt(7) lgkmcnt(3)
    v_mfma_f32_16x16x32_bf16 v[64:67], v[96:99], v[208:211], v[64:67]
    ds_read_b128 v[116:119], v9 offset:18688
    s_waitcnt vmcnt(6)
    v_mfma_f32_16x16x32_bf16 v[68:71], v[96:99], v[212:215], v[68:71]
    s_add_u32 s55, s69, 53248
    buffer_load_dwordx4 v[240:243], v124, s[4:7], s55 offen offset:0 sc1
    buffer_load_dwordx4 v[80:83], v125, s[4:7], s66 offen sc1
    buffer_load_dwordx4 v[84:87], v125, s[4:7], s66 offen offset:1024 sc1
    buffer_load_dword v88, v1, s[4:7], s67 offen sc1
    v_mfma_f32_16x16x32_bf16 v[72:75], v[100:103], v[208:211], v[72:75]
    ds_read_b128 v[96:99], v6 offset:18432
    v_mfma_f32_16x16x32_bf16 v[76:79], v[100:103], v[212:215], v[76:79]
    s_waitcnt lgkmcnt(3)
    v_mfma_f32_16x16x32_bf16 v[48:51], v[104:107], v[208:211], v[48:51]
    ds_read_b128 v[100:103], v6 offset:18688
    v_mfma_f32_16x16x32_bf16 v[52:55], v[104:107], v[212:215], v[52:55]
    buffer_load_dwordx4 v[244:247], v124, s[4:7], s55 offen offset:256 sc1
    v_mfma_f32_16x16x32_bf16 v[56:59], v[108:111], v[208:211], v[56:59]
    ds_read_b128 v[104:107], v8 offset:0
    v_mfma_f32_16x16x32_bf16 v[60:63], v[108:111], v[212:215], v[60:63]
    s_waitcnt vmcnt(10) lgkmcnt(3)
    v_mfma_f32_16x16x32_bf16 v[64:67], v[112:115], v[216:219], v[64:67]
    ds_read_b128 v[108:111], v8 offset:256
    s_waitcnt vmcnt(9)
    v_mfma_f32_16x16x32_bf16 v[68:71], v[112:115], v[220:223], v[68:71]
    buffer_load_dwordx4 v[248:251], v124, s[4:7], s55 offen offset:2048 sc1
    v_mfma_f32_16x16x32_bf16 v[72:75], v[116:119], v[216:219], v[72:75]
    ds_read_b128 v[112:115], v5 offset:0
    v_mfma_f32_16x16x32_bf16 v[76:79], v[116:119], v[220:223], v[76:79]
    s_waitcnt lgkmcnt(3)
    v_mfma_f32_16x16x32_bf16 v[48:51], v[96:99], v[216:219], v[48:51]
    ds_read_b128 v[116:119], v5 offset:256
    v_mfma_f32_16x16x32_bf16 v[52:55], v[96:99], v[220:223], v[52:55]
    buffer_load_dwordx4 v[252:255], v124, s[4:7], s55 offen offset:2304 sc1
    v_mfma_f32_16x16x32_bf16 v[56:59], v[100:103], v[216:219], v[56:59]
    ds_read_b128 v[96:99], v8 offset:2048
    v_mfma_f32_16x16x32_bf16 v[60:63], v[100:103], v[220:223], v[60:63]
    s_waitcnt vmcnt(10) lgkmcnt(3)
    v_mfma_f32_16x16x32_bf16 v[64:67], v[104:107], v[224:227], v[64:67]
    ds_read_b128 v[100:103], v8 offset:2304
    s_waitcnt vmcnt(9)
    v_mfma_f32_16x16x32_bf16 v[68:71], v[104:107], v[228:231], v[68:71]
    buffer_load_dword v15, v14, s[4:7], s47 offen sc1
    s_add_u32 s55, s69, 65536
    buffer_load_dwordx4 v[128:131], v124, s[4:7], s55 offen offset:0 sc1
    v_mfma_f32_16x16x32_bf16 v[72:75], v[108:111], v[224:227], v[72:75]
    ds_read_b128 v[104:107], v5 offset:2048
    v_mfma_f32_16x16x32_bf16 v[76:79], v[108:111], v[228:231], v[76:79]
    s_waitcnt lgkmcnt(3)
    v_mfma_f32_16x16x32_bf16 v[48:51], v[112:115], v[224:227], v[48:51]
    ds_read_b128 v[108:111], v5 offset:2304
    v_mfma_f32_16x16x32_bf16 v[52:55], v[112:115], v[228:231], v[52:55]
    buffer_load_dwordx4 v[132:135], v124, s[4:7], s55 offen offset:256 sc1
    v_mfma_f32_16x16x32_bf16 v[56:59], v[116:119], v[224:227], v[56:59]
    ds_read_b128 v[112:115], v8 offset:16384
    v_mfma_f32_16x16x32_bf16 v[60:63], v[116:119], v[228:231], v[60:63]
    s_waitcnt vmcnt(11) lgkmcnt(3)
    v_mfma_f32_16x16x32_bf16 v[64:67], v[96:99], v[232:235], v[64:67]
    ds_read_b128 v[116:119], v8 offset:16640
    s_waitcnt vmcnt(10)
    v_mfma_f32_16x16x32_bf16 v[68:71], v[96:99], v[236:239], v[68:71]
    buffer_load_dwordx4 v[136:139], v124, s[4:7], s55 offen offset:2048 sc1
    v_mfma_f32_16x16x32_bf16 v[72:75], v[100:103], v[232:235], v[72:75]
    ds_read_b128 v[96:99], v5 offset:16384
    v_mfma_f32_16x16x32_bf16 v[76:79], v[100:103], v[236:239], v[76:79]
    s_waitcnt lgkmcnt(3)
    v_mfma_f32_16x16x32_bf16 v[48:51], v[104:107], v[232:235], v[48:51]
    ds_read_b128 v[100:103], v5 offset:16640
    v_mfma_f32_16x16x32_bf16 v[52:55], v[104:107], v[236:239], v[52:55]
    buffer_load_dwordx4 v[140:143], v124, s[4:7], s55 offen offset:2304 sc1
    v_mfma_f32_16x16x32_bf16 v[56:59], v[108:111], v[232:235], v[56:59]
    ds_read_b128 v[104:107], v8 offset:18432
    v_mfma_f32_16x16x32_bf16 v[60:63], v[108:111], v[236:239], v[60:63]
    s_waitcnt vmcnt(11) lgkmcnt(3)
    v_mfma_f32_16x16x32_bf16 v[64:67], v[112:115], v[240:243], v[64:67]
    ds_read_b128 v[108:111], v8 offset:18688
    s_waitcnt vmcnt(7)
    v_mfma_f32_16x16x32_bf16 v[68:71], v[112:115], v[244:247], v[68:71]
    s_add_u32 s55, s69, 69632
    buffer_load_dwordx4 v[144:147], v124, s[4:7], s55 offen offset:0 sc1
    v_mfma_f32_16x16x32_bf16 v[72:75], v[116:119], v[240:243], v[72:75]
    ds_read_b128 v[112:115], v5 offset:18432
    v_mfma_f32_16x16x32_bf16 v[76:79], v[116:119], v[244:247], v[76:79]
    s_waitcnt lgkmcnt(3)
    v_mfma_f32_16x16x32_bf16 v[48:51], v[96:99], v[240:243], v[48:51]
    ds_read_b128 v[116:119], v5 offset:18688
    v_mfma_f32_16x16x32_bf16 v[52:55], v[96:99], v[244:247], v[52:55]
    buffer_load_dwordx4 v[148:151], v124, s[4:7], s55 offen offset:256 sc1
    v_mfma_f32_16x16x32_bf16 v[56:59], v[100:103], v[240:243], v[56:59]
    ds_read_b128 v[96:99], v8 offset:32768
    v_mfma_f32_16x16x32_bf16 v[60:63], v[100:103], v[244:247], v[60:63]
    s_waitcnt vmcnt(8) lgkmcnt(3)
    v_mfma_f32_16x16x32_bf16 v[64:67], v[104:107], v[248:251], v[64:67]
    ds_read_b128 v[100:103], v8 offset:33024
    s_waitcnt vmcnt(7)
    v_mfma_f32_16x16x32_bf16 v[68:71], v[104:107], v[252:255], v[68:71]
    buffer_load_dwordx4 v[152:155], v124, s[4:7], s55 offen offset:2048 sc1
    v_mfma_f32_16x16x32_bf16 v[72:75], v[108:111], v[248:251], v[72:75]
    ds_read_b128 v[104:107], v5 offset:32768
    v_mfma_f32_16x16x32_bf16 v[76:79], v[108:111], v[252:255], v[76:79]
    s_waitcnt lgkmcnt(3)
    v_mfma_f32_16x16x32_bf16 v[48:51], v[112:115], v[248:251], v[48:51]
    ds_read_b128 v[108:111], v5 offset:33024
    v_mfma_f32_16x16x32_bf16 v[52:55], v[112:115], v[252:255], v[52:55]
    buffer_load_dwordx4 v[156:159], v124, s[4:7], s55 offen offset:2304 sc1
    v_mfma_f32_16x16x32_bf16 v[56:59], v[116:119], v[248:251], v[56:59]
    ds_read_b128 v[112:115], v8 offset:34816
    v_mfma_f32_16x16x32_bf16 v[60:63], v[116:119], v[252:255], v[60:63]
    s_barrier
    s_waitcnt vmcnt(7) lgkmcnt(3)
    v_mfma_f32_16x16x32_bf16 v[64:67], v[96:99], v[128:131], v[64:67]
    ds_read_b128 v[116:119], v8 offset:35072
    s_waitcnt vmcnt(6)
    v_mfma_f32_16x16x32_bf16 v[68:71], v[96:99], v[132:135], v[68:71]
    s_add_u32 s56, s49, 5
    v_cmp_gt_u32 vcc, s56, v15
    s_nop 0
    s_or_b32 vcc_lo, vcc_lo, s45
    s_cbranch_scc1 pcs_22
pc_23:
    s_add_u32 s55, s69, 81920
    buffer_load_dwordx4 v[160:163], v124, s[4:7], s55 offen offset:0 sc1
    v_mfma_f32_16x16x32_bf16 v[72:75], v[100:103], v[128:131], v[72:75]
    ds_read_b128 v[96:99], v5 offset:34816
    v_mfma_f32_16x16x32_bf16 v[76:79], v[100:103], v[132:135], v[76:79]
    s_waitcnt lgkmcnt(3)
    v_mfma_f32_16x16x32_bf16 v[48:51], v[104:107], v[128:131], v[48:51]
    ds_read_b128 v[100:103], v5 offset:35072
    buffer_load_dwordx4 v[164:167], v124, s[4:7], s55 offen offset:256 sc1
    v_mfma_f32_16x16x32_bf16 v[52:55], v[104:107], v[132:135], v[52:55]
    v_permlane32_swap_b32 v80, v82
    v_mfma_f32_16x16x32_bf16 v[56:59], v[108:111], v[128:131], v[56:59]
    ds_read_b128 v[104:107], v8 offset:49152
    v_permlane32_swap_b32 v81, v83
    v_mfma_f32_16x16x32_bf16 v[60:63], v[108:111], v[132:135], v[60:63]
    v_permlane32_swap_b32 v84, v86
    s_waitcnt vmcnt(7) lgkmcnt(3)
    v_mfma_f32_16x16x32_bf16 v[64:67], v[112:115], v[136:139], v[64:67]
    ds_read_b128 v[108:111], v8 offset:49408
    s_waitcnt vmcnt(6)
    v_mfma_f32_16x16x32_bf16 v[68:71], v[112:115], v[140:143], v[68:71]
    buffer_load_dwordx4 v[168:171], v124, s[4:7], s55 offen offset:2048 sc1
    v_permlane32_swap_b32 v85, v87
    v_mfma_f32_16x16x32_bf16 v[72:75], v[116:119], v[136:139], v[72:75]
    ds_read_b128 v[112:115], v5 offset:49152
    v_mfma_f32_16x16x32_bf16 v[76:79], v[116:119], v[140:143], v[76:79]
    v_lshlrev_b32 v32, 16, v80
    s_waitcnt lgkmcnt(3)
    v_mfma_f32_16x16x32_bf16 v[48:51], v[96:99], v[136:139], v[48:51]
    ds_read_b128 v[116:119], v5 offset:49408
    v_mfma_f32_16x16x32_bf16 v[52:55], v[96:99], v[140:143], v[52:55]
    buffer_load_dwordx4 v[172:175], v124, s[4:7], s55 offen offset:2304 sc1
    v_and_b32 v33, 0xffff0000, v80
    v_mfma_f32_16x16x32_bf16 v[56:59], v[100:103], v[136:139], v[56:59]
    ds_read_b128 v[96:99], v8 offset:51200
    v_lshlrev_b32 v34, 16, v81
    v_mfma_f32_16x16x32_bf16 v[60:63], v[100:103], v[140:143], v[60:63]
    v_and_b32 v35, 0xffff0000, v81
    s_waitcnt vmcnt(7) lgkmcnt(3)
    v_mfma_f32_16x16x32_bf16 v[64:67], v[104:107], v[144:147], v[64:67]
    ds_read_b128 v[100:103], v8 offset:51456
    s_waitcnt vmcnt(6)
    v_mfma_f32_16x16x32_bf16 v[68:71], v[104:107], v[148:151], v[68:71]
    s_add_u32 s55, s69, 86016
    buffer_load_dwordx4 v[176:179], v124, s[4:7], s55 offen offset:0 sc1
    v_lshlrev_b32 v36, 16, v82
    v_mfma_f32_16x16x32_bf16 v[72:75], v[108:111], v[144:147], v[72:75]
    ds_read_b128 v[104:107], v5 offset:51200
    v_mfma_f32_16x16x32_bf16 v[76:79], v[108:111], v[148:151], v[76:79]
    v_and_b32 v37, 0xffff0000, v82
    s_waitcnt lgkmcnt(3)
    v_mfma_f32_16x16x32_bf16 v[48:51], v[112:115], v[144:147], v[48:51]
    ds_read_b128 v[108:111], v5 offset:51456
    v_mfma_f32_16x16x32_bf16 v[52:55], v[112:115], v[148:151], v[52:55]
    buffer_load_dwordx4 v[180:183], v124, s[4:7], s55 offen offset:256 sc1
    v_lshlrev_b32 v38, 16, v83
    v_mfma_f32_16x16x32_bf16 v[56:59], v[116:119], v[144:147], v[56:59]
    ds_read_b128 v[112:115], v9 offset:0
    v_and_b32 v39, 0xffff0000, v83
    v_mfma_f32_16x16x32_bf16 v[60:63], v[116:119], v[148:151], v[60:63]
    v_lshlrev_b32 v40, 16, v84
    s_waitcnt vmcnt(7) lgkmcnt(3)
    v_mfma_f32_16x16x32_bf16 v[64:67], v[96:99], v[152:155], v[64:67]
    ds_read_b128 v[116:119], v9 offset:256
    s_waitcnt vmcnt(6)
    v_mfma_f32_16x16x32_bf16 v[68:71], v[96:99], v[156:159], v[68:71]
    buffer_load_dwordx4 v[184:187], v124, s[4:7], s55 offen offset:2048 sc1
    v_and_b32 v41, 0xffff0000, v84
    v_mfma_f32_16x16x32_bf16 v[72:75], v[100:103], v[152:155], v[72:75]
    ds_read_b128 v[96:99], v6 offset:0
    v_mfma_f32_16x16x32_bf16 v[76:79], v[100:103], v[156:159], v[76:79]
    v_lshlrev_b32 v42, 16, v85
    s_waitcnt lgkmcnt(3)
    v_mfma_f32_16x16x32_bf16 v[48:51], v[104:107], v[152:155], v[48:51]
    ds_read_b128 v[100:103], v6 offset:256
    v_mfma_f32_16x16x32_bf16 v[52:55], v[104:107], v[156:159], v[52:55]
    buffer_load_dwordx4 v[188:191], v124, s[4:7], s55 offen offset:2304 sc1
    v_and_b32 v43, 0xffff0000, v85
    v_mfma_f32_16x16x32_bf16 v[56:59], v[108:111], v[152:155], v[56:59]
    ds_read_b128 v[104:107], v9 offset:2048
    v_lshlrev_b32 v44, 16, v86
    v_mfma_f32_16x16x32_bf16 v[60:63], v[108:111], v[156:159], v[60:63]
    v_and_b32 v45, 0xffff0000, v86
    s_barrier
    s_waitcnt vmcnt(7) lgkmcnt(3)
    v_mfma_f32_16x16x32_bf16 v[64:67], v[112:115], v[160:163], v[64:67]
    ds_read_b128 v[108:111], v9 offset:2304
    s_waitcnt vmcnt(6)
    v_mfma_f32_16x16x32_bf16 v[68:71], v[112:115], v[164:167], v[68:71]
    s_add_u32 s55, s69, 98304
    buffer_load_dwordx4 v[192:195], v124, s[4:7], s55 offen offset:0 sc1
    v_lshlrev_b32 v46, 16, v87
    v_mfma_f32_16x16x32_bf16 v[72:75], v[116:119], v[160:163], v[72:75]
    ds_read_b128 v[112:115], v6 offset:2048
    v_mfma_f32_16x16x32_bf16 v[76:79], v[116:119], v[164:167], v[76:79]
    v_and_b32 v47, 0xffff0000, v87
    s_waitcnt lgkmcnt(3)
    v_mfma_f32_16x16x32_bf16 v[48:51], v[96:99], v[160:163], v[48:51]
    ds_read_b128 v[116:119], v6 offset:2304
    v_mfma_f32_16x16x32_bf16 v[52:55], v[96:99], v[164:167], v[52:55]
    buffer_load_dwordx4 v[196:199], v124, s[4:7], s55 offen offset:256 sc1
    v_mfma_f32_16x16x32_bf16 v[56:59], v[100:103], v[160:163], v[56:59]
    ds_read_b128 v[96:99], v7 offset:0
    v_mfma_f32_16x16x32_bf16 v[60:63], v[100:103], v[164:167], v[60:63]
    s_waitcnt vmcnt(7) lgkmcnt(3)
    v_mfma_f32_16x16x32_bf16 v[64:67], v[104:107], v[168:171], v[64:67]
    ds_read_b128 v[100:103], v7 offset:256
    s_waitcnt vmcnt(6)
    v_mfma_f32_16x16x32_bf16 v[68:71], v[104:107], v[172:175], v[68:71]
    buffer_load_dwordx4 v[200:203], v124, s[4:7], s55 offen offset:2048 sc1
    s_lshl_b32 s50, s42, 12
    s_add_u32 s50, s50, 147456
    v_add_u32 v14, s50, v1
    v_xor_b32 v15, 8192, v14
    v_mfma_f32_16x16x32_bf16 v[72:75], v[108:111], v[168:171], v[72:75]
    ds_read_b128 v[104:107], v4 offset:0
    v_mfma_f32_16x16x32_bf16 v[76:79], v[108:111], v[172:175], v[76:79]
    s_waitcnt lgkmcnt(3)
    v_mfma_f32_16x16x32_bf16 v[48:51], v[112:115], v[168:171], v[48:51]
    ds_read_b128 v[108:111], v4 offset:256
    v_mfma_f32_16x16x32_bf16 v[52:55], v[112:115], v[172:175], v[52:55]
    buffer_load_dwordx4 v[204:207], v124, s[4:7], s55 offen offset:2304 sc1
    v_mfma_f32_16x16x32_bf16 v[56:59], v[116:119], v[168:171], v[56:59]
    ds_read_b128 v[112:115], v7 offset:2048
    v_mfma_f32_16x16x32_bf16 v[60:63], v[116:119], v[172:175], v[60:63]
    s_waitcnt vmcnt(7) lgkmcnt(3)
    v_mfma_f32_16x16x32_bf16 v[64:67], v[96:99], v[176:179], v[64:67]
    ds_read_b128 v[116:119], v7 offset:2304
    s_waitcnt vmcnt(6)
    v_mfma_f32_16x16x32_bf16 v[68:71], v[96:99], v[180:183], v[68:71]
    s_add_u32 s55, s69, 102400
    buffer_load_dwordx4 v[208:211], v124, s[4:7], s55 offen offset:0 sc1
    v_mfma_f32_16x16x32_bf16 v[72:75], v[100:103], v[176:179], v[72:75]
    ds_read_b128 v[96:99], v4 offset:2048
    v_mfma_f32_16x16x32_bf16 v[76:79], v[100:103], v[180:183], v[76:79]
    s_waitcnt lgkmcnt(3)
    v_mfma_f32_16x16x32_bf16 v[48:51], v[104:107], v[176:179], v[48:51]
    ds_read_b128 v[100:103], v4 offset:2304
    v_mfma_f32_16x16x32_bf16 v[52:55], v[104:107], v[180:183], v[52:55]
    buffer_load_dwordx4 v[212:215], v124, s[4:7], s55 offen offset:256 sc1
    v_mfma_f32_16x16x32_bf16 v[56:59], v[108:111], v[176:179], v[56:59]
    ds_read_b128 v[104:107], v7 offset:16384
    v_mfma_f32_16x16x32_bf16 v[60:63], v[108:111], v[180:183], v[60:63]
    s_waitcnt vmcnt(7) lgkmcnt(3)
    v_mfma_f32_16x16x32_bf16 v[64:67], v[112:115], v[184:187], v[64:67]
    ds_read_b128 v[108:111], v7 offset:16640
    s_waitcnt vmcnt(6)
    v_mfma_f32_16x16x32_bf16 v[68:71], v[112:115], v[188:191], v[68:71]
    buffer_load_dwordx4 v[216:219], v124, s[4:7], s55 offen offset:2048 sc1
    v_mfma_f32_16x16x32_bf16 v[72:75], v[116:119], v[184:187], v[72:75]
    ds_read_b128 v[112:115], v7 offset:18432
    v_mfma_f32_16x16x32_bf16 v[76:79], v[116:119], v[188:191], v[76:79]
    s_waitcnt lgkmcnt(3)
    v_mfma_f32_16x16x32_bf16 v[48:51], v[96:99], v[184:187], v[48:51]
    ds_read_b128 v[116:119], v7 offset:18688
    v_mfma_f32_16x16x32_bf16 v[52:55], v[96:99], v[188:191], v[52:55]
    buffer_load_dwordx4 v[220:223], v124, s[4:7], s55 offen offset:2304 sc1
    v_mfma_f32_16x16x32_bf16 v[56:59], v[100:103], v[184:187], v[56:59]
    ds_read_b128 v[96:99], v7 offset:32768
    v_mfma_f32_16x16x32_bf16 v[60:63], v[100:103], v[188:191], v[60:63]
    s_waitcnt vmcnt(7) lgkmcnt(3)
    v_mfma_f32_16x16x32_bf16 v[64:67], v[104:107], v[192:195], v[64:67]
    ds_read_b128 v[100:103], v7 offset:33024
    s_waitcnt vmcnt(6)
    v_mfma_f32_16x16x32_bf16 v[68:71], v[104:107], v[196:199], v[68:71]
    v_mfma_f32_16x16x32_bf16 v[72:75], v[108:111], v[192:195], v[72:75]
    ds_read_b128 v[104:107], v7 offset:34816
    v_mfma_f32_16x16x32_bf16 v[76:79], v[108:111], v[196:199], v[76:79]
    s_waitcnt vmcnt(5) lgkmcnt(3)
    v_mfma_f32_16x16x32_bf16 v[64:67], v[112:115], v[200:203], v[64:67]
    ds_read_b128 v[108:111], v7 offset:35072
    s_waitcnt vmcnt(4)
    v_mfma_f32_16x16x32_bf16 v[68:71], v[112:115], v[204:207], v[68:71]
    v_mfma_f32_16x16x32_bf16 v[72:75], v[116:119], v[200:203], v[72:75]
    ds_read_b128 v[112:115], v4 offset:16384
    v_mfma_f32_16x16x32_bf16 v[76:79], v[116:119], v[204:207], v[76:79]
    s_waitcnt vmcnt(3) lgkmcnt(3)
    v_mfma_f32_16x16x32_bf16 v[64:67], v[96:99], v[208:211], v[64:67]
    ds_read_b128 v[116:119], v4 offset:16640
    s_waitcnt vmcnt(2)
    v_mfma_f32_16x16x32_bf16 v[68:71], v[96:99], v[212:215], v[68:71]
    v_mfma_f32_16x16x32_bf16 v[72:75], v[100:103], v[208:211], v[72:75]
    ds_read_b128 v[96:99], v4 offset:18432
    v_mfma_f32_16x16x32_bf16 v[76:79], v[100:103], v[212:215], v[76:79]
    s_waitcnt vmcnt(1) lgkmcnt(3)
    v_mfma_f32_16x16x32_bf16 v[64:67], v[104:107], v[216:219], v[64:67]
    ds_read_b128 v[100:103], v4 offset:18688
    s_waitcnt vmcnt(0)
    v_mfma_f32_16x16x32_bf16 v[68:71], v[104:107], v[220:223], v[68:71]
    v_mfma_f32_16x16x32_bf16 v[72:75], v[108:111], v[216:219], v[72:75]
    ds_read_b128 v[104:107], v4 offset:32768
    v_mfma_f32_16x16x32_bf16 v[76:79], v[108:111], v[220:223], v[76:79]
    s_waitcnt lgkmcnt(3)
    v_mfma_f32_16x16x32_bf16 v[48:51], v[112:115], v[192:195], v[48:51]
    ds_read_b128 v[108:111], v4 offset:33024
    v_mfma_f32_16x16x32_bf16 v[52:55], v[112:115], v[196:199], v[52:55]
    v_mfma_f32_16x16x32_bf16 v[56:59], v[116:119], v[192:195], v[56:59]
    ds_read_b128 v[112:115], v4 offset:34816
    ds_write_b128 v14, v[64:67] offset:0
    v_mfma_f32_16x16x32_bf16 v[60:63], v[116:119], v[196:199], v[60:63]
    ds_write_b128 v14, v[68:71] offset:1024
    s_waitcnt lgkmcnt(5)
    v_mfma_f32_16x16x32_bf16 v[48:51], v[96:99], v[200:203], v[48:51]
    ds_read_b128 v[116:119], v4 offset:35072
    ds_write_b128 v14, v[72:75] offset:2048
    v_mfma_f32_16x16x32_bf16 v[52:55], v[96:99], v[204:207], v[52:55]
    ds_write_b128 v14, v[76:79] offset:3072
    v_mfma_f32_16x16x32_bf16 v[56:59], v[100:103], v[200:203], v[56:59]
    v_mfma_f32_16x16x32_bf16 v[60:63], v[100:103], v[204:207], v[60:63]
    s_waitcnt lgkmcnt(6)
    v_mfma_f32_16x16x32_bf16 v[48:51], v[104:107], v[208:211], v[48:51]
    v_mfma_f32_16x16x32_bf16 v[52:55], v[104:107], v[212:215], v[52:55]
    s_waitcnt lgkmcnt(0)
    s_barrier
    ds_read_b128 v[64:67], v15 offset:0
    ds_read_b128 v[68:71], v15 offset:1024
    ds_read_b128 v[72:75], v15 offset:2048
    ds_read_b128 v[76:79], v15 offset:3072
    v_mfma_f32_16x16x32_bf16 v[56:59], v[108:111], v[208:211], v[56:59]
    v_mfma_f32_16x16x32_bf16 v[60:63], v[108:111], v[212:215], v[60:63]
    v_mfma_f32_16x16x32_bf16 v[48:51], v[112:115], v[216:219], v[48:51]
    v_mfma_f32_16x16x32_bf16 v[52:55], v[112:115], v[220:223], v[52:55]
    v_mfma_f32_16x16x32_bf16 v[56:59], v[116:119], v[216:219], v[56:59]
    v_mfma_f32_16x16x32_bf16 v[60:63], v[116:119], v[220:223], v[60:63]
    s_nop 4
    v_pk_add_f32 v[48:49], v[48:49], v[32:33]
    v_pk_add_f32 v[50:51], v[50:51], v[34:35]
    v_pk_add_f32 v[52:53], v[52:53], v[36:37]
    v_pk_add_f32 v[54:55], v[54:55], v[38:39]
    v_pk_add_f32 v[56:57], v[56:57], v[40:41]
    v_pk_add_f32 v[58:59], v[58:59], v[42:43]
    v_pk_add_f32 v[60:61], v[60:61], v[44:45]
    v_pk_add_f32 v[62:63], v[62:63], v[46:47]
    s_waitcnt lgkmcnt(3)
    v_pk_add_f32 v[48:49], v[48:49], v[64:65]
    v_pk_add_f32 v[50:51], v[50:51], v[66:67]
    v_cvt_pk_bf16_f32 v20, v48, v49
    v_cvt_pk_bf16_f32 v21, v50, v51
    s_waitcnt lgkmcnt(2)
    v_pk_add_f32 v[52:53], v[52:53], v[68:69]
    v_pk_add_f32 v[54:55], v[54:55], v[70:71]
    v_cvt_pk_bf16_f32 v22, v52, v53
    v_cvt_pk_bf16_f32 v23, v54, v55
    s_waitcnt lgkmcnt(1)
    v_pk_add_f32 v[56:57], v[56:57], v[72:73]
    v_pk_add_f32 v[58:59], v[58:59], v[74:75]
    v_cvt_pk_bf16_f32 v24, v56, v57
    v_cvt_pk_bf16_f32 v25, v58, v59
    s_waitcnt lgkmcnt(0)
    v_pk_add_f32 v[60:61], v[60:61], v[76:77]
    v_pk_add_f32 v[62:63], v[62:63], v[78:79]
    v_cvt_pk_bf16_f32 v26, v60, v61
    v_cvt_pk_bf16_f32 v27, v62, v63
    s_cmp_lg_u32 s44, 0
    s_cbranch_scc1 L_final
    v_permlane32_swap_b32 v20, v22
    v_permlane32_swap_b32 v21, v23
    buffer_store_dwordx4 v[20:23], v125, s[4:7], s66 offen offset:0
    v_permlane32_swap_b32 v24, v26
    v_permlane32_swap_b32 v25, v27
    buffer_store_dwordx4 v[24:27], v125, s[4:7], s66 offen offset:1024
    v_pk_add_f32 v[64:65], v[48:49], v[50:51]
    v_pk_mul_f32 v[66:67], v[48:49], v[48:49]
    v_pk_fma_f32 v[66:67], v[50:51], v[50:51], v[66:67]
    v_pk_add_f32 v[64:65], v[64:65], v[56:57]
    v_pk_fma_f32 v[66:67], v[56:57], v[56:57], v[66:67]
    v_pk_add_f32 v[64:65], v[64:65], v[58:59]
    v_pk_fma_f32 v[66:67], v[58:59], v[58:59], v[66:67]
    v_add_f32 v64, v64, v65
    v_add_f32 v66, v66, v67
    v_pk_add_f32 v[68:69], v[52:53], v[54:55]
    v_pk_mul_f32 v[70:71], v[52:53], v[52:53]
    v_pk_fma_f32 v[70:71], v[54:55], v[54:55], v[70:71]
    v_pk_add_f32 v[68:69], v[68:69], v[60:61]
    v_pk_fma_f32 v[70:71], v[60:61], v[60:61], v[70:71]
    v_pk_add_f32 v[68:69], v[68:69], v[62:63]
    v_pk_fma_f32 v[70:71], v[62:63], v[62:63], v[70:71]
    v_add_f32 v68, v68, v69
    v_add_f32 v70, v70, v71
    v_permlane32_swap_b32 v64, v66
    s_nop 0
    v_permlane32_swap_b32 v68, v70
    v_add_f32 v64, v64, v66
    v_add_f32 v68, v68, v70
    s_nop 1
    v_permlane16_swap_b32 v64, v68
    v_add_f32 v64, v64, v68
    buffer_store_dword v64, v1, s[4:7], s67 offen
    s_and_b32 s51, s41, 1
    s_lshl_b32 s51, s51, 2
    s_add_u32 s51, s51, s42
    v_and_b32 v14, 7, v0
    v_lshlrev_b32 v14, 2, v14
    v_and_b32 v15, 8, v0
    v_lshlrev_b32 v15, 5, v15
    s_lshr_b32 s50, s51, 1
    s_lshl_b32 s50, s50, 5
    s_and_b32 s57, s51, 1
    s_lshl_b32 s57, s57, 7
    s_add_u32 s50, s50, s57
    v_add3_u32 v14, v14, v15, s50
    v_add_u32 v9, 46080, v1
    v_and_b32 v12, 0x300, v1
    v_add_u32 v10, v12, v1
    v_lshrrev_b32 v12, 5, v0
    v_lshl_add_u32 v12, v12, 11, v10
    v_add_u32 v12, 49152, v12
    v_add_u32 v13, 49152, v12
    s_add_u32 s56, s49, 4
    v_mov_b32 v11, s56
    s_mov_b64 exec, 1
    s_cmp_lg_u32 s45, 0
    s_cbranch_scc1 pubs_24
    s_waitcnt vmcnt(0)
    buffer_store_dword v11, off, s[4:7], s48
pubd_25:
    s_mov_b64 exec, -1
    s_lshl_b32 s57, s40, 3
    s_add_u32 s51, s51, s57
    s_and_b32 s64, s41, 30
    s_lshl_b32 s64, s64, 17
    s_lshl_b32 s57, s51, 11
    s_add_u32 s64, s64, s57
    s_add_u32 s64, s64, 20971520
    s_mul_i32 s65, s51, 114688
    s_and_b32 s57, s41, 30
    s_lshl_b32 s57, s57, 10
    s_add_u32 s65, s65, s57
    s_add_u32 s65, s65, 2097152
    s_and_b32 s43, s41, 30
    s_lshl_b32 s43, s43, 10
    s_add_u32 s43, s43, s65
    s_add_u32 s43, s43, 32768
    s_add_u32 s59, s59, 4194304
    v_lshrrev_b32 v29, 5, v0
    v_and_b32 v30, 0xf0, v1
    v_lshl_add_u32 v30, v29, 8, v30
    v_bfe_u32 v28, v0, 4, 1
    v_lshl_add_u32 v24, v28, 9, v30
    v_and_b32 v2, 0x330, v24
    v_and_b32 v31, 0x1f0, v1
    v_lshl_add_u32 v3, v29, 17, v31
    v_lshl_add_u32 v4, v29, 11, v31
    v_bfe_u32 v31, v0, 2, 1
    v_lshl_add_u32 v2, v31, 7, v2
    v_bfe_u32 v31, v0, 3, 1
    v_lshl_add_u32 v2, v31, 6, v2
    s_lshl_b32 s50, s42, 3
    s_add_u32 s50, s50, 130752
    v_lshl_add_u32 v5, v29, 2, s50
    s_waitcnt lgkmcnt(0)
    s_barrier
    ds_read_b128 v[80:83], v12 offset:1024
    ds_read_b128 v[84:87], v12 offset:2048
    ds_read_b128 v[88:91], v12 offset:0
    ds_read_b128 v[92:95], v12 offset:1280
    ds_read_b128 v[96:99], v12 offset:2304
    ds_read_b128 v[100:103], v12 offset:256
    s_add_u32 s56, s49, 4
pl_26:
    buffer_load_dword v15, v14, s[4:7], s47 offen sc1
    s_sub_u32 s46, s46, 1
    s_cbranch_scc1 pt_27
    s_cmp_lg_u32 s45, 0
    s_waitcnt vmcnt(0)
    v_cmp_gt_u32 vcc, s56, v15
    s_cbranch_vccnz pl_26
    s_cbranch_scc1 pa_28
pd_29:
    buffer_load_dwordx4 v[128:131], v10, s[4:7], s22 offen offset:0 sc1
    buffer_load_dwordx4 v[132:135], v10, s[4:7], s22 offen offset:256 sc1
    buffer_load_dwordx4 v[136:139], v10, s[4:7], s22 offen offset:2048 sc1
    buffer_load_dwordx4 v[140:143], v10, s[4:7], s22 offen offset:2304 sc1
    s_waitcnt vmcnt(3) lgkmcnt(4)
    v_mfma_f32_16x16x32_bf16 v[48:51], v[80:83], v[128:131], 0
    s_waitcnt vmcnt(2)
    v_mfma_f32_16x16x32_bf16 v[52:55], v[80:83], v[132:135], 0
    buffer_load_dwordx4 v[144:147], v10, s[4:7], s23 offen offset:0 sc1
    v_mfma_f32_16x16x32_bf16 v[64:67], v[128:131], v[84:87], 0
    ds_read_b128 v[80:83], v12 offset:7168
    v_mfma_f32_16x16x32_bf16 v[72:75], v[132:135], v[84:87], 0
    s_waitcnt lgkmcnt(3)
    v_mfma_f32_16x16x32_bf16 v[32:35], v[88:91], v[128:131], 0
    ds_read_b128 v[84:87], v12 offset:8192
    v_mfma_f32_16x16x32_bf16 v[36:39], v[88:91], v[132:135], 0
    buffer_load_dwordx4 v[148:151], v10, s[4:7], s23 offen offset:256 sc1
    v_mfma_f32_16x16x32_bf16 v[56:59], v[92:95], v[128:131], 0
    ds_read_b128 v[88:91], v12 offset:6144
    v_mfma_f32_16x16x32_bf16 v[60:63], v[92:95], v[132:135], 0
    buffer_load_dwordx4 v[152:155], v10, s[4:7], s23 offen offset:2048 sc1
    s_waitcnt lgkmcnt(3)
    v_mfma_f32_16x16x32_bf16 v[68:71], v[128:131], v[96:99], 0
    ds_read_b128 v[92:95], v12 offset:7424
    v_mfma_f32_16x16x32_bf16 v[76:79], v[132:135], v[96:99], 0
    buffer_load_dwordx4 v[156:159], v10, s[4:7], s23 offen offset:2304 sc1
    v_mfma_f32_16x16x32_bf16 v[40:43], v[100:103], v[128:131], 0
    ds_read_b128 v[96:99], v12 offset:8448
    v_mfma_f32_16x16x32_bf16 v[44:47], v[100:103], v[132:135], 0
    s_waitcnt vmcnt(5) lgkmcnt(3)
    v_mfma_f32_16x16x32_bf16 v[48:51], v[80:83], v[136:139], v[48:51]
    ds_read_b128 v[100:103], v12 offset:6400
    s_waitcnt vmcnt(4)
    v_mfma_f32_16x16x32_bf16 v[52:55], v[80:83], v[140:143], v[52:55]
    s_add_u32 s54, s62, 0
    buffer_load_dwordx4 v[104:107], v1, s[4:7], s54 offen offset:0 sc1
    v_mfma_f32_16x16x32_bf16 v[64:67], v[136:139], v[84:87], v[64:67]
    ds_read_b128 v[80:83], v12 offset:13312
    v_mfma_f32_16x16x32_bf16 v[72:75], v[140:143], v[84:87], v[72:75]
    s_waitcnt lgkmcnt(3)
    v_mfma_f32_16x16x32_bf16 v[32:35], v[88:91], v[136:139], v[32:35]
    ds_read_b128 v[84:87], v12 offset:14336
    v_mfma_f32_16x16x32_bf16 v[36:39], v[88:91], v[140:143], v[36:39]
    buffer_load_dwordx4 v[160:163], v10, s[4:7], s24 offen offset:0 sc1
    v_mfma_f32_16x16x32_bf16 v[56:59], v[92:95], v[136:139], v[56:59]
    ds_read_b128 v[88:91], v12 offset:12288
    v_mfma_f32_16x16x32_bf16 v[60:63], v[92:95], v[140:143], v[60:63]
    buffer_load_dwordx4 v[108:111], v1, s[4:7], s54 offen offset:1024 sc1
    s_waitcnt lgkmcnt(3)
    v_mfma_f32_16x16x32_bf16 v[68:71], v[136:139], v[96:99], v[68:71]
    ds_read_b128 v[92:95], v12 offset:13568
    v_mfma_f32_16x16x32_bf16 v[76:79], v[140:143], v[96:99], v[76:79]
    buffer_load_dwordx4 v[164:167], v10, s[4:7], s24 offen offset:256 sc1
    v_mfma_f32_16x16x32_bf16 v[40:43], v[100:103], v[136:139], v[40:43]
    ds_read_b128 v[96:99], v12 offset:14592
    v_mfma_f32_16x16x32_bf16 v[44:47], v[100:103], v[140:143], v[44:47]
    s_waitcnt vmcnt(7) lgkmcnt(3)
    v_mfma_f32_16x16x32_bf16 v[48:51], v[80:83], v[144:147], v[48:51]
    ds_read_b128 v[100:103], v12 offset:12544
    s_waitcnt vmcnt(6)
    v_mfma_f32_16x16x32_bf16 v[52:55], v[80:83], v[148:151], v[52:55]
    buffer_load_dwordx4 v[112:115], v1, s[4:7], s54 offen offset:2048 sc1
    v_mfma_f32_16x16x32_bf16 v[64:67], v[144:147], v[84:87], v[64:67]
    ds_read_b128 v[80:83], v12 offset:19456
    v_mfma_f32_16x16x32_bf16 v[72:75], v[148:151], v[84:87], v[72:75]
    s_waitcnt lgkmcnt(3)
    v_mfma_f32_16x16x32_bf16 v[32:35], v[88:91], v[144:147], v[32:35]
    ds_read_b128 v[84:87], v12 offset:20480
    v_mfma_f32_16x16x32_bf16 v[36:39], v[88:91], v[148:151], v[36:39]
    buffer_load_dwordx4 v[168:171], v10, s[4:7], s24 offen offset:2048 sc1
    v_mfma_f32_16x16x32_bf16 v[56:59], v[92:95], v[144:147], v[56:59]
    ds_read_b128 v[88:91], v12 offset:18432
    v_mfma_f32_16x16x32_bf16 v[60:63], v[92:95], v[148:151], v[60:63]
    s_waitcnt lgkmcnt(3)
    v_mfma_f32_16x16x32_bf16 v[68:71], v[144:147], v[96:99], v[68:71]
    ds_read_b128 v[92:95], v12 offset:19712
    v_mfma_f32_16x16x32_bf16 v[76:79], v[148:151], v[96:99], v[76:79]
    v_mfma_f32_16x16x32_bf16 v[40:43], v[100:103], v[144:147], v[40:43]
    ds_read_b128 v[96:99], v12 offset:20736
    v_mfma_f32_16x16x32_bf16 v[44:47], v[100:103], v[148:151], v[44:47]
    s_waitcnt vmcnt(7) lgkmcnt(3)
    v_mfma_f32_16x16x32_bf16 v[48:51], v[80:83], v[152:155], v[48:51]
    ds_read_b128 v[100:103], v12 offset:18688
    s_waitcnt vmcnt(6)
    v_mfma_f32_16x16x32_bf16 v[52:55], v[80:83], v[156:159], v[52:55]
    buffer_load_dwordx4 v[116:119], v1, s[4:7], s54 offen offset:3072 sc1
    v_mfma_f32_16x16x32_bf16 v[64:67], v[152:155], v[84:87], v[64:67]
    ds_read_b128 v[80:83], v12 offset:25600
    v_mfma_f32_16x16x32_bf16 v[72:75], v[156:159], v[84:87], v[72:75]
    s_waitcnt lgkmcnt(3)
    v_mfma_f32_16x16x32_bf16 v[32:35], v[88:91], v[152:155], v[32:35]
    ds_read_b128 v[84:87], v12 offset:26624
    v_mfma_f32_16x16x32_bf16 v[36:39], v[88:91], v[156:159], v[36:39]
    buffer_load_dwordx4 v[172:175], v10, s[4:7], s24 offen offset:2304 sc1
    v_mfma_f32_16x16x32_bf16 v[56:59], v[92:95], v[152:155], v[56:59]
    ds_read_b128 v[88:91], v12 offset:24576
    v_mfma_f32_16x16x32_bf16 v[60:63], v[92:95], v[156:159], v[60:63]
    s_waitcnt lgkmcnt(3)
    v_mfma_f32_16x16x32_bf16 v[68:71], v[152:155], v[96:99], v[68:71]
    ds_read_b128 v[92:95], v12 offset:25856
    v_mfma_f32_16x16x32_bf16 v[76:79], v[156:159], v[96:99], v[76:79]
    v_mfma_f32_16x16x32_bf16 v[40:43], v[100:103], v[152:155], v[40:43]
    ds_read_b128 v[96:99], v12 offset:26880
    v_mfma_f32_16x16x32_bf16 v[44:47], v[100:103], v[156:159], v[44:47]
    s_waitcnt vmcnt(6) lgkmcnt(3)
    v_mfma_f32_16x16x32_bf16 v[48:51], v[80:83], v[160:163], v[48:51]
    ds_read_b128 v[100:103], v12 offset:24832
    s_waitcnt vmcnt(4)
    v_mfma_f32_16x16x32_bf16 v[52:55], v[80:83], v[164:167], v[52:55]
    buffer_load_dwordx4 v[176:179], v10, s[4:7], s25 offen offset:0 sc1
    v_mfma_f32_16x16x32_bf16 v[64:67], v[160:163], v[84:87], v[64:67]
    ds_read_b128 v[80:83], v12 offset:31744
    v_mfma_f32_16x16x32_bf16 v[72:75], v[164:167], v[84:87], v[72:75]
    s_waitcnt lgkmcnt(3)
    v_mfma_f32_16x16x32_bf16 v[32:35], v[88:91], v[160:163], v[32:35]
    ds_read_b128 v[84:87], v12 offset:32768
    v_mfma_f32_16x16x32_bf16 v[36:39], v[88:91], v[164:167], v[36:39]
    buffer_load_dwordx4 v[180:183], v10, s[4:7], s25 offen offset:256 sc1
    v_mfma_f32_16x16x32_bf16 v[56:59], v[92:95], v[160:163], v[56:59]
    ds_read_b128 v[88:91], v12 offset:30720
    v_mfma_f32_16x16x32_bf16 v[60:63], v[92:95], v[164:167], v[60:63]
    buffer_load_dwordx4 v[184:187], v10, s[4:7], s25 offen offset:2048 sc1
    s_waitcnt lgkmcnt(3)
    v_mfma_f32_16x16x32_bf16 v[68:71], v[160:163], v[96:99], v[68:71]
    ds_read_b128 v[92:95], v12 offset:32000
    v_mfma_f32_16x16x32_bf16 v[76:79], v[164:167], v[96:99], v[76:79]
    buffer_load_dwordx4 v[188:191], v10, s[4:7], s25 offen offset:2304 sc1
    v_mfma_f32_16x16x32_bf16 v[40:43], v[100:103], v[160:163], v[40:43]
    ds_read_b128 v[96:99], v12 offset:33024
    v_mfma_f32_16x16x32_bf16 v[44:47], v[100:103], v[164:167], v[44:47]
    s_waitcnt vmcnt(6) lgkmcnt(3)
    v_mfma_f32_16x16x32_bf16 v[48:51], v[80:83], v[168:171], v[48:51]
    ds_read_b128 v[100:103], v12 offset:30976
    s_waitcnt vmcnt(4)
    v_mfma_f32_16x16x32_bf16 v[52:55], v[80:83], v[172:175], v[52:55]
    buffer_load_dwordx4 v[192:195], v10, s[4:7], s26 offen offset:0 sc1
    v_mfma_f32_16x16x32_bf16 v[64:67], v[168:171], v[84:87], v[64:67]
    ds_read_b128 v[80:83], v12 offset:37888
    v_mfma_f32_16x16x32_bf16 v[72:75], v[172:175], v[84:87], v[72:75]
    s_waitcnt lgkmcnt(3)
    v_mfma_f32_16x16x32_bf16 v[32:35], v[88:91], v[168:171], v[32:35]
    ds_read_b128 v[84:87], v12 offset:38912
    v_mfma_f32_16x16x32_bf16 v[36:39], v[88:91], v[172:175], v[36:39]
    buffer_load_dwordx4 v[196:199], v10, s[4:7], s26 offen offset:256 sc1
    v_mfma_f32_16x16x32_bf16 v[56:59], v[92:95], v[168:171], v[56:59]
    ds_read_b128 v[88:91], v12 offset:36864
    v_mfma_f32_16x16x32_bf16 v[60:63], v[92:95], v[172:175], v[60:63]
    buffer_load_dwordx4 v[200:203], v10, s[4:7], s26 offen offset:2048 sc1
    s_waitcnt lgkmcnt(3)
    v_mfma_f32_16x16x32_bf16 v[68:71], v[168:171], v[96:99], v[68:71]
    ds_read_b128 v[92:95], v12 offset:38144
    v_mfma_f32_16x16x32_bf16 v[76:79], v[172:175], v[96:99], v[76:79]
    buffer_load_dwordx4 v[204:207], v10, s[4:7], s26 offen offset:2304 sc1
    v_mfma_f32_16x16x32_bf16 v[40:43], v[100:103], v[168:171], v[40:43]
    ds_read_b128 v[96:99], v12 offset:39168
    v_mfma_f32_16x16x32_bf16 v[44:47], v[100:103], v[172:175], v[44:47]
    s_waitcnt vmcnt(7) lgkmcnt(3)
    v_mfma_f32_16x16x32_bf16 v[48:51], v[80:83], v[176:179], v[48:51]
    ds_read_b128 v[100:103], v12 offset:37120
    s_waitcnt vmcnt(6)
    v_mfma_f32_16x16x32_bf16 v[52:55], v[80:83], v[180:183], v[52:55]
    buffer_load_dwordx4 v[208:211], v10, s[4:7], s27 offen offset:0 sc1
    v_mfma_f32_16x16x32_bf16 v[64:67], v[176:179], v[84:87], v[64:67]
    ds_read_b128 v[80:83], v12 offset:44032
    v_mfma_f32_16x16x32_bf16 v[72:75], v[180:183], v[84:87], v[72:75]
    s_waitcnt lgkmcnt(3)
    v_mfma_f32_16x16x32_bf16 v[32:35], v[88:91], v[176:179], v[32:35]
    ds_read_b128 v[84:87], v12 offset:45056
    v_mfma_f32_16x16x32_bf16 v[36:39], v[88:91], v[180:183], v[36:39]
    buffer_load_dwordx4 v[212:215], v10, s[4:7], s27 offen offset:256 sc1
    v_mfma_f32_16x16x32_bf16 v[56:59], v[92:95], v[176:179], v[56:59]
    ds_read_b128 v[88:91], v12 offset:43008
    v_mfma_f32_16x16x32_bf16 v[60:63], v[92:95], v[180:183], v[60:63]
    v_add_f32 v104, v104, v112
    v_add_f32 v105, v105, v113
    s_waitcnt lgkmcnt(3)
    v_mfma_f32_16x16x32_bf16 v[68:71], v[176:179], v[96:99], v[68:71]
    ds_read_b128 v[92:95], v12 offset:44288
    v_mfma_f32_16x16x32_bf16 v[76:79], v[180:183], v[96:99], v[76:79]
    v_add_f32 v106, v106, v114
    v_mfma_f32_16x16x32_bf16 v[40:43], v[100:103], v[176:179], v[40:43]
    ds_read_b128 v[96:99], v12 offset:45312
    v_add_f32 v107, v107, v115
    v_mfma_f32_16x16x32_bf16 v[44:47], v[100:103], v[180:183], v[44:47]
    v_add_f32 v108, v108, v116
    s_waitcnt vmcnt(7) lgkmcnt(3)
    v_mfma_f32_16x16x32_bf16 v[48:51], v[80:83], v[184:187], v[48:51]
    ds_read_b128 v[100:103], v12 offset:43264
    s_waitcnt vmcnt(6)
    v_mfma_f32_16x16x32_bf16 v[52:55], v[80:83], v[188:191], v[52:55]
    buffer_load_dwordx4 v[216:219], v10, s[4:7], s27 offen offset:2048 sc1
    v_add_f32 v109, v109, v117
    v_mfma_f32_16x16x32_bf16 v[64:67], v[184:187], v[84:87], v[64:67]
    ds_read_b128 v[80:83], v13 offset:1024
    v_add_f32 v110, v110, v118
    v_mfma_f32_16x16x32_bf16 v[72:75], v[188:191], v[84:87], v[72:75]
    v_add_f32 v111, v111, v119
    s_waitcnt lgkmcnt(3)
    v_mfma_f32_16x16x32_bf16 v[32:35], v[88:91], v[184:187], v[32:35]
    ds_read_b128 v[84:87], v13 offset:2048
    buffer_load_dwordx4 v[220:223], v10, s[4:7], s27 offen offset:2304 sc1
    v_mfma_f32_16x16x32_bf16 v[36:39], v[88:91], v[188:191], v[36:39]
    v_add_f32 v104, v104, v108
    v_add_f32 v105, v105, v109
    v_mfma_f32_16x16x32_bf16 v[56:59], v[92:95], v[184:187], v[56:59]
    ds_read_b128 v[88:91], v13 offset:1280
    v_mfma_f32_16x16x32_bf16 v[60:63], v[92:95], v[188:191], v[60:63]
    v_add_f32 v106, v106, v110
    s_waitcnt lgkmcnt(3)
    v_mfma_f32_16x16x32_bf16 v[68:71], v[184:187], v[96:99], v[68:71]
    ds_read_b128 v[92:95], v13 offset:2304
    v_mfma_f32_16x16x32_bf16 v[76:79], v[188:191], v[96:99], v[76:79]
    v_add_f32 v107, v107, v111
    v_add_f32 v104, v104, v106
    v_mfma_f32_16x16x32_bf16 v[40:43], v[100:103], v[184:187], v[40:43]
    ds_read_b128 v[96:99], v13 offset:7168
    v_mfma_f32_16x16x32_bf16 v[44:47], v[100:103], v[188:191], v[44:47]
    v_add_f32 v105, v105, v107
    s_waitcnt vmcnt(7) lgkmcnt(3)
    v_mfma_f32_16x16x32_bf16 v[48:51], v[80:83], v[192:195], v[48:51]
    ds_read_b128 v[100:103], v13 offset:8192
    s_waitcnt vmcnt(6)
    v_mfma_f32_16x16x32_bf16 v[52:55], v[80:83], v[196:199], v[52:55]
    buffer_load_dwordx4 v[224:227], v10, s[4:7], s28 offen offset:0 sc1
    v_add_f32 v104, v104, v105
    v_mov_b32 v105, v104
    v_mfma_f32_16x16x32_bf16 v[64:67], v[192:195], v[84:87], v[64:67]
    ds_read_b128 v[80:83], v13 offset:7424
    buffer_load_dwordx4 v[228:231], v10, s[4:7], s28 offen offset:256 sc1
    v_mfma_f32_16x16x32_bf16 v[72:75], v[196:199], v[84:87], v[72:75]
    v_mov_b32 v106, 0x3b000000
    v_permlane32_swap_b32 v104, v105
    s_waitcnt lgkmcnt(3)
    v_mfma_f32_16x16x32_bf16 v[56:59], v[88:91], v[192:195], v[56:59]
    ds_read_b128 v[84:87], v13 offset:8448
    v_mfma_f32_16x16x32_bf16 v[60:63], v[88:91], v[196:199], v[60:63]
    v_mul_f32 v104, 0xbb000000, v104
    v_mfma_f32_16x16x32_bf16 v[68:71], v[192:195], v[92:95], v[68:71]
    ds_read_b128 v[88:91], v13 offset:13312
    v_mul_f32 v107, v104, v104
    v_mfma_f32_16x16x32_bf16 v[76:79], v[196:199], v[92:95], v[76:79]
    v_fma_f32 v20, v105, v106, -v107
    s_waitcnt vmcnt(7) lgkmcnt(3)
    v_mfma_f32_16x16x32_bf16 v[48:51], v[96:99], v[200:203], v[48:51]
    ds_read_b128 v[92:95], v13 offset:14336
    s_waitcnt vmcnt(6)
    v_mfma_f32_16x16x32_bf16 v[52:55], v[96:99], v[204:207], v[52:55]
    buffer_load_dwordx4 v[232:235], v10, s[4:7], s28 offen offset:2048 sc1
    v_cvt_pk_bf16_f32 v107, v104, v104
    v_mfma_f32_16x16x32_bf16 v[64:67], v[200:203], v[100:103], v[64:67]
    ds_read_b128 v[96:99], v13 offset:13568
    buffer_load_dwordx4 v[236:239], v10, s[4:7], s28 offen offset:2304 sc1
    v_mfma_f32_16x16x32_bf16 v[72:75], v[204:207], v[100:103], v[72:75]
    v_max_f32 v20, 0, v20
    v_and_b32 v107, 0xffff0000, v107
    s_waitcnt lgkmcnt(3)
    v_mfma_f32_16x16x32_bf16 v[56:59], v[80:83], v[200:203], v[56:59]
    ds_read_b128 v[100:103], v13 offset:14592
    v_mfma_f32_16x16x32_bf16 v[60:63], v[80:83], v[204:207], v[60:63]
    v_add_f32 v20, 0x3727c5ac, v20
    v_mfma_f32_16x16x32_bf16 v[68:71], v[200:203], v[84:87], v[68:71]
    ds_read_b128 v[80:83], v13 offset:19456
    v_sub_f32 v107, v104, v107
    v_mfma_f32_16x16x32_bf16 v[76:79], v[204:207], v[84:87], v[76:79]
    v_rsq_f32 v6, v20
    s_waitcnt vmcnt(7) lgkmcnt(3)
    v_mfma_f32_16x16x32_bf16 v[48:51], v[88:91], v[208:211], v[48:51]
    ds_read_b128 v[84:87], v13 offset:20480
    s_waitcnt vmcnt(6)
    v_mfma_f32_16x16x32_bf16 v[52:55], v[88:91], v[212:215], v[52:55]
    buffer_load_dwordx4 v[240:243], v10, s[4:7], s29 offen offset:0 sc1
    v_cvt_pk_bf16_f32 v28, v104, v107
    v_mfma_f32_16x16x32_bf16 v[64:67], v[208:211], v[92:95], v[64:67]
    ds_read_b128 v[88:91], v13 offset:19712
    buffer_load_dwordx4 v[244:247], v10, s[4:7], s29 offen offset:256 sc1
    v_mfma_f32_16x16x32_bf16 v[72:75], v[212:215], v[92:95], v[72:75]
    v_cvt_pk_bf16_f32 v29, v104, v107
    s_waitcnt lgkmcnt(3)
    v_mfma_f32_16x16x32_bf16 v[56:59], v[96:99], v[208:211], v[56:59]
    ds_read_b128 v[92:95], v13 offset:20736
    v_mfma_f32_16x16x32_bf16 v[60:63], v[96:99], v[212:215], v[60:63]
    v_cvt_pk_bf16_f32 v30, v104, v107
    v_cvt_pk_bf16_f32 v31, v104, v107
    v_mfma_f32_16x16x32_bf16 v[68:71], v[208:211], v[100:103], v[68:71]
    ds_read_b128 v[96:99], v13 offset:25600
    v_mfma_f32_16x16x32_bf16 v[76:79], v[212:215], v[100:103], v[76:79]
    s_lshl_b32 s50, s42, 7
    s_waitcnt vmcnt(7) lgkmcnt(3)
    v_mfma_f32_16x16x32_bf16 v[48:51], v[80:83], v[216:219], v[48:51]
    ds_read_b128 v[100:103], v13 offset:26624
    s_waitcnt vmcnt(6)
    v_mfma_f32_16x16x32_bf16 v[52:55], v[80:83], v[220:223], v[52:55]
    buffer_load_dwordx4 v[248:251], v10, s[4:7], s29 offen offset:2048 sc1
    v_and_b32 v26, 31, v0
    v_lshl_add_u32 v26, v26, 2, s50
    ds_write_b32 v26, v6
    v_mfma_f32_16x16x32_bf16 v[64:67], v[216:219], v[84:87], v[64:67]
    ds_read_b128 v[80:83], v13 offset:25856
    buffer_load_dwordx4 v[252:255], v10, s[4:7], s29 offen offset:2304 sc1
    v_mfma_f32_16x16x32_bf16 v[72:75], v[220:223], v[84:87], v[72:75]
    v_lshrrev_b32 v27, 4, v0
    v_lshl_add_u32 v27, v27, 4, s50
    s_waitcnt lgkmcnt(4)
    v_mfma_f32_16x16x32_bf16 v[56:59], v[88:91], v[216:219], v[56:59]
    ds_read_b128 v[84:87], v13 offset:26880
    ds_read_b128 v[120:123], v27 offset:0
    v_mfma_f32_16x16x32_bf16 v[60:63], v[88:91], v[220:223], v[60:63]
    ds_read_b128 v[124:127], v27 offset:64
    v_mov_b32 v8, v6
    v_mfma_f32_16x16x32_bf16 v[68:71], v[216:219], v[92:95], v[68:71]
    ds_read_b128 v[88:91], v9 offset:1024
    v_permlane16_swap_b32 v28, v30
    v_mfma_f32_16x16x32_bf16 v[76:79], v[220:223], v[92:95], v[76:79]
    v_permlane16_swap_b32 v29, v31
    s_waitcnt vmcnt(7) lgkmcnt(6)
    v_mfma_f32_16x16x32_bf16 v[48:51], v[96:99], v[224:227], v[48:51]
    ds_read_b128 v[92:95], v9 offset:2048
    s_waitcnt vmcnt(6)
    v_mfma_f32_16x16x32_bf16 v[52:55], v[96:99], v[228:231], v[52:55]
    v_permlane16_swap_b32 v6, v8
    v_mfma_f32_16x16x32_bf16 v[64:67], v[224:227], v[100:103], v[64:67]
    ds_read_b128 v[96:99], v13 offset:31744
    v_mul_f32 v22, 0x3eb8aa3b, v8
    v_mfma_f32_16x16x32_bf16 v[72:75], v[228:231], v[100:103], v[72:75]
    v_mul_f32 v20, 0x3eb8aa3b, v6
    s_waitcnt lgkmcnt(5)
    v_mfma_f32_16x16x32_bf16 v[56:59], v[80:83], v[224:227], v[56:59]
    ds_read_b128 v[100:103], v13 offset:32768
    v_mfma_f32_16x16x32_bf16 v[60:63], v[80:83], v[228:231], v[60:63]
    v_mfma_f32_16x16x32_bf16 v[68:71], v[224:227], v[84:87], v[68:71]
    ds_read_b128 v[80:83], v13 offset:32000
    v_mfma_f32_16x16x32_bf16 v[76:79], v[228:231], v[84:87], v[76:79]
    s_waitcnt lgkmcnt(3)
    v_mfma_f32_16x16x16_bf16 v[48:51], v[88:89], v[28:29], v[48:51]
    v_mfma_f32_16x16x16_bf16 v[52:55], v[88:89], v[30:31], v[52:55]
    v_mfma_f32_16x16x16_bf16 v[56:59], v[90:91], v[28:29], v[56:59]
    v_mfma_f32_16x16x16_bf16 v[60:63], v[90:91], v[30:31], v[60:63]
    ds_read_b128 v[84:87], v13 offset:33024
    ds_read_b128 v[88:91], v13 offset:37888
    v_mfma_f32_16x16x16_bf16 v[64:67], v[28:29], v[92:93], v[64:67]
    v_mfma_f32_16x16x16_bf16 v[72:75], v[30:31], v[92:93], v[72:75]
    v_mfma_f32_16x16x16_bf16 v[68:71], v[28:29], v[94:95], v[68:71]
    v_mfma_f32_16x16x16_bf16 v[76:79], v[30:31], v[94:95], v[76:79]
    ds_read_b128 v[92:95], v13 offset:38912
    s_waitcnt vmcnt(5) lgkmcnt(4)
    v_mfma_f32_16x16x32_bf16 v[48:51], v[96:99], v[232:235], v[48:51]
    s_waitcnt vmcnt(4)
    v_mfma_f32_16x16x32_bf16 v[52:55], v[96:99], v[236:239], v[52:55]
    v_mfma_f32_16x16x32_bf16 v[64:67], v[232:235], v[100:103], v[64:67]
    ds_read_b128 v[96:99], v13 offset:38144
    v_mfma_f32_16x16x32_bf16 v[72:75], v[236:239], v[100:103], v[72:75]
    s_waitcnt lgkmcnt(3)
    v_mfma_f32_16x16x32_bf16 v[56:59], v[80:83], v[232:235], v[56:59]
    ds_read_b128 v[100:103], v13 offset:39168
    v_mfma_f32_16x16x32_bf16 v[60:63], v[80:83], v[236:239], v[60:63]
    v_mfma_f32_16x16x32_bf16 v[68:71], v[232:235], v[84:87], v[68:71]
    ds_read_b128 v[80:83], v13 offset:44032
    v_mfma_f32_16x16x32_bf16 v[76:79], v[236:239], v[84:87], v[76:79]
    s_waitcnt vmcnt(3) lgkmcnt(3)
    v_mfma_f32_16x16x32_bf16 v[48:51], v[88:91], v[240:243], v[48:51]
    ds_read_b128 v[84:87], v13 offset:45056
    s_waitcnt vmcnt(2)
    v_mfma_f32_16x16x32_bf16 v[52:55], v[88:91], v[244:247], v[52:55]
    v_mfma_f32_16x16x32_bf16 v[64:67], v[240:243], v[92:95], v[64:67]
    ds_read_b128 v[88:91], v13 offset:44288
    v_mfma_f32_16x16x32_bf16 v[72:75], v[244:247], v[92:95], v[72:75]
    s_waitcnt lgkmcnt(3)
    v_mfma_f32_16x16x32_bf16 v[56:59], v[96:99], v[240:243], v[56:59]
    ds_read_b128 v[92:95], v13 offset:45312
    v_mfma_f32_16x16x32_bf16 v[60:63], v[96:99], v[244:247], v[60:63]
    v_mfma_f32_16x16x32_bf16 v[68:71], v[240:243], v[100:103], v[68:71]
    ds_read_b128 v[96:99], v13 offset:0
    v_mfma_f32_16x16x32_bf16 v[76:79], v[244:247], v[100:103], v[76:79]
    s_waitcnt vmcnt(1) lgkmcnt(3)
    v_mfma_f32_16x16x32_bf16 v[48:51], v[80:83], v[248:251], v[48:51]
    ds_read_b128 v[100:103], v13 offset:256
    s_waitcnt vmcnt(0)
    v_mfma_f32_16x16x32_bf16 v[52:55], v[80:83], v[252:255], v[52:55]
    v_mfma_f32_16x16x32_bf16 v[64:67], v[248:251], v[84:87], v[64:67]
    ds_read_b128 v[80:83], v13 offset:6144
    v_mfma_f32_16x16x32_bf16 v[72:75], v[252:255], v[84:87], v[72:75]
    s_waitcnt lgkmcnt(3)
    v_mfma_f32_16x16x32_bf16 v[56:59], v[88:91], v[248:251], v[56:59]
    ds_read_b128 v[84:87], v13 offset:6400
    v_mfma_f32_16x16x32_bf16 v[60:63], v[88:91], v[252:255], v[60:63]
    v_mfma_f32_16x16x32_bf16 v[68:71], v[248:251], v[92:95], v[68:71]
    ds_read_b128 v[88:91], v13 offset:12288
    v_mfma_f32_16x16x32_bf16 v[76:79], v[252:255], v[92:95], v[76:79]
    s_waitcnt lgkmcnt(3)
    v_mfma_f32_16x16x32_bf16 v[32:35], v[96:99], v[192:195], v[32:35]
    ds_read_b128 v[92:95], v13 offset:12544
    v_mfma_f32_16x16x32_bf16 v[36:39], v[96:99], v[196:199], v[36:39]
    v_mfma_f32_16x16x32_bf16 v[40:43], v[100:103], v[192:195], v[40:43]
    ds_read_b128 v[96:99], v13 offset:18432
    v_mul_f32 v48, v6, v48
    v_mfma_f32_16x16x32_bf16 v[44:47], v[100:103], v[196:199], v[44:47]
    v_mul_f32 v49, v6, v49
    v_mul_f32 v50, v6, v50
    v_mul_f32 v51, v6, v51
    v_mul_f32 v52, v8, v52
    v_mul_f32 v53, v8, v53
    s_waitcnt lgkmcnt(3)
    v_mfma_f32_16x16x32_bf16 v[32:35], v[80:83], v[200:203], v[32:35]
    ds_read_b128 v[100:103], v13 offset:18688
    v_mul_f32 v54, v8, v54
    v_mfma_f32_16x16x32_bf16 v[36:39], v[80:83], v[204:207], v[36:39]
    v_mul_f32 v55, v8, v55
    v_cvt_pk_bf16_f32 v104, v48, v49
    v_cvt_pk_bf16_f32 v106, v52, v53
    v_cvt_pk_bf16_f32 v105, v50, v51
    v_mfma_f32_16x16x32_bf16 v[40:43], v[84:87], v[200:203], v[40:43]
    ds_read_b128 v[80:83], v13 offset:24576
    v_cvt_pk_bf16_f32 v107, v54, v55
    v_mfma_f32_16x16x32_bf16 v[44:47], v[84:87], v[204:207], v[44:47]
    v_permlane32_swap_b32 v104, v106
    v_permlane32_swap_b32 v105, v107
    buffer_store_dwordx4 v[104:107], v2, s[4:7], s64 offen sc1
    v_mul_f32 v56, v6, v56
    v_mul_f32 v57, v6, v57
    v_mul_f32 v58, v6, v58
    s_waitcnt lgkmcnt(3)
    v_mfma_f32_16x16x32_bf16 v[32:35], v[88:91], v[208:211], v[32:35]
    ds_read_b128 v[84:87], v13 offset:24832
    v_mul_f32 v59, v6, v59
    v_mfma_f32_16x16x32_bf16 v[36:39], v[88:91], v[212:215], v[36:39]
    v_mul_f32 v60, v8, v60
    v_mul_f32 v61, v8, v61
    v_mul_f32 v62, v8, v62
    v_mul_f32 v63, v8, v63
    v_mfma_f32_16x16x32_bf16 v[40:43], v[92:95], v[208:211], v[40:43]
    ds_read_b128 v[88:91], v9 offset:0
    v_cvt_pk_bf16_f32 v108, v56, v57
    v_mfma_f32_16x16x32_bf16 v[44:47], v[92:95], v[212:215], v[44:47]
    v_cvt_pk_bf16_f32 v110, v60, v61
    v_cvt_pk_bf16_f32 v109, v58, v59
    v_cvt_pk_bf16_f32 v111, v62, v63
    v_permlane32_swap_b32 v108, v110
    s_nop 0
    v_permlane32_swap_b32 v109, v111
    s_add_u32 s51, s64, 131072
    buffer_store_dwordx4 v[108:111], v2, s[4:7], s51 offen sc1
    s_waitcnt lgkmcnt(3)
    v_mfma_f32_16x16x32_bf16 v[32:35], v[96:99], v[216:219], v[32:35]
    ds_read_b128 v[92:95], v13 offset:30720
    v_mul_f32 v64, v120, v64
    v_mfma_f32_16x16x32_bf16 v[36:39], v[96:99], v[220:223], v[36:39]
    v_mul_f32 v65, v121, v65
    v_mul_f32 v66, v122, v66
    v_mul_f32 v67, v123, v67
    v_mul_f32 v68, v120, v68
    v_mul_f32 v69, v121, v69
    v_mfma_f32_16x16x32_bf16 v[40:43], v[100:103], v[216:219], v[40:43]
    ds_read_b128 v[96:99], v13 offset:30976
    v_mul_f32 v70, v122, v70
    v_mfma_f32_16x16x32_bf16 v[44:47], v[100:103], v[220:223], v[44:47]
    v_mul_f32 v71, v123, v71
    v_cvt_pk_bf16_f32 v112, v64, v65
    v_cvt_pk_bf16_f32 v114, v68, v69
    v_cvt_pk_bf16_f32 v113, v66, v67
    s_waitcnt lgkmcnt(3)
    v_mfma_f32_16x16x32_bf16 v[32:35], v[80:83], v[224:227], v[32:35]
    ds_read_b128 v[100:103], v13 offset:36864
    v_cvt_pk_bf16_f32 v115, v70, v71
    v_mfma_f32_16x16x32_bf16 v[36:39], v[80:83], v[228:231], v[36:39]
    v_permlane32_swap_b32 v112, v114
    v_permlane32_swap_b32 v113, v115
    buffer_store_dwordx4 v[112:115], v3, s[4:7], s64 offen offset:1024 sc1
    v_mul_f32 v72, v124, v72
    v_mul_f32 v73, v125, v73
    v_mul_f32 v74, v126, v74
    v_mfma_f32_16x16x32_bf16 v[40:43], v[84:87], v[224:227], v[40:43]
    ds_read_b128 v[80:83], v13 offset:37120
    v_mul_f32 v75, v127, v75
    v_mfma_f32_16x16x32_bf16 v[44:47], v[84:87], v[228:231], v[44:47]
    v_mul_f32 v76, v124, v76
    v_mul_f32 v77, v125, v77
    v_mul_f32 v78, v126, v78
    v_mul_f32 v79, v127, v79
    s_waitcnt lgkmcnt(3)
    v_mfma_f32_16x16x16_bf16 v[32:35], v[88:89], v[28:29], v[32:35]
    v_mfma_f32_16x16x16_bf16 v[36:39], v[88:89], v[30:31], v[36:39]
    v_mfma_f32_16x16x16_bf16 v[40:43], v[90:91], v[28:29], v[40:43]
    v_mfma_f32_16x16x16_bf16 v[44:47], v[90:91], v[30:31], v[44:47]
    ds_read_b128 v[84:87], v13 offset:43008
    ds_read_b128 v[88:91], v13 offset:43264
    v_cvt_pk_bf16_f32 v116, v72, v73
    v_cvt_pk_bf16_f32 v118, v76, v77
    v_cvt_pk_bf16_f32 v117, v74, v75
    v_cvt_pk_bf16_f32 v119, v78, v79
    v_permlane32_swap_b32 v116, v118
    s_nop 0
    v_permlane32_swap_b32 v117, v119
    buffer_store_dwordx4 v[116:119], v3, s[4:7], s64 offen offset:1536 sc1
    v_mfma_f32_16x16x32_bf16 v[32:35], v[92:95], v[232:235], v[32:35]
    v_mfma_f32_16x16x32_bf16 v[36:39], v[92:95], v[236:239], v[36:39]
    s_waitcnt lgkmcnt(3)
    v_mfma_f32_16x16x32_bf16 v[40:43], v[96:99], v[232:235], v[40:43]
    v_mfma_f32_16x16x32_bf16 v[44:47], v[96:99], v[236:239], v[44:47]
    v_mfma_f32_16x16x32_bf16 v[32:35], v[100:103], v[240:243], v[32:35]
    v_mfma_f32_16x16x32_bf16 v[36:39], v[100:103], v[244:247], v[36:39]
    s_waitcnt lgkmcnt(1)
    v_mfma_f32_16x16x32_bf16 v[40:43], v[80:83], v[240:243], v[40:43]
    v_mfma_f32_16x16x32_bf16 v[44:47], v[80:83], v[244:247], v[44:47]
    v_mfma_f32_16x16x32_bf16 v[32:35], v[84:87], v[248:251], v[32:35]
    v_mfma_f32_16x16x32_bf16 v[36:39], v[84:87], v[252:255], v[36:39]
    s_waitcnt lgkmcnt(0)
    v_mfma_f32_16x16x32_bf16 v[40:43], v[88:91], v[248:251], v[40:43]
    v_mfma_f32_16x16x32_bf16 v[44:47], v[88:91], v[252:255], v[44:47]
    s_barrier
    s_mov_b32 s44, 1
    s_mov_b32 s49, 16
    s_nop 0
    v_pk_mul_f32 v[32:33], v[32:33], v[20:21] op_sel_hi:[1,0]
    v_pk_mul_f32 v[34:35], v[34:35], v[20:21] op_sel_hi:[1,0]
    v_pk_mul_f32 v[36:37], v[36:37], v[22:23] op_sel_hi:[1,0]
    v_pk_mul_f32 v[38:39], v[38:39], v[22:23] op_sel_hi:[1,0]
    v_pk_mul_f32 v[40:41], v[40:41], v[20:21] op_sel_hi:[1,0]
    v_pk_mul_f32 v[42:43], v[42:43], v[20:21] op_sel_hi:[1,0]
    v_pk_mul_f32 v[44:45], v[44:45], v[22:23] op_sel_hi:[1,0]
    v_pk_mul_f32 v[46:47], v[46:47], v[22:23] op_sel_hi:[1,0]
    v_cvt_pk_bf16_f32 v168, v32, v33
    v_cvt_pk_bf16_f32 v169, v34, v35
    v_cvt_pk_bf16_f32 v170, v36, v37
    v_cvt_pk_bf16_f32 v171, v38, v39
    v_cvt_pk_bf16_f32 v172, v40, v41
    v_cvt_pk_bf16_f32 v173, v42, v43
    v_cvt_pk_bf16_f32 v174, v44, v45
    v_cvt_pk_bf16_f32 v175, v46, v47
    v_permlane32_swap_b32 v168, v170
    v_permlane32_swap_b32 v169, v171
    v_permlane32_swap_b32 v172, v174
    v_permlane32_swap_b32 v173, v175
    buffer_store_dwordx4 v[168:171], v24, s[4:7], s65 offen offset:0
    buffer_store_dwordx4 v[172:175], v24, s[4:7], s65 offen offset:1024
    v_pk_mul_f32 v[48:49], v[48:49], v[48:49]
    v_pk_mul_f32 v[52:53], v[52:53], v[52:53]
    v_pk_mul_f32 v[56:57], v[56:57], v[56:57]
    v_pk_mul_f32 v[60:61], v[60:61], v[60:61]
    v_pk_fma_f32 v[48:49], v[50:51], v[50:51], v[48:49]
    v_pk_fma_f32 v[52:53], v[54:55], v[54:55], v[52:53]
    v_pk_fma_f32 v[56:57], v[58:59], v[58:59], v[56:57]
    v_pk_fma_f32 v[60:61], v[62:63], v[62:63], v[60:61]
    v_add_f32 v48, v48, v49
    v_add_f32 v52, v52, v53
    v_add_f32 v56, v56, v57
    v_add_f32 v60, v60, v61
    s_nop 0
    v_permlane32_swap_b32 v48, v56
    v_permlane32_swap_b32 v52, v60
    v_add_f32 v48, v48, v56
    v_add_f32 v52, v52, v60
    s_nop 1
    v_permlane16_swap_b32 v48, v52
    v_add_f32 v26, v48, v52
    s_nop 1
    v_max_u32_dpp v26, v26, v26 quad_perm:[1,0,3,2] row_mask:0xf bank_mask:0xf
    s_nop 1
    v_max_u32_dpp v26, v26, v26 quad_perm:[2,3,0,1] row_mask:0xf bank_mask:0xf
    s_nop 1
    v_max_u32_dpp v26, v26, v26 row_half_mirror row_mask:0xf bank_mask:0xf
    s_nop 1
    v_max_u32_dpp v26, v26, v26 row_mirror row_mask:0xf bank_mask:0xf
    v_mov_b32 v28, v26
    s_nop 1
    v_permlane16_swap_b32 v26, v28
    v_max_u32 v26, v26, v28
    v_or_b32 v26, 1, v26
    ds_write_b32 v5, v26
    v_lshrrev_b32 v29, 5, v0
    v_and_b32 v30, 0xf0, v1
    v_lshl_add_u32 v30, v29, 8, v30
    v_add_u32 v16, 114176, v1
    v_and_b32 v31, 15, v0
    v_min_u32 v31, 1, v31
    v_mov_b32 v28, 116224
    v_lshl_add_u32 v28, v31, 16, v28
    v_add_u32 v30, 115200, v30
    v_cndmask_b32 v17, v30, v28, s[82:83]
    v_add_u32 v30, 512, v30
    v_cndmask_b32 v20, v30, v28, s[82:83]
    v_mov_b32 v21, 0xdddddddd
    s_lshl_b32 s50, s42, 2
    s_add_u32 s50, s50, 130720
    v_mov_b32 v25, s50
    v_pk_mov_b32 v[96:97], 0, 0
    v_pk_mov_b32 v[98:99], 0, 0
    v_pk_mov_b32 v[100:101], 0, 0
    v_pk_mov_b32 v[102:103], 0, 0
    v_pk_mov_b32 v[104:105], 0, 0
    v_pk_mov_b32 v[106:107], 0, 0
    v_pk_mov_b32 v[108:109], 0, 0
    v_pk_mov_b32 v[110:111], 0, 0
    v_pk_mov_b32 v[112:113], 0, 0
    v_pk_mov_b32 v[114:115], 0, 0
    v_pk_mov_b32 v[116:117], 0, 0
    v_pk_mov_b32 v[118:119], 0, 0
    v_pk_mov_b32 v[120:121], 0, 0
    v_pk_mov_b32 v[122:123], 0, 0
    v_pk_mov_b32 v[124:125], 0, 0
    v_pk_mov_b32 v[126:127], 0, 0
    s_add_u32 s56, s49, 1
    v_mov_b32 v27, s56
    s_mov_b64 exec, 1
    s_cmp_lg_u32 s45, 0
    s_cbranch_scc1 pubs_31
    s_waitcnt vmcnt(0)
    buffer_store_dword v27, off, s[4:7], s48
pubd_32:
    s_mov_b64 exec, -1
    s_waitcnt lgkmcnt(0)
    s_lshl_b32 s53, s41, 7
    s_add_u32 s53, s53, s58
    s_add_u32 s53, s53, 8192
    s_cmp_lg_u32 s42, 0
    s_barrier
    s_cbranch_scc1 nf_30
    v_mov_b32 v32, 130752
    ds_read_b128 v[36:39], v32 offset:16
    ds_read_b128 v[32:35], v32
    s_waitcnt lgkmcnt(0)
    v_max_u32 v32, v32, v34
    v_max_u32 v33, v33, v35
    v_max_u32 v34, v36, v38
    v_max_u32 v35, v37, v39
    v_max_u32 v32, v32, v34
    v_max_u32 v33, v33, v35
    s_mov_b64 exec, 1
    buffer_store_dwordx2 v[32:33], off, s[4:7], s53 sc1
    s_mov_b64 exec, -1
nf_30:
    s_branch L_attn
L_final:
    s_mov_b32 s12, s34
    s_and_b32 s13, s35, 0xffff
    s_mov_b32 s14, 2097152
    s_mov_b32 s15, 0x20000
    v_and_b32 v14, 31, v0
    v_lshlrev_b32 v14, 10, v14
    v_lshrrev_b32 v15, 5, v0
    v_lshl_add_u32 v14, v15, 4, v14
    v_permlane16_swap_b32 v20, v22
    v_permlane16_swap_b32 v21, v23
    v_permlane16_swap_b32 v24, v26
    v_permlane16_swap_b32 v25, v27
    buffer_store_dwordx4 v[20:23], v14, s[12:15], s70 offen
    buffer_store_dwordx4 v[24:27], v14, s[12:15], s70 offen offset:32
L_exit:
    s_endpgm
L_startL:
    v_mul_u32_u24 v16, 3072, v4
    v_lshlrev_b32 v8, 2, v0
    v_and_b32 v8, 64, v8
    v_xor_b32 v8, v8, v5
    v_add_u32 v16, v16, v8
    v_xor_b32 v10, 32, v16
    s_sub_u32 s62, s42, 4
    s_mul_i32 s66, s62, 49152
    s_lshr_b32 s57, s41, 2
    s_lshl_b32 s57, s57, 7
    s_add_u32 s66, s66, s57
    s_mul_i32 s54, s62, 6144
    s_add_u32 s54, s54, 65536
    s_lshl_b32 s62, s62, 12
    s_mov_b32 s12, s22
    s_and_b32 s13, s23, 0xffff
    s_mov_b32 s14, 1572864
    s_mov_b32 s15, 0x20000
    s_mov_b32 s16, s36
    s_and_b32 s17, s37, 0xffff
    s_mov_b32 s18, 256
    s_mov_b32 s19, 0x20000
    s_lshl_b32 s58, s40, 14
    s_add_u32 s58, s58, 25165824
    s_getreg_b32 s43, hwreg(HW_REG_XCC_ID, 0, 4)
    s_or_b32 s43, s43, 16
    s_or_b32 s50, s62, s41
    s_cbranch_scc1 w4_33
    v_mov_b32 v20, 0
    v_mov_b32 v21, 0
    v_mov_b32 v22, 0
    v_mov_b32 v23, 0
    v_lshrrev_b32 v8, 1, v0
    v_lshlrev_b32 v8, 7, v8
    v_and_b32 v9, 16, v1
    v_add_u32 v8, v8, v9
    s_add_u32 s50, s58, 4096
    s_add_u32 s51, s58, 8192
    buffer_store_dwordx4 v[20:23], v1, s[4:7], s58 offen offset:0 sc1
    buffer_store_dwordx4 v[20:23], v1, s[4:7], s58 offen offset:1024 sc1
    buffer_store_dwordx4 v[20:23], v8, s[4:7], s50 offen sc1
    buffer_store_dwordx4 v[20:23], v8, s[4:7], s51 offen sc1
w4_33:
    s_and_b32 s55, s41, 1
    s_xor_b32 s55, s55, 0
    s_add_u32 s55, s55, s40
    s_and_b32 s55, s55, 7
    s_mul_i32 s55, s55, 196608
    s_add_u32 s55, s55, s66
    s_add_u32 m0, s54, 0
    s_nop 0
    buffer_load_dwordx4 v16, s[12:15], s55 offen offset:0 lds
    buffer_load_dwordx4 v16, s[12:15], s55 offen offset:1024 lds
    buffer_load_dwordx4 v16, s[12:15], s55 offen offset:2048 lds
    s_add_u32 m0, s54, 3072
    s_add_u32 s55, s55, 24576
    buffer_load_dwordx4 v10, s[12:15], s55 offen offset:0 lds
    buffer_load_dwordx4 v10, s[12:15], s55 offen offset:1024 lds
    buffer_load_dwordx4 v10, s[12:15], s55 offen offset:2048 lds
    s_waitcnt vmcnt(6)
    s_or_b32 s50, s62, s41
    s_cbranch_scc1 w4_34
    s_lshl_b32 s50, s40, 2
    v_mov_b32 v8, s43
    s_mov_b64 exec, 1
    buffer_store_dword v8, off, s[16:19], s50 offset:0 sc1
    s_mov_b64 exec, -1
w4_34:
    s_setprio 1
    s_mov_b32 s3, 1
    s_cmp_lg_u32 s3, 0
    s_branch L_ln0
L_lnL:
    s_setprio 0
    s_and_b32 s55, s41, 1
    s_xor_b32 s55, s55, 1
    s_add_u32 s55, s55, s40
    s_and_b32 s55, s55, 7
    s_mul_i32 s55, s55, 196608
    s_add_u32 s55, s55, s66
    s_add_u32 m0, s54, 24576
    s_nop 0
    buffer_load_dwordx4 v16, s[12:15], s55 offen offset:0 lds
    buffer_load_dwordx4 v16, s[12:15], s55 offen offset:1024 lds
    buffer_load_dwordx4 v16, s[12:15], s55 offen offset:2048 lds
    s_add_u32 m0, s54, 27648
    s_add_u32 s55, s55, 24576
    buffer_load_dwordx4 v10, s[12:15], s55 offen offset:0 lds
    buffer_load_dwordx4 v10, s[12:15], s55 offen offset:1024 lds
    buffer_load_dwordx4 v10, s[12:15], s55 offen offset:2048 lds
    s_lshr_b32 s50, s41, 1
    s_and_b32 s50, s50, 1
    s_lshl_b32 s50, s50, 6
    v_bfe_u32 v17, v0, 3, 1
    v_lshlrev_b32 v17, 6, v17
    v_xor_b32 v17, s50, v17
    v_and_b32 v8, 3, v0
    v_lshl_add_u32 v17, v8, 3, v17
    v_bfe_u32 v8, v0, 4, 1
    v_lshl_add_u32 v17, v8, 5, v17
    v_bfe_u32 v8, v0, 2, 2
    v_lshl_add_u32 v17, v8, 7, v17
    v_lshrrev_b32 v8, 5, v0
    v_mul_u32_u24 v8, 512, v8
    v_add_u32 v17, v17, v8
    v_add_u32 v17, s54, v17
    v_add_u32 v15, 49152, v17
    v_xor_b32 v7, 32, v17
    v_xor_b32 v6, 32, v15
    s_waitcnt vmcnt(6)
    s_waitcnt lgkmcnt(0)
    ds_read_b64_tr_b16 v[152:153], v17 offset:0
    ds_read_b64_tr_b16 v[154:155], v7 offset:3072
    ds_read_b64_tr_b16 v[156:157], v17 offset:1024
    ds_read_b64_tr_b16 v[158:159], v7 offset:4096
    ds_read_b64_tr_b16 v[160:161], v17 offset:2048
    ds_read_b64_tr_b16 v[162:163], v7 offset:5120
    s_waitcnt lgkmcnt(6)
    s_barrier
    s_and_b32 s55, s41, 1
    s_xor_b32 s55, s55, 2
    s_add_u32 s55, s55, s40
    s_and_b32 s55, s55, 7
    s_mul_i32 s55, s55, 196608
    s_add_u32 s55, s55, s66
    s_add_u32 m0, s54, 49152
    s_nop 0
    buffer_load_dwordx4 v16, s[12:15], s55 offen offset:0 lds
    buffer_load_dwordx4 v16, s[12:15], s55 offen offset:1024 lds
    buffer_load_dwordx4 v16, s[12:15], s55 offen offset:2048 lds
    s_add_u32 m0, s54, 52224
    s_add_u32 s55, s55, 24576
    buffer_load_dwordx4 v10, s[12:15], s55 offen offset:0 lds
    buffer_load_dwordx4 v10, s[12:15], s55 offen offset:1024 lds
    buffer_load_dwordx4 v10, s[12:15], s55 offen offset:2048 lds
    s_mov_b32 s44, 0
    s_mov_b32 s45, 0
    s_mov_b32 s49, 0
    s_mov_b32 s46, 100000
    s_mov_b32 s80, 0
    s_mov_b32 s81, -1
    s_mov_b32 s82, 0xffff0000
    s_mov_b32 s83, 0xffff0000
    s_lshl_b32 s58, s40, 14
    s_add_u32 s58, s58, 25165824
    s_mov_b32 s47, s58
    s_lshl_b32 s48, s41, 2
    s_lshl_b32 s57, s42, 7
    s_add_u32 s48, s48, s57
    s_add_u32 s48, s48, s58
    s_lshl_b32 s59, s41, 17
    s_add_u32 s59, s59, 16777216
    v_lshl_add_u32 v11, s40, 2, v0
    v_and_b32 v11, 28, v11
    s_waitcnt vmcnt(6)
    ds_read_b64_tr_b16 v[164:165], v17 offset:24576
    ds_read_b64_tr_b16 v[166:167], v7 offset:27648
    ds_read_b64_tr_b16 v[168:169], v17 offset:25600
    ds_read_b64_tr_b16 v[170:171], v7 offset:28672
    ds_read_b64_tr_b16 v[172:173], v17 offset:26624
    ds_read_b64_tr_b16 v[174:175], v7 offset:29696
    s_waitcnt lgkmcnt(6)
    s_barrier
    buffer_load_dword v13, v11, s[16:19], 0 offen offset:0 sc1
    s_and_b32 s55, s41, 1
    s_xor_b32 s55, s55, 3
    s_add_u32 s55, s55, s40
    s_and_b32 s55, s55, 7
    s_mul_i32 s55, s55, 196608
    s_add_u32 s55, s55, s66
    s_add_u32 m0, s54, 73728
    s_nop 0
    buffer_load_dwordx4 v16, s[12:15], s55 offen offset:0 lds
    buffer_load_dwordx4 v16, s[12:15], s55 offen offset:1024 lds
    buffer_load_dwordx4 v16, s[12:15], s55 offen offset:2048 lds
    s_add_u32 m0, s54, 76800
    s_add_u32 s55, s55, 24576
    buffer_load_dwordx4 v10, s[12:15], s55 offen offset:0 lds
    buffer_load_dwordx4 v10, s[12:15], s55 offen offset:1024 lds
    buffer_load_dwordx4 v10, s[12:15], s55 offen offset:2048 lds
    s_waitcnt vmcnt(7)
    ds_read_b64_tr_b16 v[176:177], v15 offset:0
    ds_read_b64_tr_b16 v[178:179], v6 offset:3072
    ds_read_b64_tr_b16 v[180:181], v15 offset:1024
    ds_read_b64_tr_b16 v[182:183], v6 offset:4096
    ds_read_b64_tr_b16 v[184:185], v15 offset:2048
    ds_read_b64_tr_b16 v[186:187], v6 offset:5120
    s_waitcnt lgkmcnt(6)
    s_barrier
    s_and_b32 s55, s41, 1
    s_xor_b32 s55, s55, 4
    s_add_u32 s55, s55, s40
    s_and_b32 s55, s55, 7
    s_mul_i32 s55, s55, 196608
    s_add_u32 s55, s55, s66
    s_add_u32 m0, s54, 0
    s_nop 0
    buffer_load_dwordx4 v16, s[12:15], s55 offen offset:0 lds
    buffer_load_dwordx4 v16, s[12:15], s55 offen offset:1024 lds
    buffer_load_dwordx4 v16, s[12:15], s55 offen offset:2048 lds
    s_add_u32 m0, s54, 3072
    s_add_u32 s55, s55, 24576
    buffer_load_dwordx4 v10, s[12:15], s55 offen offset:0 lds
    buffer_load_dwordx4 v10, s[12:15], s55 offen offset:1024 lds
    buffer_load_dwordx4 v10, s[12:15], s55 offen offset:2048 lds
    s_waitcnt vmcnt(6)
    ds_read_b64_tr_b16 v[188:189], v15 offset:24576
    ds_read_b64_tr_b16 v[190:191], v6 offset:27648
    ds_read_b64_tr_b16 v[192:193], v15 offset:25600
    ds_read_b64_tr_b16 v[194:195], v6 offset:28672
    ds_read_b64_tr_b16 v[196:197], v15 offset:26624
    ds_read_b64_tr_b16 v[198:199], v6 offset:29696
    s_waitcnt lgkmcnt(6)
    s_barrier
    s_and_b32 s55, s41, 1
    s_xor_b32 s55, s55, 5
    s_add_u32 s55, s55, s40
    s_and_b32 s55, s55, 7
    s_mul_i32 s55, s55, 196608
    s_add_u32 s55, s55, s66
    s_add_u32 m0, s54, 24576
    s_nop 0
    buffer_load_dwordx4 v16, s[12:15], s55 offen offset:0 lds
    buffer_load_dwordx4 v16, s[12:15], s55 offen offset:1024 lds
    buffer_load_dwordx4 v16, s[12:15], s55 offen offset:2048 lds
    s_add_u32 m0, s54, 27648
    s_add_u32 s55, s55, 24576
    buffer_load_dwordx4 v10, s[12:15], s55 offen offset:0 lds
    buffer_load_dwordx4 v10, s[12:15], s55 offen offset:1024 lds
    buffer_load_dwordx4 v10, s[12:15], s55 offen offset:2048 lds
    v_cmp_ne_u32 s[78:79], 0, v13
    s_lshl_b32 s51, s40, 2
    s_bitcmp1_b32 s78, 0
    s_cbranch_scc1 og_35
spin_36:
    buffer_load_dword v13, off, s[16:19], s51 offset:0 sc1
    s_waitcnt vmcnt(0)
    v_cmp_eq_u32 vcc, 0, v13
    s_cbranch_vccz spind_37
    s_sub_u32 s46, s46, 1
    s_cbranch_scc0 spin_36
    s_mov_b32 s46, 0
spind_37:
og_35:
    v_readfirstlane_b32 s52, v13
    s_nop 0
    s_cmp_lg_u32 s52, s43
    s_cselect_b32 s45, 1, 0
    s_cmp_lg_u32 s62, 0
    s_cbranch_scc1 w4_38
    v_mov_b32 v8, 1
    s_mov_b64 exec, 1
    s_cmp_lg_u32 s45, 0
    s_cbranch_scc1 sh_39
    buffer_store_dword v8, off, s[4:7], s48
    s_branch hd_40
sh_39:
    buffer_store_dword v8, off, s[16:19], s51 offset:128 sc1
hd_40:
    s_mov_b64 exec, -1
w4_38:
    s_waitcnt vmcnt(6)
    ds_read_b64_tr_b16 v[200:201], v17 offset:0
    ds_read_b64_tr_b16 v[202:203], v7 offset:3072
    ds_read_b64_tr_b16 v[204:205], v17 offset:1024
    ds_read_b64_tr_b16 v[206:207], v7 offset:4096
    ds_read_b64_tr_b16 v[208:209], v17 offset:2048
    ds_read_b64_tr_b16 v[210:211], v7 offset:5120
    s_waitcnt lgkmcnt(6)
    s_barrier
    s_and_b32 s55, s41, 1
    s_xor_b32 s55, s55, 6
    s_add_u32 s55, s55, s40
    s_and_b32 s55, s55, 7
    s_mul_i32 s55, s55, 196608
    s_add_u32 s55, s55, s66
    s_add_u32 m0, s54, 49152
    s_nop 0
    buffer_load_dwordx4 v16, s[12:15], s55 offen offset:0 lds
    buffer_load_dwordx4 v16, s[12:15], s55 offen offset:1024 lds
    buffer_load_dwordx4 v16, s[12:15], s55 offen offset:2048 lds
    s_add_u32 m0, s54, 52224
    s_add_u32 s55, s55, 24576
    buffer_load_dwordx4 v10, s[12:15], s55 offen offset:0 lds
    buffer_load_dwordx4 v10, s[12:15], s55 offen offset:1024 lds
    buffer_load_dwordx4 v10, s[12:15], s55 offen offset:2048 lds
    s_waitcnt vmcnt(6)
    ds_read_b64_tr_b16 v[212:213], v17 offset:24576
    ds_read_b64_tr_b16 v[214:215], v7 offset:27648
    ds_read_b64_tr_b16 v[216:217], v17 offset:25600
    ds_read_b64_tr_b16 v[218:219], v7 offset:28672
    ds_read_b64_tr_b16 v[220:221], v17 offset:26624
    ds_read_b64_tr_b16 v[222:223], v7 offset:29696
    s_waitcnt lgkmcnt(6)
    s_barrier
    s_and_b32 s55, s41, 1
    s_xor_b32 s55, s55, 7
    s_add_u32 s55, s55, s40
    s_and_b32 s55, s55, 7
    s_mul_i32 s55, s55, 196608
    s_add_u32 s55, s55, s66
    s_add_u32 m0, s54, 73728
    s_nop 0
    buffer_load_dwordx4 v16, s[12:15], s55 offen offset:0 lds
    buffer_load_dwordx4 v16, s[12:15], s55 offen offset:1024 lds
    buffer_load_dwordx4 v16, s[12:15], s55 offen offset:2048 lds
    s_add_u32 m0, s54, 76800
    s_add_u32 s55, s55, 24576
    buffer_load_dwordx4 v10, s[12:15], s55 offen offset:0 lds
    buffer_load_dwordx4 v10, s[12:15], s55 offen offset:1024 lds
    buffer_load_dwordx4 v10, s[12:15], s55 offen offset:2048 lds
    s_waitcnt vmcnt(6)
    ds_read_b64_tr_b16 v[224:225], v15 offset:0
    ds_read_b64_tr_b16 v[226:227], v6 offset:3072
    ds_read_b64_tr_b16 v[228:229], v15 offset:1024
    ds_read_b64_tr_b16 v[230:231], v6 offset:4096
    ds_read_b64_tr_b16 v[232:233], v15 offset:2048
    ds_read_b64_tr_b16 v[234:235], v6 offset:5120
    s_waitcnt lgkmcnt(6)
    s_barrier
    v_and_b32 v12, 31, v0
    v_lshlrev_b32 v12, 2, v12
    buffer_load_dword v13, v12, s[4:7], s58 offen offset:512 sc1
    s_waitcnt vmcnt(1)
    ds_read_b64_tr_b16 v[236:237], v15 offset:24576
    ds_read_b64_tr_b16 v[238:239], v6 offset:27648
    ds_read_b64_tr_b16 v[240:241], v15 offset:25600
    ds_read_b64_tr_b16 v[242:243], v6 offset:28672
    ds_read_b64_tr_b16 v[244:245], v15 offset:26624
    ds_read_b64_tr_b16 v[246:247], v6 offset:29696
    s_waitcnt lgkmcnt(6)
    s_barrier
    s_waitcnt vmcnt(0)
    s_lshl_b32 s50, s40, 2
    s_cmp_lg_u32 s45, 0
    s_cbranch_scc1 md_42
ml_41:
    v_cmp_eq_u32 vcc, 0, v13
    s_cbranch_vccz md_42
    buffer_load_dword v9, off, s[16:19], s50 offset:128 sc1
    buffer_load_dword v13, v12, s[4:7], s58 offen offset:512 sc1
    s_waitcnt vmcnt(0)
    v_readfirstlane_b32 s45, v9
    s_nop 0
    s_cmp_lg_u32 s45, 0
    s_cbranch_scc1 md_42
    s_sub_u32 s46, s46, 1
    s_cbranch_scc0 ml_41
    s_mov_b32 s46, 0
md_42:
    v_mov_b32 v8, 130784
    v_mov_b32 v12, 0
    v_mov_b32 v13, s45
    ds_write_b64 v8, v[12:13]
    s_lshl_b32 s50, s45, 10
    s_add_u32 s47, s47, s50
    s_add_u32 s48, s48, s50
    s_and_b32 s63, s41, 15
    s_mul_i32 s63, s63, 229376
    s_add_u32 s63, s63, s62
    s_add_u32 s63, s63, 10485760
    s_and_b32 s64, s41, 7
    s_mul_i32 s64, s64, 229376
    s_add_u32 s64, s64, s62
    s_add_u32 s64, s64, 14680064
    s_and_b32 s65, s41, 7
    s_lshl_b32 s65, s65, 16
    s_add_u32 s65, s65, s62
    s_add_u32 s65, s65, 9961472
    s_lshl_b32 s61, s41, 7
    s_add_u32 s61, s61, s58
    s_add_u32 s61, s61, 4096
    v_lshrrev_b32 v10, 2, v0
    v_add_u32 v10, s40, v10
    v_and_b32 v10, 7, v10
    v_lshlrev_b32 v10, 14, v10
    v_and_b32 v8, 3, v0
    v_lshl_add_u32 v10, v8, 7, v10
    s_and_b32 s60, s41, 28
    s_lshl_b32 s60, s60, 7
    s_and_b32 s57, s41, 3
    s_lshl_b32 s57, s57, 2
    s_add_u32 s60, s60, s57
    s_add_u32 s60, s60, 25169920
    s_mov_b64 s[84:85], 0
    s_not_b64 s[86:87], s[80:81]
    v_mov_b32 v20, 0x3f803f80
    v_mov_b32 v21, 0x3f803f80
    v_mov_b32 v22, 0x3f803f80
    v_mov_b32 v23, 0x3f803f80
    v_bfe_u32 v8, v0, 4, 1
    v_mul_u32_u24 v8, 2064, v8
    v_lshrrev_b32 v9, 5, v0
    v_mul_u32_u24 v9, 16512, v9
    s_mov_b32 s51, s62
    s_lshr_b32 s57, s62, 7
    s_add_u32 s51, s51, s57
    s_add_u32 s51, s51, 132864
    v_add3_u32 v8, v8, v9, s51
    v_bfe_u32 v12, v0, 3, 1
    s_and_b32 s50, s41, 28
    s_lshl_b32 s50, s50, 2
    s_lshr_b32 s57, s62, 12
    s_lshl_b32 s57, s57, 2
    s_add_u32 s50, s50, s57
    s_and_b32 s57, s41, 2
    s_lshl_b32 s57, s57, 7
    s_add_u32 s50, s50, s57
    v_lshl_add_u32 v12, v12, 7, s50
    s_waitcnt lgkmcnt(0)
    s_barrier
    ds_write_b128 v8, v[20:23]
    v_mfma_f32_32x32x16_bf16 v[24:39], v[20:23], v[152:155], 0
    v_mfma_f32_32x32x16_bf16 v[24:39], v[20:23], v[164:167], v[24:39]
    v_mfma_f32_32x32x16_bf16 v[24:39], v[20:23], v[176:179], v[24:39]
    v_mfma_f32_32x32x16_bf16 v[24:39], v[20:23], v[188:191], v[24:39]
    v_mfma_f32_32x32x16_bf16 v[24:39], v[20:23], v[200:203], v[24:39]
    v_mfma_f32_32x32x16_bf16 v[24:39], v[20:23], v[212:215], v[24:39]
    v_mfma_f32_32x32x16_bf16 v[24:39], v[20:23], v[224:227], v[24:39]
    v_mfma_f32_32x32x16_bf16 v[24:39], v[20:23], v[236:239], v[24:39]
    v_mfma_f32_32x32x16_bf16 v[40:55], v[20:23], v[156:159], 0
    v_mfma_f32_32x32x16_bf16 v[40:55], v[20:23], v[168:171], v[40:55]
    v_mfma_f32_32x32x16_bf16 v[40:55], v[20:23], v[180:183], v[40:55]
    v_mfma_f32_32x32x16_bf16 v[40:55], v[20:23], v[192:195], v[40:55]
    v_mfma_f32_32x32x16_bf16 v[40:55], v[20:23], v[204:207], v[40:55]
    v_mfma_f32_32x32x16_bf16 v[40:55], v[20:23], v[216:219], v[40:55]
    v_mfma_f32_32x32x16_bf16 v[40:55], v[20:23], v[228:231], v[40:55]
    v_mfma_f32_32x32x16_bf16 v[40:55], v[20:23], v[240:243], v[40:55]
    v_mfma_f32_32x32x16_bf16 v[56:71], v[20:23], v[160:163], 0
    v_mfma_f32_32x32x16_bf16 v[56:71], v[20:23], v[172:175], v[56:71]
    v_mfma_f32_32x32x16_bf16 v[56:71], v[20:23], v[184:187], v[56:71]
    v_mfma_f32_32x32x16_bf16 v[56:71], v[20:23], v[196:199], v[56:71]
    v_mfma_f32_32x32x16_bf16 v[56:71], v[20:23], v[208:211], v[56:71]
    v_mfma_f32_32x32x16_bf16 v[56:71], v[20:23], v[220:223], v[56:71]
    v_mfma_f32_32x32x16_bf16 v[56:71], v[20:23], v[232:235], v[56:71]
    v_mfma_f32_32x32x16_bf16 v[56:71], v[20:23], v[244:247], v[56:71]
    s_mul_i32 s50, s40, 917504
    s_mul_i32 s57, s62, 56
    s_add_u32 s50, s50, s57
    s_lshl_b32 s57, s41, 10
    s_add_u32 s50, s50, s57
    s_add_u32 s50, s50, 2097152
    s_lshr_b32 s51, s62, 1
    s_lshl_b32 s52, s40, 14
    s_add_u32 s52, s52, s59
    s_add_u32 s52, s52, s62
    s_lshr_b32 s53, s62, 1
    s_lshr_b32 s57, s62, 8
    s_add_u32 s53, s53, s57
    v_cvt_pk_bf16_f32 v248, v24, v24
    v_and_b32 v9, 0xffff0000, v248
    v_sub_f32 v9, v24, v9
    v_cvt_pk_bf16_f32 v249, v9, v9
    v_cvt_pk_bf16_f32 v250, v40, v40
    v_and_b32 v9, 0xffff0000, v250
    v_sub_f32 v9, v40, v9
    v_cvt_pk_bf16_f32 v251, v9, v9
    v_cvt_pk_bf16_f32 v252, v56, v56
    v_and_b32 v9, 0xffff0000, v252
    v_sub_f32 v9, v56, v9
    v_cvt_pk_bf16_f32 v253, v9, v9
    s_barrier
    s_add_u32 s56, s49, 1
pl_43:
    buffer_load_dword v13, v12, s[4:7], s47 offen sc1
    s_sub_u32 s46, s46, 1
    s_cbranch_scc1 pt_44
    s_cmp_lg_u32 s45, 0
    s_waitcnt vmcnt(0)
    v_cmp_gt_u32 vcc, s56, v13
    s_cbranch_vccnz pl_43
    s_cbranch_scc1 pa_45
pd_46:
    s_add_u32 m0, s53, 130816
    s_add_u32 s57, s52, 0
    buffer_load_dwordx4 v1, s[4:7], s57 offen offset:0 sc1 lds
    buffer_load_dwordx4 v1, s[4:7], s57 offen offset:1024 sc1 lds
    s_add_u32 m0, s51, 32768
    s_add_u32 s57, s50, 0
    buffer_load_dwordx4 v1, s[4:7], s57 offen offset:0 sc1 lds
    s_add_u32 m0, s51, 33792
    s_add_u32 s57, s50, 114688
    buffer_load_dwordx4 v1, s[4:7], s57 offen offset:0 sc1 lds
    s_add_u32 m0, s53, 139072
    s_add_u32 s57, s52, 2048
    buffer_load_dwordx4 v1, s[4:7], s57 offen offset:0 sc1 lds
    buffer_load_dwordx4 v1, s[4:7], s57 offen offset:1024 sc1 lds
    s_lshr_b32 s54, s62, 12
    s_lshl_b32 s50, s41, 3
    s_add_u32 s50, s50, s40
    s_mov_b32 s70, 2146435072
    s_cmp_ge_u32 s41, 23
    s_cbranch_scc1 L_pr_none
    s_cmp_ge_u32 s50, 112
    s_cbranch_scc1 L_pr_o
    s_mov_b32 s8, s28
    s_and_b32 s9, s29, 0xffff
    s_mov_b32 s10, 1835008
    s_mov_b32 s11, 0x20000
    s_mov_b32 s12, s30
    s_and_b32 s13, s31, 0xffff
    s_mov_b32 s14, 1835008
    s_mov_b32 s15, 0x20000
    s_mov_b32 s71, 3584
    s_lshr_b32 s68, s50, 2
    s_lshl_b32 s68, s68, 7
    s_and_b32 s57, s50, 3
    s_mul_i32 s57, s57, 458752
    s_add_u32 s68, s68, s57
    s_mov_b32 s69, s68
    s_lshr_b32 s52, s50, 2
    s_lshl_b32 s52, s52, 2
    s_add_u32 s52, s52, s54
    s_and_b32 s51, s52, 15
    s_mul_i32 s51, s51, 7
    s_lshr_b32 s57, s52, 4
    s_add_u32 s51, s51, s57
    s_lshl_b32 s70, s51, 10
    s_and_b32 s57, s50, 3
    s_lshl_b32 s57, s57, 8
    s_add_u32 s70, s70, s57
    s_add_u32 s70, s70, 14155776
    s_lshl_b32 s67, s51, 15
    s_and_b32 s57, s50, 3
    s_lshl_b32 s57, s57, 13
    s_add_u32 s67, s67, s57
    s_add_u32 s67, s67, 10485760
    s_mov_b32 s72, 4096
    s_lshl_b32 s52, s54, 5
    s_mov_b32 s53, 16384
    s_branch L_pr_go
L_pr_o:
    s_and_b32 s52, s50, 3
    s_lshl_b32 s52, s52, 1
    s_lshr_b32 s57, s54, 1
    s_add_u32 s52, s52, s57
    s_cmp_ge_u32 s50, 128
    s_cbranch_scc1 L_pr_2
    s_mov_b32 s8, s24
    s_and_b32 s9, s25, 0xffff
    s_mov_b32 s10, 524288
    s_mov_b32 s11, 0x20000
    s_mov_b32 s12, s24
    s_and_b32 s13, s25, 0xffff
    s_mov_b32 s14, 524288
    s_mov_b32 s15, 0x20000
    s_sub_u32 s50, s50, 112
    s_lshl_b32 s67, s52, 16
    s_lshr_b32 s57, s50, 2
    s_and_b32 s57, s57, 1
    s_lshl_b32 s57, s57, 15
    s_add_u32 s67, s67, s57
    s_lshr_b32 s57, s50, 3
    s_lshl_b32 s57, s57, 13
    s_add_u32 s67, s67, s57
    s_and_b32 s57, s54, 1
    s_lshl_b32 s57, s57, 12
    s_add_u32 s67, s67, s57
    s_add_u32 s67, s67, 9961472
    s_branch L_pr_o2
L_pr_2:
    s_mov_b32 s8, s32
    s_and_b32 s9, s33, 0xffff
    s_mov_b32 s10, 1835008
    s_mov_b32 s11, 0x20000
    s_mov_b32 s12, s32
    s_and_b32 s13, s33, 0xffff
    s_mov_b32 s14, 1835008
    s_mov_b32 s15, 0x20000
    s_sub_u32 s50, s50, 128
    s_mul_i32 s67, s52, 229376
    s_lshr_b32 s57, s50, 3
    s_lshl_b32 s57, s57, 15
    s_add_u32 s67, s67, s57
    s_lshr_b32 s57, s50, 2
    s_and_b32 s57, s57, 1
    s_lshl_b32 s57, s57, 13
    s_add_u32 s67, s67, s57
    s_and_b32 s57, s54, 1
    s_lshl_b32 s57, s57, 12
    s_add_u32 s67, s67, s57
    s_add_u32 s67, s67, 14680064
    s_branch L_pr_o2
L_pr_none:
    s_mov_b32 s8, s24
    s_and_b32 s9, s25, 0xffff
    s_mov_b32 s10, 0
    s_mov_b32 s11, 0x20000
    s_mov_b32 s12, s24
    s_and_b32 s13, s25, 0xffff
    s_mov_b32 s14, 0
    s_mov_b32 s15, 0x20000
    s_mov_b32 s50, 0
    s_mov_b32 s67, 2146435072
L_pr_o2:
    s_mov_b32 s71, 1024
    s_mov_b32 s72, 16384
    s_and_b32 s68, s50, 3
    s_lshl_b32 s68, s68, 8
    s_lshr_b32 s57, s50, 2
    s_lshl_b32 s57, s57, 17
    s_add_u32 s68, s68, s57
    s_add_u32 s69, s68, 128
    s_lshr_b32 s52, s54, 1
    s_lshl_b32 s52, s52, 14
    s_and_b32 s57, s54, 1
    s_lshl_b32 s57, s57, 6
    s_add_u32 s52, s52, s57
    s_mov_b32 s53, 32
L_pr_go:
    v_lshrrev_b32 v6, 3, v0
    v_mul_lo_u32 v6, v6, s71
    v_and_b32 v8, 0x70, v1
    v_add_u32 v6, v6, v8
    s_lshl_b32 s71, s71, 3
    s_mul_i32 s51, s71, s54
    s_lshl_b32 s51, s51, 2
    s_add_u32 s68, s68, s51
    s_add_u32 s69, s69, s51
    v_bfe_u32 v7, v0, 4, 1
    v_mul_lo_u32 v7, v7, s53
    v_and_b32 v8, 3, v0
    v_lshl_add_u32 v7, v8, 3, v7
    v_bfe_u32 v8, v0, 2, 2
    v_lshl_add_u32 v7, v8, 7, v7
    v_and_b32 v8, 0x200, v1
    s_add_u32 s52, s52, 0
    v_add3_u32 v7, v7, v8, s52
    s_lshl_b32 s50, s41, 4
    s_lshr_b32 s57, s62, 12
    s_lshl_b32 s57, s57, 2
    s_add_u32 s50, s50, s57
    v_lshrrev_b32 v5, 4, v0
    v_add_lshl_u32 v5, v5, s50, 7
    v_min_u32 v5, L_end-L_pc-4, v5
    v_add_u32 v2, s62, v1
    v_add_u32 v3, 0x10000, v2
    v_add_u32 v4, 0x20000, v2
    s_setprio 1
    s_waitcnt vmcnt(2)
    s_waitcnt lgkmcnt(0)
    s_barrier
    s_lshr_b32 s50, s62, 1
    v_add_u32 v8, s50, v1
    ds_read_b128 v[32:35], v8 offset:32768
    ds_read_b128 v[36:39], v8 offset:33792
    s_waitcnt vmcnt(0)
    s_barrier
kvn_47:
    s_andn2_b32 s52, 0xf0, s84
    s_cbranch_scc0 kvd_48
    s_cmp_eq_u32 s78, -1
    s_cbranch_scc1 kvr_49
    buffer_load_dword v13, v11, s[16:19], 0 offen offset:0 sc1
    s_waitcnt vmcnt(0)
    v_cmp_ne_u32 s[78:79], 0, v13
kvr_49:
    s_mov_b64 exec, 0xf0
    buffer_load_dword v9, v10, s[4:7], s60 offen sc1
    s_waitcnt vmcnt(0)
    v_cmp_ne_u32 vcc, 0, v9
    s_mov_b64 exec, -1
    s_and_b32 s52, vcc_lo, s78
    s_or_b32 s84, s84, s52
    s_sub_u32 s46, s46, 1
    s_cbranch_scc0 kvn_47
    s_mov_b32 s46, 0
kvd_48:
    s_add_u32 s50, s40, 1
    s_and_b32 s50, s50, 7
    s_lshl_b32 s50, s50, 14
    s_add_u32 s50, s50, s59
    s_add_u32 s50, s50, s62
    s_mov_b32 s51, s62
    s_lshr_b32 s57, s62, 7
    s_add_u32 s51, s51, s57
    s_add_u32 m0, s51, 147328
    s_add_u32 s57, s50, 0
    buffer_load_dwordx4 v1, s[4:7], s57 offen offset:0 sc1 lds
    buffer_load_dwordx4 v1, s[4:7], s57 offen offset:1024 sc1 lds
    s_add_u32 m0, m0, 16
    s_nop 0
    buffer_load_dwordx4 v1, s[4:7], s57 offen offset:2048 sc1 lds
    buffer_load_dwordx4 v1, s[4:7], s57 offen offset:3072 sc1 lds
    s_waitcnt lgkmcnt(0)
    v_dot2_f32_bf16 v16, v32, v32, 0
    v_dot2_f32_bf16 v17, v36, v36, 0
    v_dot2_f32_bf16 v16, v33, v33, v16
    v_dot2_f32_bf16 v17, v37, v37, v17
    v_dot2_f32_bf16 v16, v34, v34, v16
    v_dot2_f32_bf16 v17, v38, v38, v17
    v_dot2_f32_bf16 v16, v35, v35, v16
    v_dot2_f32_bf16 v17, v39, v39, v17
    s_nop 2
    v_permlane32_swap_b32 v16, v17
    v_add_f32 v16, v16, v17
    global_load_dword v14, v5, s[96:97]
    s_add_u32 m0, s62, 0
    s_nop 0
    buffer_load_dwordx4 v6, s[8:11], s68 offen nt lds
    s_add_u32 s68, s68, s71
    s_add_u32 m0, s62, 16384
    s_nop 0
    buffer_load_dwordx4 v6, s[12:15], s69 offen nt lds
    s_add_u32 s69, s69, s71
    s_add_u32 m0, s62, 1024
    s_nop 0
    buffer_load_dwordx4 v6, s[8:11], s68 offen nt lds
    s_add_u32 s68, s68, s71
    s_add_u32 m0, s62, 17408
    s_nop 0
    buffer_load_dwordx4 v6, s[12:15], s69 offen nt lds
    s_add_u32 s69, s69, s71
    s_add_u32 m0, s62, 2048
    s_nop 0
    buffer_load_dwordx4 v6, s[8:11], s68 offen nt lds
    s_add_u32 s68, s68, s71
    s_add_u32 m0, s62, 18432
    s_nop 0
    buffer_load_dwordx4 v6, s[12:15], s69 offen nt lds
    s_add_u32 s69, s69, s71
    s_add_u32 m0, s62, 3072
    s_nop 0
    buffer_load_dwordx4 v6, s[8:11], s68 offen nt lds
    s_add_u32 s68, s68, s71
    s_add_u32 m0, s62, 19456
    s_nop 0
    buffer_load_dwordx4 v6, s[12:15], s69 offen nt lds
    s_add_u32 s69, s69, s71
    s_waitcnt vmcnt(9)
    s_barrier
kvn_50:
    s_andn2_b32 s52, 0xf00, s84
    s_cbranch_scc0 kvd_51
    s_cmp_eq_u32 s78, -1
    s_cbranch_scc1 kvr_52
    buffer_load_dword v13, v11, s[16:19], 0 offen offset:0 sc1
    s_waitcnt vmcnt(0)
    v_cmp_ne_u32 s[78:79], 0, v13
kvr_52:
    s_andn2_b64 exec, s[86:87], s[84:85]
    buffer_load_dword v9, v10, s[4:7], s60 offen sc1
    s_waitcnt vmcnt(0)
    v_cmp_ne_u32 vcc, 0, v9
    s_mov_b64 exec, -1
    s_and_b32 s52, vcc_lo, s78
    s_or_b32 s84, s84, s52
    s_sub_u32 s46, s46, 1
    s_cbranch_scc0 kvn_50
    s_mov_b32 s46, 0
kvd_51:
    s_add_u32 s50, s40, 2
    s_and_b32 s50, s50, 7
    s_lshl_b32 s50, s50, 14
    s_add_u32 s50, s50, s59
    s_add_u32 s50, s50, s62
    s_mov_b32 s51, s62
    s_lshr_b32 s57, s62, 7
    s_add_u32 s51, s51, s57
    s_add_u32 m0, s51, 130816
    s_add_u32 s57, s50, 0
    buffer_load_dwordx4 v1, s[4:7], s57 offen offset:0 sc1 lds
    buffer_load_dwordx4 v1, s[4:7], s57 offen offset:1024 sc1 lds
    s_add_u32 m0, m0, 16
    s_nop 0
    buffer_load_dwordx4 v1, s[4:7], s57 offen offset:2048 sc1 lds
    buffer_load_dwordx4 v1, s[4:7], s57 offen offset:3072 sc1 lds
    global_load_dword v14, v5, s[96:97]
    s_waitcnt vmcnt(5)
    v_mov_b32 v8, 130784
    v_mov_b32 v9, 1
    s_mov_b64 exec, 1
    ds_add_u32 v8, v9
spin_53:
    ds_read_b32 v9, v8
    s_waitcnt lgkmcnt(0)
    v_cmp_gt_u32 vcc, 4, v9
    s_cbranch_vccz spind_54
    s_sub_u32 s46, s46, 1
    s_cbranch_scc0 spin_53
    s_mov_b32 s46, 0
spind_54:
    s_mov_b64 exec, -1
    ds_read_b64_tr_b16 v[24:25], v7 offset:0
    ds_read_b64_tr_b16 v[26:27], v7 offset:1024
    ds_read_b64_tr_b16 v[28:29], v7 offset:2048
    ds_read_b64_tr_b16 v[30:31], v7 offset:3072
    ds_read_b64_tr_b16 v[32:33], v7 offset:4096
    ds_read_b64_tr_b16 v[34:35], v7 offset:5120
    ds_read_b64_tr_b16 v[36:37], v7 offset:6144
    ds_read_b64_tr_b16 v[38:39], v7 offset:7168
    ds_read_b64_tr_b16 v[40:41], v7 offset:8192
    ds_read_b64_tr_b16 v[42:43], v7 offset:9216
    ds_read_b64_tr_b16 v[44:45], v7 offset:10240
    ds_read_b64_tr_b16 v[46:47], v7 offset:11264
    ds_read_b64_tr_b16 v[48:49], v7 offset:12288
    ds_read_b64_tr_b16 v[50:51], v7 offset:13312
    ds_read_b64_tr_b16 v[52:53], v7 offset:14336
    ds_read_b64_tr_b16 v[54:55], v7 offset:15360
    v_mov_b32 v72, 0x3f803f80
    v_mov_b32 v73, 0x3f803f80
    v_mov_b32 v74, 0x3f803f80
    v_mov_b32 v75, 0x3f803f80
    s_add_u32 s72, s67, s72
    s_waitcnt lgkmcnt(0)
    v_mfma_f32_32x32x16_bf16 v[56:71], v[72:75], v[24:27], 0
    buffer_store_dwordx4 v[24:27], v1, s[4:7], s67 offen offset:0 sc1
    v_mfma_f32_32x32x16_bf16 v[56:71], v[72:75], v[28:31], v[56:71]
    buffer_store_dwordx4 v[28:31], v1, s[4:7], s67 offen offset:1024 sc1
    v_mfma_f32_32x32x16_bf16 v[56:71], v[72:75], v[32:35], v[56:71]
    buffer_store_dwordx4 v[32:35], v1, s[4:7], s67 offen offset:2048 sc1
    v_mfma_f32_32x32x16_bf16 v[56:71], v[72:75], v[36:39], v[56:71]
    buffer_store_dwordx4 v[36:39], v1, s[4:7], s67 offen offset:3072 sc1
    v_mfma_f32_32x32x16_bf16 v[56:71], v[72:75], v[40:43], v[56:71]
    buffer_store_dwordx4 v[40:43], v1, s[4:7], s72 offen offset:0 sc1
    v_mfma_f32_32x32x16_bf16 v[56:71], v[72:75], v[44:47], v[56:71]
    buffer_store_dwordx4 v[44:47], v1, s[4:7], s72 offen offset:1024 sc1
    v_mfma_f32_32x32x16_bf16 v[56:71], v[72:75], v[48:51], v[56:71]
    buffer_store_dwordx4 v[48:51], v1, s[4:7], s72 offen offset:2048 sc1
    v_mfma_f32_32x32x16_bf16 v[56:71], v[72:75], v[52:55], v[56:71]
    buffer_store_dwordx4 v[52:55], v1, s[4:7], s72 offen offset:3072 sc1
    v_and_b32 v8, 0xf0, v1
    v_bfe_u32 v9, v0, 4, 1
    v_lshl_add_u32 v8, v9, 3, v8
    s_nop 7
    v_cvt_pk_bf16_f32 v58, v56, v56
    v_and_b32 v57, 0xffff0000, v58
    v_sub_f32 v57, v56, v57
    v_cvt_pk_bf16_f32 v59, v57, v57
    buffer_store_dwordx2 v[58:59], v8, s[4:7], s70 offen sc1
    s_waitcnt vmcnt(10)
    s_barrier
kvn_55:
    s_andn2_b32 s52, 0xf000, s84
    s_cbranch_scc0 kvd_56
    s_cmp_eq_u32 s78, -1
    s_cbranch_scc1 kvr_57
    buffer_load_dword v13, v11, s[16:19], 0 offen offset:0 sc1
    s_waitcnt vmcnt(0)
    v_cmp_ne_u32 s[78:79], 0, v13
kvr_57:
    s_andn2_b64 exec, s[86:87], s[84:85]
    buffer_load_dword v9, v10, s[4:7], s60 offen sc1
    s_waitcnt vmcnt(0)
    v_cmp_ne_u32 vcc, 0, v9
    s_mov_b64 exec, -1
    s_and_b32 s52, vcc_lo, s78
    s_or_b32 s84, s84, s52
    s_sub_u32 s46, s46, 1
    s_cbranch_scc0 kvn_55
    s_mov_b32 s46, 0
kvd_56:
    s_add_u32 s50, s40, 3
    s_and_b32 s50, s50, 7
    s_lshl_b32 s50, s50, 14
    s_add_u32 s50, s50, s59
    s_add_u32 s50, s50, s62
    s_mov_b32 s51, s62
    s_lshr_b32 s57, s62, 7
    s_add_u32 s51, s51, s57
    s_add_u32 m0, s51, 147328
    s_add_u32 s57, s50, 0
    buffer_load_dwordx4 v1, s[4:7], s57 offen offset:0 sc1 lds
    buffer_load_dwordx4 v1, s[4:7], s57 offen offset:1024 sc1 lds
    s_add_u32 m0, m0, 16
    s_nop 0
    buffer_load_dwordx4 v1, s[4:7], s57 offen offset:2048 sc1 lds
    buffer_load_dwordx4 v1, s[4:7], s57 offen offset:3072 sc1 lds
    global_load_dword v14, v5, s[96:97]
    s_waitcnt vmcnt(5)
    v_mov_b32 v8, 130784
    v_mov_b32 v9, 1
    s_mov_b64 exec, 1
    ds_add_u32 v8, v9
spin_58:
    ds_read_b32 v9, v8
    s_waitcnt lgkmcnt(0)
    v_cmp_gt_u32 vcc, 8, v9
    s_cbranch_vccz spind_59
    s_sub_u32 s46, s46, 1
    s_cbranch_scc0 spin_58
    s_mov_b32 s46, 0
spind_59:
    s_mov_b64 exec, -1
    s_cmp_lg_u32 s62, 0
    s_cbranch_scc1 w4_60
    s_add_u32 s50, s61, 4096
    v_mov_b32 v8, 1
    s_mov_b64 exec, 1
    buffer_store_dword v8, off, s[4:7], s50 offset:16 sc1
    s_mov_b64 exec, -1
w4_60:
    v_lshrrev_b32 v8, 5, v0
    v_lshlrev_b32 v8, 15, v8
    v_bfe_u32 v9, v0, 2, 3
    v_lshl_add_u32 v8, v9, 7, v8
    s_lshl_b32 s50, s40, 18
    s_lshr_b32 s57, s41, 3
    s_lshl_b32 s57, s57, 16
    s_add_u32 s50, s50, s57
    s_and_b32 s57, s41, 7
    s_lshl_b32 s57, s57, 12
    s_add_u32 s50, s50, s57
    s_lshr_b32 s57, s62, 2
    s_add_u32 s50, s50, s57
    buffer_load_dword v14, v8, s[4:7], s50 offen sc1
    v_lshrrev_b32 v8, 5, v0
    v_lshlrev_b32 v8, 7, v8
    s_lshl_b32 s50, s40, 15
    s_lshl_b32 s57, s41, 10
    s_add_u32 s50, s50, s57
    s_lshr_b32 s57, s62, 4
    s_add_u32 s50, s50, s57
    s_add_u32 s50, s50, 9437184
    buffer_load_dword v14, v8, s[4:7], s50 offen sc1
    s_waitcnt vmcnt(3)
    s_barrier
kvn_61:
    s_andn2_b32 s52, 0xf0000, s84
    s_cbranch_scc0 kvd_62
    s_cmp_eq_u32 s78, -1
    s_cbranch_scc1 kvr_63
    buffer_load_dword v13, v11, s[16:19], 0 offen offset:0 sc1
    s_waitcnt vmcnt(0)
    v_cmp_ne_u32 s[78:79], 0, v13
kvr_63:
    s_andn2_b64 exec, s[86:87], s[84:85]
    buffer_load_dword v9, v10, s[4:7], s60 offen sc1
    s_waitcnt vmcnt(0)
    v_cmp_ne_u32 vcc, 0, v9
    s_mov_b64 exec, -1
    s_and_b32 s52, vcc_lo, s78
    s_or_b32 s84, s84, s52
    s_sub_u32 s46, s46, 1
    s_cbranch_scc0 kvn_61
    s_mov_b32 s46, 0
kvd_62:
    s_add_u32 s50, s40, 4
    s_and_b32 s50, s50, 7
    s_lshl_b32 s50, s50, 14
    s_add_u32 s50, s50, s59
    s_add_u32 s50, s50, s62
    s_mov_b32 s51, s62
    s_lshr_b32 s57, s62, 7
    s_add_u32 s51, s51, s57
    s_add_u32 m0, s51, 130816
    s_add_u32 s57, s50, 0
    buffer_load_dwordx4 v1, s[4:7], s57 offen offset:0 sc1 lds
    buffer_load_dwordx4 v1, s[4:7], s57 offen offset:1024 sc1 lds
    s_add_u32 m0, m0, 16
    s_nop 0
    buffer_load_dwordx4 v1, s[4:7], s57 offen offset:2048 sc1 lds
    buffer_load_dwordx4 v1, s[4:7], s57 offen offset:3072 sc1 lds
    global_load_dword v14, v5, s[96:97]
    s_waitcnt vmcnt(1)
    v_min_u32 v12, 45, v0
    v_lshlrev_b32 v8, 2, v12
    s_bfe_u32 s50, s41, 0x20001
    v_add_u32 v9, s50, v8
    v_and_b32 v8, 0x70, v8
    v_and_b32 v13, 3, v12
    s_and_b32 s50, s41, 12
    v_add3_u32 v8, v8, v13, s50
    v_cmp_gt_u32 vcc, 28, v12
    s_nop 1
    v_cndmask_b32 v8, v9, v8, vcc
    v_and_b32 v12, 7, v8
    v_lshlrev_b32 v12, 14, v12
    v_lshrrev_b32 v8, 3, v8
    v_lshl_add_u32 v12, v8, 7, v12
    s_mov_b32 s52, 25174032
    s_mov_b32 s68, s78
    buffer_load_dword v15, v12, s[4:7], s52 offen sc1
    s_barrier
kvn_64:
    s_andn2_b32 s52, 0xf00000, s84
    s_cbranch_scc0 kvd_65
    s_cmp_eq_u32 s78, -1
    s_cbranch_scc1 kvr_66
    buffer_load_dword v13, v11, s[16:19], 0 offen offset:0 sc1
    s_waitcnt vmcnt(0)
    v_cmp_ne_u32 s[78:79], 0, v13
kvr_66:
    s_andn2_b64 exec, s[86:87], s[84:85]
    buffer_load_dword v9, v10, s[4:7], s60 offen sc1
    s_waitcnt vmcnt(0)
    v_cmp_ne_u32 vcc, 0, v9
    s_mov_b64 exec, -1
    s_and_b32 s52, vcc_lo, s78
    s_or_b32 s84, s84, s52
    s_sub_u32 s46, s46, 1
    s_cbranch_scc0 kvn_64
    s_mov_b32 s46, 0
kvd_65:
    s_add_u32 s50, s40, 5
    s_and_b32 s50, s50, 7
    s_lshl_b32 s50, s50, 14
    s_add_u32 s50, s50, s59
    s_add_u32 s50, s50, s62
    s_mov_b32 s51, s62
    s_lshr_b32 s57, s62, 7
    s_add_u32 s51, s51, s57
    s_add_u32 m0, s51, 147328
    s_add_u32 s57, s50, 0
    buffer_load_dwordx4 v1, s[4:7], s57 offen offset:0 sc1 lds
    buffer_load_dwordx4 v1, s[4:7], s57 offen offset:1024 sc1 lds
    s_add_u32 m0, m0, 16
    s_nop 0
    buffer_load_dwordx4 v1, s[4:7], s57 offen offset:2048 sc1 lds
    buffer_load_dwordx4 v1, s[4:7], s57 offen offset:3072 sc1 lds
    global_load_dword v14, v5, s[96:97]
    s_waitcnt vmcnt(5)
    v_cmp_eq_u32 vcc, 0, v15
    s_nop 0
    s_orn2_b32 s52, vcc_lo, s68
    s_or_b32 s52, s52, vcc_hi
    s_cbranch_scc0 pwd_67
spin_68:
    buffer_load_dword v13, v11, s[16:19], 0 offen offset:0 sc1
    s_waitcnt vmcnt(0)
    v_cmp_eq_u32 vcc, 0, v13
    s_cbranch_vccz spind_69
    s_sub_u32 s46, s46, 1
    s_cbranch_scc0 spin_68
    s_mov_b32 s46, 0
spind_69:
    s_mov_b32 s52, 25174032
spin_70:
    buffer_load_dword v13, v12, s[4:7], s52 offen sc1
    s_waitcnt vmcnt(0)
    v_cmp_eq_u32 vcc, 0, v13
    s_cbranch_vccz spind_71
    s_sub_u32 s46, s46, 1
    s_cbranch_scc0 spin_70
    s_mov_b32 s46, 0
spind_71:
pwd_67:
    s_mov_b32 s78, -1
    s_add_u32 m0, s62, 0
    s_add_u32 s57, s65, 0
    buffer_load_dwordx4 v1, s[4:7], s57 offen offset:0 sc1 lds
    buffer_load_dwordx4 v1, s[4:7], s57 offen offset:1024 sc1 lds
    buffer_load_dwordx4 v1, s[4:7], s57 offen offset:2048 sc1 lds
    buffer_load_dwordx4 v1, s[4:7], s57 offen offset:3072 sc1 lds
    s_add_u32 m0, s62, 16384
    s_add_u32 s57, s65, 16384
    buffer_load_dwordx4 v1, s[4:7], s57 offen offset:0 sc1 lds
    buffer_load_dwordx4 v1, s[4:7], s57 offen offset:1024 sc1 lds
    buffer_load_dwordx4 v1, s[4:7], s57 offen offset:2048 sc1 lds
    buffer_load_dwordx4 v1, s[4:7], s57 offen offset:3072 sc1 lds
    s_add_u32 m0, s62, 32768
    s_add_u32 s57, s65, 32768
    buffer_load_dwordx4 v1, s[4:7], s57 offen offset:0 sc1 lds
    buffer_load_dwordx4 v1, s[4:7], s57 offen offset:1024 sc1 lds
    buffer_load_dwordx4 v1, s[4:7], s57 offen offset:2048 sc1 lds
    buffer_load_dwordx4 v1, s[4:7], s57 offen offset:3072 sc1 lds
    s_add_u32 m0, s62, 49152
    s_add_u32 s57, s65, 49152
    buffer_load_dwordx4 v1, s[4:7], s57 offen offset:0 sc1 lds
    buffer_load_dwordx4 v1, s[4:7], s57 offen offset:1024 sc1 lds
    buffer_load_dwordx4 v1, s[4:7], s57 offen offset:2048 sc1 lds
    buffer_load_dwordx4 v1, s[4:7], s57 offen offset:3072 sc1 lds
    s_add_u32 s57, s64, 196608
    buffer_load_dwordx4 v[120:123], v1, s[4:7], s57 offen offset:0 sc1
    buffer_load_dwordx4 v[124:127], v1, s[4:7], s57 offen offset:1024 sc1
    buffer_load_dwordx4 v[128:131], v1, s[4:7], s57 offen offset:2048 sc1
    buffer_load_dwordx4 v[132:135], v1, s[4:7], s57 offen offset:3072 sc1
    s_add_u32 s57, s64, 212992
    buffer_load_dwordx4 v[136:139], v1, s[4:7], s57 offen offset:0 sc1
    buffer_load_dwordx4 v[140:143], v1, s[4:7], s57 offen offset:1024 sc1
    buffer_load_dwordx4 v[144:147], v1, s[4:7], s57 offen offset:2048 sc1
    buffer_load_dwordx4 v[148:151], v1, s[4:7], s57 offen offset:3072 sc1
    s_waitcnt vmcnt(25)
    s_barrier
kvn_72:
    s_andn2_b32 s52, 0xf000000, s84
    s_cbranch_scc0 kvd_73
    s_cmp_eq_u32 s78, -1
    s_cbranch_scc1 kvr_74
    buffer_load_dword v13, v11, s[16:19], 0 offen offset:0 sc1
    s_waitcnt vmcnt(0)
    v_cmp_ne_u32 s[78:79], 0, v13
kvr_74:
    s_andn2_b64 exec, s[86:87], s[84:85]
    buffer_load_dword v9, v10, s[4:7], s60 offen sc1
    s_waitcnt vmcnt(0)
    v_cmp_ne_u32 vcc, 0, v9
    s_mov_b64 exec, -1
    s_and_b32 s52, vcc_lo, s78
    s_or_b32 s84, s84, s52
    s_sub_u32 s46, s46, 1
    s_cbranch_scc0 kvn_72
    s_mov_b32 s46, 0
kvd_73:
    s_add_u32 s50, s40, 6
    s_and_b32 s50, s50, 7
    s_lshl_b32 s50, s50, 14
    s_add_u32 s50, s50, s59
    s_add_u32 s50, s50, s62
    s_mov_b32 s51, s62
    s_lshr_b32 s57, s62, 7
    s_add_u32 s51, s51, s57
    s_add_u32 m0, s51, 130816
    s_add_u32 s57, s50, 0
    buffer_load_dwordx4 v1, s[4:7], s57 offen offset:0 sc1 lds
    buffer_load_dwordx4 v1, s[4:7], s57 offen offset:1024 sc1 lds
    s_add_u32 m0, m0, 16
    s_nop 0
    buffer_load_dwordx4 v1, s[4:7], s57 offen offset:2048 sc1 lds
    buffer_load_dwordx4 v1, s[4:7], s57 offen offset:3072 sc1 lds
    global_load_dword v14, v5, s[96:97]
    s_add_u32 m0, s62, 65536
    s_add_u32 s57, s63, 0
    buffer_load_dwordx4 v1, s[4:7], s57 offen offset:0 sc1 lds
    buffer_load_dwordx4 v1, s[4:7], s57 offen offset:1024 sc1 lds
    buffer_load_dwordx4 v1, s[4:7], s57 offen offset:2048 sc1 lds
    buffer_load_dwordx4 v1, s[4:7], s57 offen offset:3072 sc1 lds
    s_add_u32 m0, s62, 81920
    s_add_u32 s57, s63, 16384
    buffer_load_dwordx4 v1, s[4:7], s57 offen offset:0 sc1 lds
    buffer_load_dwordx4 v1, s[4:7], s57 offen offset:1024 sc1 lds
    buffer_load_dwordx4 v1, s[4:7], s57 offen offset:2048 sc1 lds
    buffer_load_dwordx4 v1, s[4:7], s57 offen offset:3072 sc1 lds
    s_add_u32 m0, s62, 98304
    s_add_u32 s57, s63, 32768
    buffer_load_dwordx4 v1, s[4:7], s57 offen offset:0 sc1 lds
    buffer_load_dwordx4 v1, s[4:7], s57 offen offset:1024 sc1 lds
    buffer_load_dwordx4 v1, s[4:7], s57 offen offset:2048 sc1 lds
    buffer_load_dwordx4 v1, s[4:7], s57 offen offset:3072 sc1 lds
    s_add_u32 m0, s62, 114688
    s_add_u32 s57, s63, 49152
    buffer_load_dwordx4 v1, s[4:7], s57 offen offset:0 sc1 lds
    buffer_load_dwordx4 v1, s[4:7], s57 offen offset:1024 sc1 lds
    buffer_load_dwordx4 v1, s[4:7], s57 offen offset:2048 sc1 lds
    buffer_load_dwordx4 v[20:23], v1, s[4:7], s57 offen offset:3072 sc1
    s_add_u32 s57, s63, 65536
    buffer_load_dwordx4 v[24:27], v1, s[4:7], s57 offen offset:0 sc1
    buffer_load_dwordx4 v[28:31], v1, s[4:7], s57 offen offset:1024 sc1
    buffer_load_dwordx4 v[32:35], v1, s[4:7], s57 offen offset:2048 sc1
    buffer_load_dwordx4 v[36:39], v1, s[4:7], s57 offen offset:3072 sc1
    s_waitcnt vmcnt(21)
    s_barrier
kvn_75:
    s_andn2_b32 s52, 0xf0000000, s84
    s_cbranch_scc0 kvd_76
    s_cmp_eq_u32 s78, -1
    s_cbranch_scc1 kvr_77
    buffer_load_dword v13, v11, s[16:19], 0 offen offset:0 sc1
    s_waitcnt vmcnt(0)
    v_cmp_ne_u32 s[78:79], 0, v13
kvr_77:
    s_andn2_b64 exec, s[86:87], s[84:85]
    buffer_load_dword v9, v10, s[4:7], s60 offen sc1
    s_waitcnt vmcnt(0)
    v_cmp_ne_u32 vcc, 0, v9
    s_mov_b64 exec, -1
    s_and_b32 s52, vcc_lo, s78
    s_or_b32 s84, s84, s52
    s_sub_u32 s46, s46, 1
    s_cbranch_scc0 kvn_75
    s_mov_b32 s46, 0
kvd_76:
    s_add_u32 s50, s40, 7
    s_and_b32 s50, s50, 7
    s_lshl_b32 s50, s50, 14
    s_add_u32 s50, s50, s59
    s_add_u32 s50, s50, s62
    s_mov_b32 s51, s62
    s_lshr_b32 s57, s62, 7
    s_add_u32 s51, s51, s57
    s_add_u32 m0, s51, 147328
    s_add_u32 s57, s50, 0
    buffer_load_dwordx4 v1, s[4:7], s57 offen offset:0 sc1 lds
    buffer_load_dwordx4 v1, s[4:7], s57 offen offset:1024 sc1 lds
    s_add_u32 m0, m0, 16
    s_nop 0
    buffer_load_dwordx4 v1, s[4:7], s57 offen offset:2048 sc1 lds
    buffer_load_dwordx4 v1, s[4:7], s57 offen offset:3072 sc1 lds
    global_load_dword v14, v5, s[96:97]
kvn_78:
    s_andn2_b32 s52, 0xf, s84
    s_cbranch_scc0 kvd_79
    s_cmp_eq_u32 s78, -1
    s_cbranch_scc1 kvr_80
    buffer_load_dword v13, v11, s[16:19], 0 offen offset:0 sc1
    s_waitcnt vmcnt(0)
    v_cmp_ne_u32 s[78:79], 0, v13
kvr_80:
    s_mov_b64 exec, 0xf
    buffer_load_dword v9, v10, s[4:7], s60 offen sc1
    s_waitcnt vmcnt(0)
    v_cmp_ne_u32 vcc, 0, v9
    s_mov_b64 exec, -1
    s_and_b32 s52, vcc_lo, s78
    s_or_b32 s84, s84, s52
    s_sub_u32 s46, s46, 1
    s_cbranch_scc0 kvn_78
    s_mov_b32 s46, 0
kvd_79:
    s_add_u32 s50, s40, 0
    s_and_b32 s50, s50, 7
    buffer_load_dword v17, v10, s[4:7], s60 offen sc1
    s_add_u32 s57, s63, 81920
    buffer_load_dwordx4 v[40:43], v1, s[4:7], s57 offen offset:0 sc1
    buffer_load_dwordx4 v[44:47], v1, s[4:7], s57 offen offset:1024 sc1
    buffer_load_dwordx4 v[48:51], v1, s[4:7], s57 offen offset:2048 sc1
    buffer_load_dwordx4 v[52:55], v1, s[4:7], s57 offen offset:3072 sc1
    s_add_u32 s57, s63, 98304
    buffer_load_dwordx4 v[56:59], v1, s[4:7], s57 offen offset:0 sc1
    buffer_load_dwordx4 v[60:63], v1, s[4:7], s57 offen offset:1024 sc1
    buffer_load_dwordx4 v[64:67], v1, s[4:7], s57 offen offset:2048 sc1
    buffer_load_dwordx4 v[68:71], v1, s[4:7], s57 offen offset:3072 sc1
    s_add_u32 s57, s63, 114688
    buffer_load_dwordx4 v[72:75], v1, s[4:7], s57 offen offset:0 sc1
    buffer_load_dwordx4 v[76:79], v1, s[4:7], s57 offen offset:1024 sc1
    buffer_load_dwordx4 v[80:83], v1, s[4:7], s57 offen offset:2048 sc1
    buffer_load_dwordx4 v[84:87], v1, s[4:7], s57 offen offset:3072 sc1
    s_add_u32 s57, s63, 131072
    buffer_load_dwordx4 v[88:91], v1, s[4:7], s57 offen offset:0 sc1
    buffer_load_dwordx4 v[92:95], v1, s[4:7], s57 offen offset:1024 sc1
    buffer_load_dwordx4 v[96:99], v1, s[4:7], s57 offen offset:2048 sc1
    buffer_load_dwordx4 v[100:103], v1, s[4:7], s57 offen offset:3072 sc1
    s_mov_b32 s8, s20
    s_and_b32 s9, s21, 0xffff
    s_mov_b32 s10, 2097152
    s_mov_b32 s11, 0x20000
    s_lshl_b32 s51, s40, 3
    s_lshr_b32 s57, s41, 3
    s_lshl_b32 s57, s57, 1
    s_add_u32 s51, s51, s57
    s_lshr_b32 s57, s62, 12
    s_and_b32 s57, s57, 1
    s_add_u32 s51, s51, s57
    s_and_b32 s52, s41, 7
    s_lshl_b32 s52, s52, 1
    s_lshr_b32 s57, s62, 13
    s_add_u32 s52, s52, s57
    s_lshl_b32 s50, s51, 15
    s_lshl_b32 s57, s52, 6
    s_add_u32 s50, s50, s57
    v_and_b32 v8, 31, v0
    v_lshlrev_b32 v8, 10, v8
    v_lshrrev_b32 v9, 5, v0
    v_lshl_add_u32 v8, v9, 3, v8
    buffer_load_dwordx2 v[6:7], v8, s[8:11], s50 offen offset:0
    buffer_load_dwordx2 v[12:13], v8, s[8:11], s50 offen offset:16
    buffer_load_dwordx2 v[254:255], v8, s[8:11], s50 offen offset:32
    buffer_load_dwordx2 v[18:19], v8, s[8:11], s50 offen offset:48
    s_waitcnt vmcnt(22)
    s_waitcnt vmcnt(20)
    v_max_u32_dpp v17, v17, v17 quad_perm:[1,0,3,2] row_mask:0xf bank_mask:0xf
    s_nop 1
    v_max_u32_dpp v17, v17, v17 quad_perm:[2,3,0,1] row_mask:0xf bank_mask:0xf
    s_nop 1
    v_max_u32_dpp v17, v17, v17 row_half_mirror row_mask:0xf bank_mask:0xf
    s_nop 1
    v_max_u32_dpp v17, v17, v17 row_mirror row_mask:0xf bank_mask:0xf
    v_mov_b32 v8, v17
    s_nop 1
    v_permlane16_swap_b32 v17, v8
    v_max_u32 v17, v17, v8
    v_mul_f32 v17, v16, v17
    v_cmp_nge_f32 vcc, 0x45100000, v17
    s_lshr_b32 s50, s62, 10
    s_add_u32 s50, s50, 130720
    s_or_b32 s51, vcc_lo, vcc_hi
    v_mov_b32 v8, s50
    v_mov_b32 v9, s51
    ds_write_b32 v8, v9
    s_waitcnt lgkmcnt(0)
    s_barrier
    global_load_dword v14, v5, s[96:97]
    s_and_b32 s50, s41, 15
    s_mul_i32 s50, s50, 7168
    s_lshr_b32 s57, s62, 1
    s_add_u32 s50, s50, s57
    s_add_u32 s50, s50, 14155776
    s_lshr_b32 s53, s62, 1
    s_cmp_eq_u32 s42, 7
    s_cbranch_scc1 mb_81
    s_add_u32 m0, s53, 131072
    s_add_u32 s57, s50, 0
    buffer_load_dwordx4 v1, s[4:7], s57 offen offset:0 sc1 lds
    s_cmp_eq_u32 s42, 6
    s_cbranch_scc1 mb_81
    buffer_load_dwordx4 v1, s[4:7], s57 offen offset:1024 sc1 lds
mb_81:
    s_add_u32 s53, s53, 136192
    v_add_u32 v8, s53, v1
    s_waitcnt vmcnt(1)
    ds_write_b64 v8, v[6:7] offset:0
    ds_write_b64 v8, v[12:13] offset:8
    ds_write_b64 v8, v[254:255] offset:1024
    ds_write_b64 v8, v[18:19] offset:1032
    s_add_u32 s57, s63, 147456
    buffer_load_dwordx4 v[104:107], v1, s[4:7], s57 offen offset:0 sc1
    buffer_load_dwordx4 v[108:111], v1, s[4:7], s57 offen offset:1024 sc1
    buffer_load_dwordx4 v[112:115], v1, s[4:7], s57 offen offset:2048 sc1
    buffer_load_dwordx4 v[116:119], v1, s[4:7], s57 offen offset:3072 sc1
    v_lshrrev_b32 v8, 5, v0
    v_mul_u32_u24 v8, 114688, v8
    v_bfe_u32 v9, v0, 2, 3
    v_lshl_add_u32 v8, v9, 7, v8
    s_mul_i32 s50, s40, 917504
    s_mul_i32 s57, s62, 56
    s_add_u32 s50, s50, s57
    s_lshl_b32 s57, s41, 10
    s_add_u32 s50, s50, s57
    s_add_u32 s50, s50, 2097152
    buffer_load_dword v14, v8, s[4:7], s50 offen sc1
    v_lshrrev_b32 v8, 5, v0
    v_lshlrev_b32 v8, 15, v8
    v_bfe_u32 v9, v0, 2, 3
    v_lshl_add_u32 v8, v9, 7, v8
    s_lshl_b32 s50, s40, 18
    s_lshr_b32 s57, s41, 3
    s_lshl_b32 s57, s57, 16
    s_add_u32 s50, s50, s57
    s_and_b32 s57, s41, 7
    s_lshl_b32 s57, s57, 12
    s_add_u32 s50, s50, s57
    s_lshr_b32 s57, s62, 2
    s_add_u32 s50, s50, s57
    buffer_load_dword v14, v8, s[4:7], s50 offen sc1
    v_lshrrev_b32 v8, 5, v0
    v_lshlrev_b32 v8, 7, v8
    s_lshl_b32 s50, s40, 15
    s_lshl_b32 s57, s41, 10
    s_add_u32 s50, s50, s57
    s_lshr_b32 s57, s62, 4
    s_add_u32 s50, s50, s57
    s_add_u32 s50, s50, 9437184
    buffer_load_dword v14, v8, s[4:7], s50 offen sc1
    v_min_u32 v8, 39, v0
    v_lshlrev_b32 v8, 7, v8
    s_mul_i32 s50, s40, 917504
    s_lshr_b32 s57, s41, 2
    s_mul_i32 s57, s57, 114688
    s_add_u32 s50, s50, s57
    s_and_b32 s57, s41, 3
    s_mul_i32 s57, s57, 20480
    s_add_u32 s50, s50, s57
    s_lshr_b32 s57, s62, 12
    s_mul_i32 s57, s57, 5120
    s_add_u32 s50, s50, s57
    s_add_u32 s50, s50, 2129920
    buffer_load_dword v14, v8, s[4:7], s50 offen sc1
    s_setprio 0
    s_waitcnt vmcnt(0)
    s_waitcnt lgkmcnt(0)
    s_barrier
    s_barrier
    ds_write_b128 v3, v[20:23] offset:52224
    ds_write_b128 v4, v[24:27] offset:0
    ds_write_b128 v4, v[28:31] offset:1024
    ds_write_b128 v4, v[32:35] offset:2048
    ds_write_b128 v4, v[36:39] offset:3072
    s_barrier
    ds_write_b128 v2, v[40:43] offset:0
    ds_write_b128 v2, v[44:47] offset:1024
    ds_write_b128 v2, v[48:51] offset:2048
    ds_write_b128 v2, v[52:55] offset:3072
    ds_write_b128 v2, v[56:59] offset:16384
    ds_write_b128 v2, v[60:63] offset:17408
    ds_write_b128 v2, v[64:67] offset:18432
    ds_write_b128 v2, v[68:71] offset:19456
    ds_write_b128 v2, v[72:75] offset:32768
    ds_write_b128 v2, v[76:79] offset:33792
    ds_write_b128 v2, v[80:83] offset:34816
    ds_write_b128 v2, v[84:87] offset:35840
    ds_write_b128 v2, v[88:91] offset:49152
    ds_write_b128 v2, v[92:95] offset:50176
    ds_write_b128 v2, v[96:99] offset:51200
    ds_write_b128 v2, v[100:103] offset:52224
    s_waitcnt lgkmcnt(12)
    s_barrier
    ds_write_b128 v4, v[104:107] offset:16384
    ds_write_b128 v4, v[108:111] offset:17408
    ds_write_b128 v4, v[112:115] offset:18432
    ds_write_b128 v4, v[116:119] offset:19456
    s_waitcnt lgkmcnt(0)
    s_barrier
    s_add_u32 m0, s62, 65536
    s_add_u32 s57, s63, 163840
    buffer_load_dwordx4 v1, s[4:7], s57 offen offset:0 sc1 lds
    buffer_load_dwordx4 v1, s[4:7], s57 offen offset:1024 sc1 lds
    buffer_load_dwordx4 v1, s[4:7], s57 offen offset:2048 sc1 lds
    buffer_load_dwordx4 v1, s[4:7], s57 offen offset:3072 sc1 lds
    s_add_u32 m0, s62, 98304
    s_add_u32 s57, s63, 196608
    buffer_load_dwordx4 v1, s[4:7], s57 offen offset:0 sc1 lds
    buffer_load_dwordx4 v1, s[4:7], s57 offen offset:1024 sc1 lds
    s_waitcnt vmcnt(5)
    buffer_load_dwordx4 v1, s[4:7], s57 offen offset:2048 sc1 lds
    s_waitcnt vmcnt(5)
    buffer_load_dwordx4 v1, s[4:7], s57 offen offset:3072 sc1 lds
    s_add_u32 m0, s62, 131072
    s_add_u32 s57, s64, 0
    s_waitcnt vmcnt(5)
    buffer_load_dwordx4 v1, s[4:7], s57 offen offset:0 sc1 lds
    s_waitcnt vmcnt(5)
    buffer_load_dwordx4 v1, s[4:7], s57 offen offset:1024 sc1 lds
    s_waitcnt vmcnt(5)
    buffer_load_dwordx4 v1, s[4:7], s57 offen offset:2048 sc1 lds
    s_waitcnt vmcnt(5)
    buffer_load_dwordx4 v1, s[4:7], s57 offen offset:3072 sc1 lds
    s_add_u32 s57, s64, 131072
    buffer_load_dwordx4 v[24:27], v1, s[4:7], s57 offen offset:0 sc1
    buffer_load_dwordx4 v[28:31], v1, s[4:7], s57 offen offset:1024 sc1
    buffer_load_dwordx4 v[32:35], v1, s[4:7], s57 offen offset:2048 sc1
    buffer_load_dwordx4 v[36:39], v1, s[4:7], s57 offen offset:3072 sc1
    global_load_dword v14, v5, s[96:97]
    s_barrier
    s_add_u32 m0, s62, 81920
    s_add_u32 s57, s63, 180224
    s_waitcnt vmcnt(5)
    buffer_load_dwordx4 v1, s[4:7], s57 offen offset:0 sc1 lds
    s_waitcnt vmcnt(5)
    buffer_load_dwordx4 v1, s[4:7], s57 offen offset:1024 sc1 lds
    s_waitcnt vmcnt(5)
    buffer_load_dwordx4 v1, s[4:7], s57 offen offset:2048 sc1 lds
    s_waitcnt vmcnt(5)
    buffer_load_dwordx4 v1, s[4:7], s57 offen offset:3072 sc1 lds
    s_add_u32 m0, s62, 114688
    s_add_u32 s57, s63, 212992
    s_waitcnt vmcnt(5)
    buffer_load_dwordx4 v1, s[4:7], s57 offen offset:0 sc1 lds
    s_waitcnt vmcnt(5)
    buffer_load_dwordx4 v1, s[4:7], s57 offen offset:1024 sc1 lds
    s_waitcnt vmcnt(5)
    buffer_load_dwordx4 v1, s[4:7], s57 offen offset:2048 sc1 lds
    s_waitcnt vmcnt(5)
    buffer_load_dwordx4 v1, s[4:7], s57 offen offset:3072 sc1 lds
    s_add_u32 m0, s62, 0
    s_add_u32 s57, s64, 16384
    s_waitcnt vmcnt(5)
    buffer_load_dwordx4 v1, s[4:7], s57 offen offset:0 sc1 lds
    s_waitcnt vmcnt(5)
    buffer_load_dwordx4 v1, s[4:7], s57 offen offset:1024 sc1 lds
    s_waitcnt vmcnt(5)
    buffer_load_dwordx4 v1, s[4:7], s57 offen offset:2048 sc1 lds
    s_waitcnt vmcnt(5)
    buffer_load_dwordx4 v1, s[4:7], s57 offen offset:3072 sc1 lds
    s_barrier
    s_add_u32 m0, s62, 16384
    s_add_u32 s57, s64, 32768
    s_waitcnt vmcnt(5)
    buffer_load_dwordx4 v1, s[4:7], s57 offen offset:0 sc1 lds
    s_waitcnt vmcnt(5)
    buffer_load_dwordx4 v1, s[4:7], s57 offen offset:1024 sc1 lds
    s_waitcnt vmcnt(5)
    buffer_load_dwordx4 v1, s[4:7], s57 offen offset:2048 sc1 lds
    s_waitcnt vmcnt(5)
    buffer_load_dwordx4 v1, s[4:7], s57 offen offset:3072 sc1 lds
    s_add_u32 m0, s62, 49152
    s_add_u32 s57, s64, 65536
    s_waitcnt vmcnt(5)
    buffer_load_dwordx4 v1, s[4:7], s57 offen offset:0 sc1 lds
    s_waitcnt vmcnt(5)
    buffer_load_dwordx4 v1, s[4:7], s57 offen offset:1024 sc1 lds
    s_waitcnt vmcnt(5)
    buffer_load_dwordx4 v1, s[4:7], s57 offen offset:2048 sc1 lds
    s_waitcnt vmcnt(5)
    buffer_load_dwordx4 v1, s[4:7], s57 offen offset:3072 sc1 lds
    s_add_u32 s57, s64, 147456
    buffer_load_dwordx4 v[40:43], v1, s[4:7], s57 offen offset:0 sc1
    buffer_load_dwordx4 v[44:47], v1, s[4:7], s57 offen offset:1024 sc1
    buffer_load_dwordx4 v[48:51], v1, s[4:7], s57 offen offset:2048 sc1
    buffer_load_dwordx4 v[52:55], v1, s[4:7], s57 offen offset:3072 sc1
    s_barrier
    s_cmp_lg_u32 s62, 0
    s_cbranch_scc1 w4_82
    s_add_u32 s56, s49, 2
    v_mov_b32 v13, s56
    s_mov_b64 exec, 1
    s_cmp_lg_u32 s45, 0
    s_cbranch_scc1 pubs_83
    buffer_store_dword v13, off, s[4:7], s48
pubd_84:
    s_mov_b64 exec, -1
w4_82:
    s_add_u32 m0, s62, 32768
    s_add_u32 s57, s64, 49152
    s_waitcnt vmcnt(5)
    buffer_load_dwordx4 v1, s[4:7], s57 offen offset:0 sc1 lds
    s_waitcnt vmcnt(5)
    buffer_load_dwordx4 v1, s[4:7], s57 offen offset:1024 sc1 lds
    s_waitcnt vmcnt(5)
    buffer_load_dwordx4 v1, s[4:7], s57 offen offset:2048 sc1 lds
    s_waitcnt vmcnt(5)
    buffer_load_dwordx4 v1, s[4:7], s57 offen offset:3072 sc1 lds
    s_add_u32 m0, s62, 147456
    s_add_u32 s57, s64, 81920
    s_waitcnt vmcnt(5)
    buffer_load_dwordx4 v1, s[4:7], s57 offen offset:0 sc1 lds
    s_waitcnt vmcnt(5)
    buffer_load_dwordx4 v1, s[4:7], s57 offen offset:1024 sc1 lds
    s_waitcnt vmcnt(5)
    buffer_load_dwordx4 v1, s[4:7], s57 offen offset:2048 sc1 lds
    s_waitcnt vmcnt(5)
    buffer_load_dwordx4 v1, s[4:7], s57 offen offset:3072 sc1 lds
    s_add_u32 s57, s64, 163840
    buffer_load_dwordx4 v[56:59], v1, s[4:7], s57 offen offset:0 sc1
    buffer_load_dwordx4 v[60:63], v1, s[4:7], s57 offen offset:1024 sc1
    buffer_load_dwordx4 v[64:67], v1, s[4:7], s57 offen offset:2048 sc1
    buffer_load_dwordx4 v[68:71], v1, s[4:7], s57 offen offset:3072 sc1
    s_barrier
    s_cmp_lg_u32 s62, 0
    s_cbranch_scc1 w4_85
    s_add_u32 s56, s49, 3
    v_mov_b32 v13, s56
    s_mov_b64 exec, 1
    s_cmp_lg_u32 s45, 0
    s_cbranch_scc1 pubs_86
    buffer_store_dword v13, off, s[4:7], s48
pubd_87:
    s_mov_b64 exec, -1
w4_85:
    s_add_u32 m0, s62, 65536
    s_add_u32 s57, s64, 98304
    s_waitcnt vmcnt(5)
    buffer_load_dwordx4 v1, s[4:7], s57 offen offset:0 sc1 lds
    s_waitcnt vmcnt(5)
    buffer_load_dwordx4 v1, s[4:7], s57 offen offset:1024 sc1 lds
    s_waitcnt vmcnt(5)
    buffer_load_dwordx4 v1, s[4:7], s57 offen offset:2048 sc1 lds
    s_waitcnt vmcnt(5)
    buffer_load_dwordx4 v1, s[4:7], s57 offen offset:3072 sc1 lds
    s_add_u32 m0, s62, 81920
    s_add_u32 s57, s64, 114688
    s_waitcnt vmcnt(5)
    buffer_load_dwordx4 v1, s[4:7], s57 offen offset:0 sc1 lds
    s_waitcnt vmcnt(5)
    buffer_load_dwordx4 v1, s[4:7], s57 offen offset:1024 sc1 lds
    s_waitcnt vmcnt(5)
    buffer_load_dwordx4 v1, s[4:7], s57 offen offset:2048 sc1 lds
    s_waitcnt vmcnt(5)
    buffer_load_dwordx4 v1, s[4:7], s57 offen offset:3072 sc1 lds
    s_add_u32 s57, s64, 180224
    buffer_load_dwordx4 v[72:75], v1, s[4:7], s57 offen offset:0 sc1
    buffer_load_dwordx4 v[76:79], v1, s[4:7], s57 offen offset:1024 sc1
    buffer_load_dwordx4 v[80:83], v1, s[4:7], s57 offen offset:2048 sc1
    buffer_load_dwordx4 v[84:87], v1, s[4:7], s57 offen offset:3072 sc1
    s_barrier
    s_cmp_lg_u32 s62, 0
    s_cbranch_scc1 w4_88
    s_add_u32 s56, s49, 4
    v_mov_b32 v13, s56
    s_mov_b64 exec, 1
    s_cmp_lg_u32 s45, 0
    s_cbranch_scc1 pubs_89
    buffer_store_dword v13, off, s[4:7], s48
pubd_90:
    s_mov_b64 exec, -1
w4_88:
    global_load_dword v14, v5, s[96:97]
    ds_write_b128 v3, v[24:27] offset:32768
    ds_write_b128 v3, v[28:31] offset:33792
    ds_write_b128 v3, v[32:35] offset:34816
    ds_write_b128 v3, v[36:39] offset:35840
    ds_write_b128 v3, v[40:43] offset:49152
    ds_write_b128 v3, v[44:47] offset:50176
    ds_write_b128 v3, v[48:51] offset:51200
    ds_write_b128 v3, v[52:55] offset:52224
    s_waitcnt vmcnt(9)
    s_waitcnt vmcnt(5)
    s_waitcnt lgkmcnt(4)
    s_barrier
    s_cmp_lg_u32 s62, 0
    s_cbranch_scc1 w4_91
    s_add_u32 s56, s49, 5
    v_mov_b32 v13, s56
    s_mov_b64 exec, 1
    s_cmp_lg_u32 s45, 0
    s_cbranch_scc1 pubs_92
    buffer_store_dword v13, off, s[4:7], s48
pubd_93:
    s_mov_b64 exec, -1
w4_91:
    ds_write_b128 v4, v[56:59] offset:0
    ds_write_b128 v4, v[60:63] offset:1024
    ds_write_b128 v4, v[64:67] offset:2048
    ds_write_b128 v4, v[68:71] offset:3072
    ds_write_b128 v2, v[120:123] offset:16384
    ds_write_b128 v2, v[124:127] offset:17408
    ds_write_b128 v2, v[128:131] offset:18432
    ds_write_b128 v2, v[132:135] offset:19456
    s_waitcnt vmcnt(1)
    ds_write_b128 v2, v[72:75] offset:0
    ds_write_b128 v2, v[76:79] offset:1024
    ds_write_b128 v2, v[80:83] offset:2048
    ds_write_b128 v2, v[84:87] offset:3072
    s_lshr_b32 s51, s62, 12
    s_mul_i32 s51, s51, 3072
    s_add_u32 s51, s51, 49152
    v_add_u32 v8, s51, v1
    v_add_u32 v9, 49152, v8
    s_lshr_b32 s50, s62, 12
    s_lshl_b32 s50, s50, 8
    s_add_u32 s50, s50, 46080
    v_and_b32 v12, 0xf0, v1
    v_bfe_u32 v15, v0, 4, 1
    v_lshl_add_u32 v12, v15, 3, v12
    v_add_u32 v12, s50, v12
    s_waitcnt lgkmcnt(8)
    s_barrier
    ds_write_b128 v2, v[136:139] offset:32768
    ds_write_b128 v2, v[140:143] offset:33792
    ds_write_b128 v2, v[144:147] offset:34816
    ds_write_b128 v2, v[148:151] offset:35840
    s_waitcnt lgkmcnt(0)
    s_barrier
    ds_write_b128 v8, v[152:155] offset:0
    ds_write_b128 v8, v[156:159] offset:1024
    ds_write_b128 v8, v[160:163] offset:2048
    ds_write_b128 v8, v[164:167] offset:12288
    ds_write_b128 v8, v[168:171] offset:13312
    ds_write_b128 v8, v[172:175] offset:14336
    ds_write_b128 v8, v[176:179] offset:24576
    ds_write_b128 v8, v[180:183] offset:25600
    ds_write_b128 v8, v[184:187] offset:26624
    s_barrier
    ds_write_b128 v8, v[188:191] offset:36864
    ds_write_b128 v8, v[192:195] offset:37888
    ds_write_b128 v8, v[196:199] offset:38912
    ds_write_b128 v9, v[200:203] offset:0
    ds_write_b128 v9, v[204:207] offset:1024
    ds_write_b128 v9, v[208:211] offset:2048
    ds_write_b128 v9, v[212:215] offset:12288
    ds_write_b128 v9, v[216:219] offset:13312
    ds_write_b128 v9, v[220:223] offset:14336
    ds_write_b128 v9, v[224:227] offset:24576
    ds_write_b128 v9, v[228:231] offset:25600
    ds_write_b128 v9, v[232:235] offset:26624
    ds_write_b128 v9, v[236:239] offset:36864
    ds_write_b128 v9, v[240:243] offset:37888
    ds_write_b128 v9, v[244:247] offset:38912
    ds_write_b64 v12, v[248:249] offset:0
    ds_write_b64 v12, v[250:251] offset:1024
    ds_write_b64 v12, v[252:253] offset:2048
    s_add_u32 s59, s59, 4194304
    s_add_u32 s61, s61, 4096
    s_waitcnt lgkmcnt(0)
    s_barrier
    v_lshrrev_b32 v10, 2, v0
    v_add_u32 v10, s40, v10
    v_and_b32 v10, 7, v10
    v_lshlrev_b32 v10, 14, v10
    v_and_b32 v8, 1, v0
    v_lshl_add_u32 v10, v8, 7, v10
    s_and_b32 s60, s41, 30
    s_lshl_b32 s60, s60, 7
    s_and_b32 s57, s41, 1
    s_lshl_b32 s57, s57, 2
    s_add_u32 s60, s60, s57
    s_add_u32 s60, s60, 25174016
    s_mov_b64 s[84:85], 0
    s_not_b64 s[86:87], s[80:81]
    v_mov_b32 v20, 0x3f803f80
    v_mov_b32 v21, 0x3f803f80
    v_mov_b32 v22, 0x3f803f80
    v_mov_b32 v23, 0x3f803f80
    v_bfe_u32 v8, v0, 4, 1
    v_mul_u32_u24 v8, 2064, v8
    v_lshrrev_b32 v9, 5, v0
    v_mul_u32_u24 v9, 16512, v9
    s_mov_b32 s51, s62
    s_lshr_b32 s57, s62, 7
    s_add_u32 s51, s51, s57
    s_add_u32 s51, s51, 132864
    v_add3_u32 v8, v8, v9, s51
    v_bfe_u32 v12, v0, 3, 1
    s_and_b32 s50, s41, 30
    s_lshl_b32 s50, s50, 2
    s_lshr_b32 s57, s62, 13
    s_lshl_b32 s57, s57, 2
    s_add_u32 s50, s50, s57
    s_lshr_b32 s57, s62, 12
    s_and_b32 s57, s57, 1
    s_lshl_b32 s57, s57, 8
    s_add_u32 s50, s50, s57
    v_lshl_add_u32 v12, v12, 7, s50
    s_waitcnt lgkmcnt(0)
    s_barrier
    ds_write_b128 v8, v[20:23]
    s_mul_i32 s50, s40, 917504
    s_mul_i32 s57, s62, 56
    s_add_u32 s50, s50, s57
    s_lshl_b32 s57, s41, 10
    s_add_u32 s50, s50, s57
    s_add_u32 s50, s50, 2097152
    s_lshr_b32 s51, s62, 1
    s_lshl_b32 s52, s40, 14
    s_add_u32 s52, s52, s59
    s_add_u32 s52, s52, s62
    s_lshr_b32 s53, s62, 1
    s_lshr_b32 s57, s62, 8
    s_add_u32 s53, s53, s57
    s_barrier
    s_add_u32 s56, s49, 17
pl_94:
    buffer_load_dword v13, v12, s[4:7], s47 offen sc1
    s_sub_u32 s46, s46, 1
    s_cbranch_scc1 pt_95
    s_cmp_lg_u32 s45, 0
    s_waitcnt vmcnt(0)
    v_cmp_gt_u32 vcc, s56, v13
    s_cbranch_vccnz pl_94
    s_cbranch_scc1 pa_96
pd_97:
    s_add_u32 m0, s53, 130816
    s_add_u32 s57, s52, 0
    buffer_load_dwordx4 v1, s[4:7], s57 offen offset:0 sc1 lds
    buffer_load_dwordx4 v1, s[4:7], s57 offen offset:1024 sc1 lds
    s_add_u32 m0, s51, 32768
    s_add_u32 s57, s50, 0
    buffer_load_dwordx4 v1, s[4:7], s57 offen offset:0 sc1 lds
    s_add_u32 m0, s51, 33792
    s_add_u32 s57, s50, 114688
    buffer_load_dwordx4 v1, s[4:7], s57 offen offset:0 sc1 lds
    s_add_u32 m0, s53, 139072
    s_add_u32 s57, s52, 2048
    buffer_load_dwordx4 v1, s[4:7], s57 offen offset:0 sc1 lds
    buffer_load_dwordx4 v1, s[4:7], s57 offen offset:1024 sc1 lds
    s_setprio 1
    s_waitcnt vmcnt(2)
    s_waitcnt lgkmcnt(0)
    s_barrier
    s_lshr_b32 s50, s62, 1
    v_add_u32 v8, s50, v1
    ds_read_b128 v[160:163], v8 offset:32768
    ds_read_b128 v[164:167], v8 offset:33792
    s_waitcnt vmcnt(0)
    s_barrier
kvn_98:
    s_andn2_b32 s52, 0xf0, s84
    s_cbranch_scc0 kvd_99
    s_mov_b64 exec, 0xf0
    buffer_load_dword v9, v10, s[4:7], s60 offen sc1
    s_waitcnt vmcnt(0)
    v_cmp_ne_u32 vcc, 0, v9
    s_mov_b64 exec, -1
    s_and_b32 s52, vcc_lo, s78
    s_or_b32 s84, s84, s52
    s_sub_u32 s46, s46, 1
    s_cbranch_scc0 kvn_98
    s_mov_b32 s46, 0
kvd_99:
    s_add_u32 s50, s40, 1
    s_and_b32 s50, s50, 7
    s_lshl_b32 s50, s50, 14
    s_add_u32 s50, s50, s59
    s_add_u32 s50, s50, s62
    s_mov_b32 s51, s62
    s_lshr_b32 s57, s62, 7
    s_add_u32 s51, s51, s57
    s_add_u32 m0, s51, 147328
    s_add_u32 s57, s50, 0
    buffer_load_dwordx4 v1, s[4:7], s57 offen offset:0 sc1 lds
    buffer_load_dwordx4 v1, s[4:7], s57 offen offset:1024 sc1 lds
    s_add_u32 m0, m0, 16
    s_nop 0
    buffer_load_dwordx4 v1, s[4:7], s57 offen offset:2048 sc1 lds
    buffer_load_dwordx4 v1, s[4:7], s57 offen offset:3072 sc1 lds
    s_waitcnt lgkmcnt(0)
    v_dot2_f32_bf16 v16, v160, v160, 0
    v_dot2_f32_bf16 v17, v164, v164, 0
    v_dot2_f32_bf16 v16, v161, v161, v16
    v_dot2_f32_bf16 v17, v165, v165, v17
    v_dot2_f32_bf16 v16, v162, v162, v16
    v_dot2_f32_bf16 v17, v166, v166, v17
    v_dot2_f32_bf16 v16, v163, v163, v16
    v_dot2_f32_bf16 v17, v167, v167, v17
    s_nop 2
    v_permlane32_swap_b32 v16, v17
    v_add_f32 v16, v16, v17
    global_load_dword v14, v5, s[96:97]
    s_waitcnt vmcnt(1)
    s_barrier
kvn_101:
    s_andn2_b32 s52, 0xf00, s84
    s_cbranch_scc0 kvd_102
    s_andn2_b64 exec, s[86:87], s[84:85]
    buffer_load_dword v9, v10, s[4:7], s60 offen sc1
    s_waitcnt vmcnt(0)
    v_cmp_ne_u32 vcc, 0, v9
    s_mov_b64 exec, -1
    s_and_b32 s52, vcc_lo, s78
    s_or_b32 s84, s84, s52
    s_sub_u32 s46, s46, 1
    s_cbranch_scc0 kvn_101
    s_mov_b32 s46, 0
kvd_102:
    s_add_u32 s50, s40, 2
    s_and_b32 s50, s50, 7
    s_lshl_b32 s50, s50, 14
    s_add_u32 s50, s50, s59
    s_add_u32 s50, s50, s62
    s_mov_b32 s51, s62
    s_lshr_b32 s57, s62, 7
    s_add_u32 s51, s51, s57
    s_add_u32 m0, s51, 130816
    s_add_u32 s57, s50, 0
    buffer_load_dwordx4 v1, s[4:7], s57 offen offset:0 sc1 lds
    buffer_load_dwordx4 v1, s[4:7], s57 offen offset:1024 sc1 lds
    s_add_u32 m0, m0, 16
    s_nop 0
    buffer_load_dwordx4 v1, s[4:7], s57 offen offset:2048 sc1 lds
    buffer_load_dwordx4 v1, s[4:7], s57 offen offset:3072 sc1 lds
    global_load_dword v14, v5, s[96:97]
    s_waitcnt vmcnt(1)
    s_barrier
kvn_104:
    s_andn2_b32 s52, 0xf000, s84
    s_cbranch_scc0 kvd_105
    s_andn2_b64 exec, s[86:87], s[84:85]
    buffer_load_dword v9, v10, s[4:7], s60 offen sc1
    s_waitcnt vmcnt(0)
    v_cmp_ne_u32 vcc, 0, v9
    s_mov_b64 exec, -1
    s_and_b32 s52, vcc_lo, s78
    s_or_b32 s84, s84, s52
    s_sub_u32 s46, s46, 1
    s_cbranch_scc0 kvn_104
    s_mov_b32 s46, 0
kvd_105:
    s_add_u32 s50, s40, 3
    s_and_b32 s50, s50, 7
    s_lshl_b32 s50, s50, 14
    s_add_u32 s50, s50, s59
    s_add_u32 s50, s50, s62
    s_mov_b32 s51, s62
    s_lshr_b32 s57, s62, 7
    s_add_u32 s51, s51, s57
    s_add_u32 m0, s51, 147328
    s_add_u32 s57, s50, 0
    buffer_load_dwordx4 v1, s[4:7], s57 offen offset:0 sc1 lds
    buffer_load_dwordx4 v1, s[4:7], s57 offen offset:1024 sc1 lds
    s_add_u32 m0, m0, 16
    s_nop 0
    buffer_load_dwordx4 v1, s[4:7], s57 offen offset:2048 sc1 lds
    buffer_load_dwordx4 v1, s[4:7], s57 offen offset:3072 sc1 lds
    global_load_dword v14, v5, s[96:97]
    s_waitcnt vmcnt(1)
    s_barrier
kvn_107:
    s_andn2_b32 s52, 0xf0000, s84
    s_cbranch_scc0 kvd_108
    s_andn2_b64 exec, s[86:87], s[84:85]
    buffer_load_dword v9, v10, s[4:7], s60 offen sc1
    s_waitcnt vmcnt(0)
    v_cmp_ne_u32 vcc, 0, v9
    s_mov_b64 exec, -1
    s_and_b32 s52, vcc_lo, s78
    s_or_b32 s84, s84, s52
    s_sub_u32 s46, s46, 1
    s_cbranch_scc0 kvn_107
    s_mov_b32 s46, 0
kvd_108:
    s_add_u32 s50, s40, 4
    s_and_b32 s50, s50, 7
    s_lshl_b32 s50, s50, 14
    s_add_u32 s50, s50, s59
    s_add_u32 s50, s50, s62
    s_mov_b32 s51, s62
    s_lshr_b32 s57, s62, 7
    s_add_u32 s51, s51, s57
    s_add_u32 m0, s51, 130816
    s_add_u32 s57, s50, 0
    buffer_load_dwordx4 v1, s[4:7], s57 offen offset:0 sc1 lds
    buffer_load_dwordx4 v1, s[4:7], s57 offen offset:1024 sc1 lds
    s_add_u32 m0, m0, 16
    s_nop 0
    buffer_load_dwordx4 v1, s[4:7], s57 offen offset:2048 sc1 lds
    buffer_load_dwordx4 v1, s[4:7], s57 offen offset:3072 sc1 lds
    global_load_dword v14, v5, s[96:97]
    s_add_u32 m0, s62, 0
    s_add_u32 s57, s65, 0
    buffer_load_dwordx4 v1, s[4:7], s57 offen offset:0 sc1 lds
    buffer_load_dwordx4 v1, s[4:7], s57 offen offset:1024 sc1 lds
    buffer_load_dwordx4 v1, s[4:7], s57 offen offset:2048 sc1 lds
    buffer_load_dwordx4 v1, s[4:7], s57 offen offset:3072 sc1 lds
    s_add_u32 m0, s62, 16384
    s_add_u32 s57, s65, 16384
    buffer_load_dwordx4 v1, s[4:7], s57 offen offset:0 sc1 lds
    buffer_load_dwordx4 v1, s[4:7], s57 offen offset:1024 sc1 lds
    buffer_load_dwordx4 v1, s[4:7], s57 offen offset:2048 sc1 lds
    buffer_load_dwordx4 v1, s[4:7], s57 offen offset:3072 sc1 lds
    s_add_u32 m0, s62, 32768
    s_add_u32 s57, s65, 32768
    buffer_load_dwordx4 v1, s[4:7], s57 offen offset:0 sc1 lds
    buffer_load_dwordx4 v1, s[4:7], s57 offen offset:1024 sc1 lds
    buffer_load_dwordx4 v1, s[4:7], s57 offen offset:2048 sc1 lds
    buffer_load_dwordx4 v1, s[4:7], s57 offen offset:3072 sc1 lds
    s_waitcnt vmcnt(13)
    s_barrier
kvn_110:
    s_andn2_b32 s52, 0xf00000, s84
    s_cbranch_scc0 kvd_111
    s_andn2_b64 exec, s[86:87], s[84:85]
    buffer_load_dword v9, v10, s[4:7], s60 offen sc1
    s_waitcnt vmcnt(0)
    v_cmp_ne_u32 vcc, 0, v9
    s_mov_b64 exec, -1
    s_and_b32 s52, vcc_lo, s78
    s_or_b32 s84, s84, s52
    s_sub_u32 s46, s46, 1
    s_cbranch_scc0 kvn_110
    s_mov_b32 s46, 0
kvd_111:
    s_add_u32 s50, s40, 5
    s_and_b32 s50, s50, 7
    s_lshl_b32 s50, s50, 14
    s_add_u32 s50, s50, s59
    s_add_u32 s50, s50, s62
    s_mov_b32 s51, s62
    s_lshr_b32 s57, s62, 7
    s_add_u32 s51, s51, s57
    s_add_u32 m0, s51, 147328
    s_add_u32 s57, s50, 0
    buffer_load_dwordx4 v1, s[4:7], s57 offen offset:0 sc1 lds
    buffer_load_dwordx4 v1, s[4:7], s57 offen offset:1024 sc1 lds
    s_add_u32 m0, m0, 16
    s_nop 0
    buffer_load_dwordx4 v1, s[4:7], s57 offen offset:2048 sc1 lds
    buffer_load_dwordx4 v1, s[4:7], s57 offen offset:3072 sc1 lds
    global_load_dword v14, v5, s[96:97]
    s_add_u32 m0, s62, 49152
    s_add_u32 s57, s65, 49152
    buffer_load_dwordx4 v1, s[4:7], s57 offen offset:0 sc1 lds
    buffer_load_dwordx4 v1, s[4:7], s57 offen offset:1024 sc1 lds
    buffer_load_dwordx4 v1, s[4:7], s57 offen offset:2048 sc1 lds
    buffer_load_dwordx4 v1, s[4:7], s57 offen offset:3072 sc1 lds
    s_add_u32 m0, s62, 65536
    s_add_u32 s57, s63, 0
    buffer_load_dwordx4 v1, s[4:7], s57 offen offset:0 sc1 lds
    buffer_load_dwordx4 v1, s[4:7], s57 offen offset:1024 sc1 lds
    buffer_load_dwordx4 v1, s[4:7], s57 offen offset:2048 sc1 lds
    buffer_load_dwordx4 v1, s[4:7], s57 offen offset:3072 sc1 lds
    s_add_u32 m0, s62, 81920
    s_add_u32 s57, s63, 16384
    buffer_load_dwordx4 v1, s[4:7], s57 offen offset:0 sc1 lds
    buffer_load_dwordx4 v1, s[4:7], s57 offen offset:1024 sc1 lds
    buffer_load_dwordx4 v1, s[4:7], s57 offen offset:2048 sc1 lds
    buffer_load_dwordx4 v1, s[4:7], s57 offen offset:3072 sc1 lds
    s_waitcnt vmcnt(13)
    s_barrier
kvn_113:
    s_andn2_b32 s52, 0xf000000, s84
    s_cbranch_scc0 kvd_114
    s_andn2_b64 exec, s[86:87], s[84:85]
    buffer_load_dword v9, v10, s[4:7], s60 offen sc1
    s_waitcnt vmcnt(0)
    v_cmp_ne_u32 vcc, 0, v9
    s_mov_b64 exec, -1
    s_and_b32 s52, vcc_lo, s78
    s_or_b32 s84, s84, s52
    s_sub_u32 s46, s46, 1
    s_cbranch_scc0 kvn_113
    s_mov_b32 s46, 0
kvd_114:
    s_add_u32 s50, s40, 6
    s_and_b32 s50, s50, 7
    s_lshl_b32 s50, s50, 14
    s_add_u32 s50, s50, s59
    s_add_u32 s50, s50, s62
    s_mov_b32 s51, s62
    s_lshr_b32 s57, s62, 7
    s_add_u32 s51, s51, s57
    s_add_u32 m0, s51, 130816
    s_add_u32 s57, s50, 0
    buffer_load_dwordx4 v1, s[4:7], s57 offen offset:0 sc1 lds
    buffer_load_dwordx4 v1, s[4:7], s57 offen offset:1024 sc1 lds
    s_add_u32 m0, m0, 16
    s_nop 0
    buffer_load_dwordx4 v1, s[4:7], s57 offen offset:2048 sc1 lds
    buffer_load_dwordx4 v1, s[4:7], s57 offen offset:3072 sc1 lds
    global_load_dword v14, v5, s[96:97]
    s_add_u32 m0, s62, 98304
    s_add_u32 s57, s63, 32768
    buffer_load_dwordx4 v1, s[4:7], s57 offen offset:0 sc1 lds
    buffer_load_dwordx4 v1, s[4:7], s57 offen offset:1024 sc1 lds
    buffer_load_dwordx4 v1, s[4:7], s57 offen offset:2048 sc1 lds
    buffer_load_dwordx4 v1, s[4:7], s57 offen offset:3072 sc1 lds
    s_add_u32 m0, s62, 114688
    s_add_u32 s57, s63, 49152
    buffer_load_dwordx4 v1, s[4:7], s57 offen offset:0 sc1 lds
    buffer_load_dwordx4 v1, s[4:7], s57 offen offset:1024 sc1 lds
    buffer_load_dwordx4 v1, s[4:7], s57 offen offset:2048 sc1 lds
    buffer_load_dwordx4 v[20:23], v1, s[4:7], s57 offen offset:3072 sc1
    s_add_u32 s57, s63, 65536
    buffer_load_dwordx4 v[152:155], v1, s[4:7], s57 offen offset:0 sc1
    buffer_load_dwordx4 v[156:159], v1, s[4:7], s57 offen offset:1024 sc1
    buffer_load_dwordx4 v[160:163], v1, s[4:7], s57 offen offset:2048 sc1
    buffer_load_dwordx4 v[164:167], v1, s[4:7], s57 offen offset:3072 sc1
    s_waitcnt vmcnt(13)
    s_barrier
kvn_116:
    s_andn2_b32 s52, 0xf0000000, s84
    s_cbranch_scc0 kvd_117
    s_andn2_b64 exec, s[86:87], s[84:85]
    buffer_load_dword v9, v10, s[4:7], s60 offen sc1
    s_waitcnt vmcnt(0)
    v_cmp_ne_u32 vcc, 0, v9
    s_mov_b64 exec, -1
    s_and_b32 s52, vcc_lo, s78
    s_or_b32 s84, s84, s52
    s_sub_u32 s46, s46, 1
    s_cbranch_scc0 kvn_116
    s_mov_b32 s46, 0
kvd_117:
    s_add_u32 s50, s40, 7
    s_and_b32 s50, s50, 7
    s_lshl_b32 s50, s50, 14
    s_add_u32 s50, s50, s59
    s_add_u32 s50, s50, s62
    s_mov_b32 s51, s62
    s_lshr_b32 s57, s62, 7
    s_add_u32 s51, s51, s57
    s_add_u32 m0, s51, 147328
    s_add_u32 s57, s50, 0
    buffer_load_dwordx4 v1, s[4:7], s57 offen offset:0 sc1 lds
    buffer_load_dwordx4 v1, s[4:7], s57 offen offset:1024 sc1 lds
    s_add_u32 m0, m0, 16
    s_nop 0
    buffer_load_dwordx4 v1, s[4:7], s57 offen offset:2048 sc1 lds
    buffer_load_dwordx4 v1, s[4:7], s57 offen offset:3072 sc1 lds
    global_load_dword v14, v5, s[96:97]
kvn_119:
    s_andn2_b32 s52, 0xf, s84
    s_cbranch_scc0 kvd_120
    s_mov_b64 exec, 0xf
    buffer_load_dword v9, v10, s[4:7], s60 offen sc1
    s_waitcnt vmcnt(0)
    v_cmp_ne_u32 vcc, 0, v9
    s_mov_b64 exec, -1
    s_and_b32 s52, vcc_lo, s78
    s_or_b32 s84, s84, s52
    s_sub_u32 s46, s46, 1
    s_cbranch_scc0 kvn_119
    s_mov_b32 s46, 0
kvd_120:
    s_add_u32 s50, s40, 0
    s_and_b32 s50, s50, 7
    buffer_load_dword v17, v10, s[4:7], s60 offen sc1
    s_add_u32 s57, s63, 81920
    buffer_load_dwordx4 v[168:171], v1, s[4:7], s57 offen offset:0 sc1
    buffer_load_dwordx4 v[172:175], v1, s[4:7], s57 offen offset:1024 sc1
    buffer_load_dwordx4 v[176:179], v1, s[4:7], s57 offen offset:2048 sc1
    buffer_load_dwordx4 v[180:183], v1, s[4:7], s57 offen offset:3072 sc1
    s_add_u32 s57, s63, 98304
    buffer_load_dwordx4 v[184:187], v1, s[4:7], s57 offen offset:0 sc1
    buffer_load_dwordx4 v[188:191], v1, s[4:7], s57 offen offset:1024 sc1
    buffer_load_dwordx4 v[192:195], v1, s[4:7], s57 offen offset:2048 sc1
    buffer_load_dwordx4 v[196:199], v1, s[4:7], s57 offen offset:3072 sc1
    s_add_u32 s57, s63, 114688
    buffer_load_dwordx4 v[200:203], v1, s[4:7], s57 offen offset:0 sc1
    buffer_load_dwordx4 v[204:207], v1, s[4:7], s57 offen offset:1024 sc1
    buffer_load_dwordx4 v[208:211], v1, s[4:7], s57 offen offset:2048 sc1
    buffer_load_dwordx4 v[212:215], v1, s[4:7], s57 offen offset:3072 sc1
    v_min_u32 v8, 39, v0
    v_lshlrev_b32 v8, 7, v8
    s_mul_i32 s50, s40, 917504
    s_lshr_b32 s57, s41, 2
    s_mul_i32 s57, s57, 114688
    s_add_u32 s50, s50, s57
    s_and_b32 s57, s41, 3
    s_mul_i32 s57, s57, 20480
    s_add_u32 s50, s50, s57
    s_lshr_b32 s57, s62, 12
    s_mul_i32 s57, s57, 5120
    s_add_u32 s50, s50, s57
    s_add_u32 s50, s50, 2129920
    buffer_load_dword v14, v8, s[4:7], s50 offen sc1
    s_waitcnt vmcnt(15)
    s_waitcnt vmcnt(13)
    v_max_u32_dpp v17, v17, v17 quad_perm:[1,0,3,2] row_mask:0xf bank_mask:0xf
    s_nop 1
    v_max_u32_dpp v17, v17, v17 quad_perm:[2,3,0,1] row_mask:0xf bank_mask:0xf
    s_nop 1
    v_max_u32_dpp v17, v17, v17 row_half_mirror row_mask:0xf bank_mask:0xf
    s_nop 1
    v_max_u32_dpp v17, v17, v17 row_mirror row_mask:0xf bank_mask:0xf
    v_mov_b32 v8, v17
    s_nop 1
    v_permlane16_swap_b32 v17, v8
    v_max_u32 v17, v17, v8
    v_mul_f32 v17, v16, v17
    v_cmp_nge_f32 vcc, 0x45100000, v17
    s_lshr_b32 s50, s62, 10
    s_add_u32 s50, s50, 130720
    s_or_b32 s51, vcc_lo, vcc_hi
    v_mov_b32 v8, s50
    v_mov_b32 v9, s51
    ds_write_b32 v8, v9
    s_waitcnt lgkmcnt(0)
    s_barrier
    global_load_dword v14, v5, s[96:97]
    s_and_b32 s50, s41, 15
    s_mul_i32 s50, s50, 7168
    s_lshr_b32 s57, s62, 1
    s_add_u32 s50, s50, s57
    s_add_u32 s50, s50, 14155776
    s_lshr_b32 s53, s62, 1
    s_cmp_eq_u32 s42, 7
    s_cbranch_scc1 mb_122
    s_add_u32 m0, s53, 131072
    s_add_u32 s57, s50, 0
    buffer_load_dwordx4 v1, s[4:7], s57 offen offset:0 sc1 lds
    s_cmp_eq_u32 s42, 6
    s_cbranch_scc1 mb_122
    buffer_load_dwordx4 v1, s[4:7], s57 offen offset:1024 sc1 lds
mb_122:
    s_lshl_b32 s51, s40, 3
    s_lshr_b32 s57, s41, 3
    s_lshl_b32 s57, s57, 1
    s_add_u32 s51, s51, s57
    s_lshr_b32 s57, s62, 12
    s_and_b32 s57, s57, 1
    s_add_u32 s51, s51, s57
    s_and_b32 s52, s41, 7
    s_lshl_b32 s52, s52, 1
    s_lshr_b32 s57, s62, 13
    s_add_u32 s52, s52, s57
    s_lshl_b32 s50, s51, 15
    s_lshl_b32 s57, s52, 11
    s_add_u32 s50, s50, s57
    s_add_u32 m0, s53, 136192
    s_add_u32 s57, s50, 0
    buffer_load_dwordx4 v1, s[4:7], s57 offen offset:0 sc1 lds
    buffer_load_dwordx4 v1, s[4:7], s57 offen offset:1024 sc1 lds
    v_lshrrev_b32 v8, 5, v0
    v_mul_u32_u24 v8, 114688, v8
    v_bfe_u32 v9, v0, 2, 3
    v_lshl_add_u32 v8, v9, 7, v8
    s_mul_i32 s50, s40, 917504
    s_mul_i32 s57, s62, 56
    s_add_u32 s50, s50, s57
    s_lshl_b32 s57, s41, 10
    s_add_u32 s50, s50, s57
    s_add_u32 s50, s50, 2097152
    buffer_load_dword v14, v8, s[4:7], s50 offen sc1
    v_lshrrev_b32 v8, 5, v0
    v_lshlrev_b32 v8, 7, v8
    s_lshl_b32 s50, s40, 15
    s_lshl_b32 s57, s41, 10
    s_add_u32 s50, s50, s57
    s_lshr_b32 s57, s62, 4
    s_add_u32 s50, s50, s57
    s_add_u32 s50, s50, 9437184
    buffer_load_dword v14, v8, s[4:7], s50 offen sc1
    s_setprio 0
    s_waitcnt vmcnt(0)
    s_waitcnt lgkmcnt(0)
    s_barrier
    s_barrier
    ds_write_b128 v3, v[20:23] offset:52224
    ds_write_b128 v4, v[152:155] offset:0
    ds_write_b128 v4, v[156:159] offset:1024
    ds_write_b128 v4, v[160:163] offset:2048
    ds_write_b128 v4, v[164:167] offset:3072
    s_barrier
    ds_write_b128 v2, v[168:171] offset:0
    ds_write_b128 v2, v[172:175] offset:1024
    ds_write_b128 v2, v[176:179] offset:2048
    ds_write_b128 v2, v[180:183] offset:3072
    ds_write_b128 v2, v[184:187] offset:16384
    ds_write_b128 v2, v[188:191] offset:17408
    ds_write_b128 v2, v[192:195] offset:18432
    ds_write_b128 v2, v[196:199] offset:19456
    ds_write_b128 v2, v[200:203] offset:32768
    ds_write_b128 v2, v[204:207] offset:33792
    ds_write_b128 v2, v[208:211] offset:34816
    ds_write_b128 v2, v[212:215] offset:35840
    ds_write_b128 v2, v[88:91] offset:49152
    ds_write_b128 v2, v[92:95] offset:50176
    ds_write_b128 v2, v[96:99] offset:51200
    ds_write_b128 v2, v[100:103] offset:52224
    s_waitcnt lgkmcnt(12)
    s_barrier
    ds_write_b128 v4, v[104:107] offset:16384
    ds_write_b128 v4, v[108:111] offset:17408
    ds_write_b128 v4, v[112:115] offset:18432
    ds_write_b128 v4, v[116:119] offset:19456
    s_waitcnt lgkmcnt(0)
    s_barrier
    s_add_u32 m0, s62, 65536
    s_add_u32 s57, s63, 163840
    buffer_load_dwordx4 v1, s[4:7], s57 offen offset:0 sc1 lds
    buffer_load_dwordx4 v1, s[4:7], s57 offen offset:1024 sc1 lds
    buffer_load_dwordx4 v1, s[4:7], s57 offen offset:2048 sc1 lds
    buffer_load_dwordx4 v1, s[4:7], s57 offen offset:3072 sc1 lds
    s_add_u32 m0, s62, 98304
    s_add_u32 s57, s63, 196608
    buffer_load_dwordx4 v1, s[4:7], s57 offen offset:0 sc1 lds
    buffer_load_dwordx4 v1, s[4:7], s57 offen offset:1024 sc1 lds
    s_waitcnt vmcnt(5)
    buffer_load_dwordx4 v1, s[4:7], s57 offen offset:2048 sc1 lds
    s_waitcnt vmcnt(5)
    buffer_load_dwordx4 v1, s[4:7], s57 offen offset:3072 sc1 lds
    s_add_u32 m0, s62, 131072
    s_add_u32 s57, s64, 0
    s_waitcnt vmcnt(5)
    buffer_load_dwordx4 v1, s[4:7], s57 offen offset:0 sc1 lds
    s_waitcnt vmcnt(5)
    buffer_load_dwordx4 v1, s[4:7], s57 offen offset:1024 sc1 lds
    s_waitcnt vmcnt(5)
    buffer_load_dwordx4 v1, s[4:7], s57 offen offset:2048 sc1 lds
    s_waitcnt vmcnt(5)
    buffer_load_dwordx4 v1, s[4:7], s57 offen offset:3072 sc1 lds
    s_barrier
    s_add_u32 m0, s62, 81920
    s_add_u32 s57, s63, 180224
    s_waitcnt vmcnt(5)
    buffer_load_dwordx4 v1, s[4:7], s57 offen offset:0 sc1 lds
    s_waitcnt vmcnt(5)
    buffer_load_dwordx4 v1, s[4:7], s57 offen offset:1024 sc1 lds
    s_waitcnt vmcnt(5)
    buffer_load_dwordx4 v1, s[4:7], s57 offen offset:2048 sc1 lds
    s_waitcnt vmcnt(5)
    buffer_load_dwordx4 v1, s[4:7], s57 offen offset:3072 sc1 lds
    s_add_u32 m0, s62, 114688
    s_add_u32 s57, s63, 212992
    s_waitcnt vmcnt(5)
    buffer_load_dwordx4 v1, s[4:7], s57 offen offset:0 sc1 lds
    s_waitcnt vmcnt(5)
    buffer_load_dwordx4 v1, s[4:7], s57 offen offset:1024 sc1 lds
    s_waitcnt vmcnt(5)
    buffer_load_dwordx4 v1, s[4:7], s57 offen offset:2048 sc1 lds
    s_waitcnt vmcnt(5)
    buffer_load_dwordx4 v1, s[4:7], s57 offen offset:3072 sc1 lds
    s_add_u32 m0, s62, 0
    s_add_u32 s57, s64, 16384
    s_waitcnt vmcnt(5)
    buffer_load_dwordx4 v1, s[4:7], s57 offen offset:0 sc1 lds
    s_waitcnt vmcnt(5)
    buffer_load_dwordx4 v1, s[4:7], s57 offen offset:1024 sc1 lds
    s_waitcnt vmcnt(5)
    buffer_load_dwordx4 v1, s[4:7], s57 offen offset:2048 sc1 lds
    s_waitcnt vmcnt(5)
    buffer_load_dwordx4 v1, s[4:7], s57 offen offset:3072 sc1 lds
    s_barrier
    s_add_u32 m0, s62, 16384
    s_add_u32 s57, s64, 32768
    s_waitcnt vmcnt(5)
    buffer_load_dwordx4 v1, s[4:7], s57 offen offset:0 sc1 lds
    s_waitcnt vmcnt(5)
    buffer_load_dwordx4 v1, s[4:7], s57 offen offset:1024 sc1 lds
    s_waitcnt vmcnt(5)
    buffer_load_dwordx4 v1, s[4:7], s57 offen offset:2048 sc1 lds
    s_waitcnt vmcnt(5)
    buffer_load_dwordx4 v1, s[4:7], s57 offen offset:3072 sc1 lds
    s_add_u32 m0, s62, 49152
    s_add_u32 s57, s64, 65536
    s_waitcnt vmcnt(5)
    buffer_load_dwordx4 v1, s[4:7], s57 offen offset:0 sc1 lds
    s_waitcnt vmcnt(5)
    buffer_load_dwordx4 v1, s[4:7], s57 offen offset:1024 sc1 lds
    s_waitcnt vmcnt(5)
    buffer_load_dwordx4 v1, s[4:7], s57 offen offset:2048 sc1 lds
    s_waitcnt vmcnt(5)
    buffer_load_dwordx4 v1, s[4:7], s57 offen offset:3072 sc1 lds
    s_barrier
    s_cmp_lg_u32 s62, 0
    s_cbranch_scc1 w4_123
    s_add_u32 s56, s49, 18
    v_mov_b32 v13, s56
    s_mov_b64 exec, 1
    s_cmp_lg_u32 s45, 0
    s_cbranch_scc1 pubs_124
    buffer_store_dword v13, off, s[4:7], s48
pubd_125:
    s_mov_b64 exec, -1
w4_123:
    s_add_u32 m0, s62, 32768
    s_add_u32 s57, s64, 49152
    s_waitcnt vmcnt(5)
    buffer_load_dwordx4 v1, s[4:7], s57 offen offset:0 sc1 lds
    s_waitcnt vmcnt(5)
    buffer_load_dwordx4 v1, s[4:7], s57 offen offset:1024 sc1 lds
    s_waitcnt vmcnt(5)
    buffer_load_dwordx4 v1, s[4:7], s57 offen offset:2048 sc1 lds
    s_waitcnt vmcnt(5)
    buffer_load_dwordx4 v1, s[4:7], s57 offen offset:3072 sc1 lds
    s_add_u32 m0, s62, 147456
    s_add_u32 s57, s64, 81920
    s_waitcnt vmcnt(5)
    buffer_load_dwordx4 v1, s[4:7], s57 offen offset:0 sc1 lds
    s_waitcnt vmcnt(5)
    buffer_load_dwordx4 v1, s[4:7], s57 offen offset:1024 sc1 lds
    s_waitcnt vmcnt(5)
    buffer_load_dwordx4 v1, s[4:7], s57 offen offset:2048 sc1 lds
    s_waitcnt vmcnt(5)
    buffer_load_dwordx4 v1, s[4:7], s57 offen offset:3072 sc1 lds
    s_barrier
    s_cmp_lg_u32 s62, 0
    s_cbranch_scc1 w4_126
    s_add_u32 s56, s49, 19
    v_mov_b32 v13, s56
    s_mov_b64 exec, 1
    s_cmp_lg_u32 s45, 0
    s_cbranch_scc1 pubs_127
    buffer_store_dword v13, off, s[4:7], s48
pubd_128:
    s_mov_b64 exec, -1
w4_126:
    s_add_u32 m0, s62, 65536
    s_add_u32 s57, s64, 98304
    s_waitcnt vmcnt(5)
    buffer_load_dwordx4 v1, s[4:7], s57 offen offset:0 sc1 lds
    s_waitcnt vmcnt(5)
    buffer_load_dwordx4 v1, s[4:7], s57 offen offset:1024 sc1 lds
    s_waitcnt vmcnt(5)
    buffer_load_dwordx4 v1, s[4:7], s57 offen offset:2048 sc1 lds
    s_waitcnt vmcnt(5)
    buffer_load_dwordx4 v1, s[4:7], s57 offen offset:3072 sc1 lds
    s_add_u32 m0, s62, 81920
    s_add_u32 s57, s64, 114688
    s_waitcnt vmcnt(5)
    buffer_load_dwordx4 v1, s[4:7], s57 offen offset:0 sc1 lds
    s_waitcnt vmcnt(5)
    buffer_load_dwordx4 v1, s[4:7], s57 offen offset:1024 sc1 lds
    s_waitcnt vmcnt(5)
    buffer_load_dwordx4 v1, s[4:7], s57 offen offset:2048 sc1 lds
    s_waitcnt vmcnt(5)
    buffer_load_dwordx4 v1, s[4:7], s57 offen offset:3072 sc1 lds
    s_barrier
    s_cmp_lg_u32 s62, 0
    s_cbranch_scc1 w4_129
    s_add_u32 s56, s49, 20
    v_mov_b32 v13, s56
    s_mov_b64 exec, 1
    s_cmp_lg_u32 s45, 0
    s_cbranch_scc1 pubs_130
    buffer_store_dword v13, off, s[4:7], s48
pubd_131:
    s_mov_b64 exec, -1
w4_129:
    ds_write_b128 v3, v[24:27] offset:32768
    ds_write_b128 v3, v[28:31] offset:33792
    ds_write_b128 v3, v[32:35] offset:34816
    ds_write_b128 v3, v[36:39] offset:35840
    ds_write_b128 v3, v[40:43] offset:49152
    ds_write_b128 v3, v[44:47] offset:50176
    ds_write_b128 v3, v[48:51] offset:51200
    ds_write_b128 v3, v[52:55] offset:52224
    s_waitcnt vmcnt(4)
    s_waitcnt vmcnt(0)
    s_waitcnt lgkmcnt(4)
    s_barrier
    s_cmp_lg_u32 s62, 0
    s_cbranch_scc1 w4_132
    s_add_u32 s56, s49, 21
    v_mov_b32 v13, s56
    s_mov_b64 exec, 1
    s_cmp_lg_u32 s45, 0
    s_cbranch_scc1 pubs_133
    buffer_store_dword v13, off, s[4:7], s48
pubd_134:
    s_mov_b64 exec, -1
w4_132:
    ds_write_b128 v4, v[56:59] offset:0
    ds_write_b128 v4, v[60:63] offset:1024
    ds_write_b128 v4, v[64:67] offset:2048
    ds_write_b128 v4, v[68:71] offset:3072
    ds_write_b128 v2, v[120:123] offset:16384
    ds_write_b128 v2, v[124:127] offset:17408
    ds_write_b128 v2, v[128:131] offset:18432
    ds_write_b128 v2, v[132:135] offset:19456
    ds_write_b128 v2, v[72:75] offset:0
    ds_write_b128 v2, v[76:79] offset:1024
    ds_write_b128 v2, v[80:83] offset:2048
    ds_write_b128 v2, v[84:87] offset:3072
    s_waitcnt lgkmcnt(8)
    s_barrier
    ds_write_b128 v2, v[136:139] offset:32768
    ds_write_b128 v2, v[140:143] offset:33792
    ds_write_b128 v2, v[144:147] offset:34816
    ds_write_b128 v2, v[148:151] offset:35840
    s_waitcnt lgkmcnt(0)
    s_barrier
    s_barrier
    s_endpgm
L_fallback:
    s_add_u32 s53, s59, 131072
    v_subrev_u32 v28, 114176, v17
    s_nop 7
    v_mov_b32 v136, 0x3f803f80
    v_mov_b32 v137, 0x3f803f80
    v_mov_b32 v138, 0x3f803f80
    v_mov_b32 v139, 0x3f803f80
    v_mov_b32 v140, 0x3f803f80
    v_mov_b32 v141, 0x3f803f80
    v_mov_b32 v142, 0x3f803f80
    v_mov_b32 v143, 0x3f803f80
    s_mov_b32 s50, s59
    v_mov_b32 v26, 0xff800000
L_fb1_0:
    buffer_load_dwordx4 v[128:131], v1, s[4:7], s50 offen sc1
    s_waitcnt vmcnt(0)
    v_mfma_f32_32x32x16_bf16 v[32:47], v[128:131], v[8:11], 0
    s_nop 11
    v_max3_f32 v26, v32, v33, v26
    v_max3_f32 v26, v34, v35, v26
    v_max3_f32 v26, v36, v37, v26
    v_max3_f32 v26, v38, v39, v26
    v_max3_f32 v26, v40, v41, v26
    v_max3_f32 v26, v42, v43, v26
    v_max3_f32 v26, v44, v45, v26
    v_max3_f32 v26, v46, v47, v26
    s_add_u32 s50, s50, 2048
    s_cmp_lt_u32 s50, s53
    s_cbranch_scc1 L_fb1_0
    v_mov_b32 v27, v26
    s_nop 1
    v_permlane32_swap_b32 v26, v27
    v_max_f32 v26, v26, v27
    v_sub_f32 v64, 0, v26
    v_sub_f32 v65, 0, v26
    v_sub_f32 v66, 0, v26
    v_sub_f32 v67, 0, v26
    v_sub_f32 v68, 0, v26
    v_sub_f32 v69, 0, v26
    v_sub_f32 v70, 0, v26
    v_sub_f32 v71, 0, v26
    v_sub_f32 v72, 0, v26
    v_sub_f32 v73, 0, v26
    v_sub_f32 v74, 0, v26
    v_sub_f32 v75, 0, v26
    v_sub_f32 v76, 0, v26
    v_sub_f32 v77, 0, v26
    v_sub_f32 v78, 0, v26
    v_sub_f32 v79, 0, v26
    v_mov_b32 v96, 0
    v_mov_b32 v97, 0
    v_mov_b32 v98, 0
    v_mov_b32 v99, 0
    v_mov_b32 v100, 0
    v_mov_b32 v101, 0
    v_mov_b32 v102, 0
    v_mov_b32 v103, 0
    v_mov_b32 v104, 0
    v_mov_b32 v105, 0
    v_mov_b32 v106, 0
    v_mov_b32 v107, 0
    v_mov_b32 v108, 0
    v_mov_b32 v109, 0
    v_mov_b32 v110, 0
    v_mov_b32 v111, 0
    s_mov_b32 s50, s59
L_fb2_0:
    buffer_load_dwordx4 v[128:131], v1, s[4:7], s50 offen sc1
    s_not_b64 exec, s[82:83]
    buffer_load_dwordx4 v[136:139], v28, s[4:7], s50 offen sc1
    buffer_load_dwordx4 v[140:143], v28, s[4:7], s50 offen offset:512 sc1
    s_mov_b64 exec, -1
    s_waitcnt vmcnt(0)
    v_mfma_f32_32x32x16_bf16 v[32:47], v[128:131], v[8:11], v[64:79]
    s_nop 11
    v_exp_f32 v32, v32
    v_exp_f32 v33, v33
    v_exp_f32 v34, v34
    v_exp_f32 v35, v35
    v_exp_f32 v36, v36
    v_exp_f32 v37, v37
    v_exp_f32 v38, v38
    v_exp_f32 v39, v39
    v_exp_f32 v40, v40
    v_exp_f32 v41, v41
    v_exp_f32 v42, v42
    v_exp_f32 v43, v43
    v_exp_f32 v44, v44
    v_exp_f32 v45, v45
    v_exp_f32 v46, v46
    v_exp_f32 v47, v47
    v_smfmac_f32_32x32x32_bf16 v[96:111], v[136:139], v[32:39], v21
    s_nop 0
    v_smfmac_f32_32x32x32_bf16 v[96:111], v[140:143], v[40:47], v21
    s_nop 11
    s_add_u32 s50, s50, 2048
    s_cmp_lt_u32 s50, s53
    s_cbranch_scc1 L_fb2_0
    s_mov_b32 s50, s59
    v_mov_b32 v26, 0xff800000
L_fb1_1:
    buffer_load_dwordx4 v[128:131], v1, s[4:7], s50 offen sc1
    s_waitcnt vmcnt(0)
    v_mfma_f32_32x32x16_bf16 v[32:47], v[128:131], v[12:15], 0
    s_nop 11
    v_max3_f32 v26, v32, v33, v26
    v_max3_f32 v26, v34, v35, v26
    v_max3_f32 v26, v36, v37, v26
    v_max3_f32 v26, v38, v39, v26
    v_max3_f32 v26, v40, v41, v26
    v_max3_f32 v26, v42, v43, v26
    v_max3_f32 v26, v44, v45, v26
    v_max3_f32 v26, v46, v47, v26
    s_add_u32 s50, s50, 2048
    s_cmp_lt_u32 s50, s53
    s_cbranch_scc1 L_fb1_1
    v_mov_b32 v27, v26
    s_nop 1
    v_permlane32_swap_b32 v26, v27
    v_max_f32 v26, v26, v27
    v_sub_f32 v80, 0, v26
    v_sub_f32 v81, 0, v26
    v_sub_f32 v82, 0, v26
    v_sub_f32 v83, 0, v26
    v_sub_f32 v84, 0, v26
    v_sub_f32 v85, 0, v26
    v_sub_f32 v86, 0, v26
    v_sub_f32 v87, 0, v26
    v_sub_f32 v88, 0, v26
    v_sub_f32 v89, 0, v26
    v_sub_f32 v90, 0, v26
    v_sub_f32 v91, 0, v26
    v_sub_f32 v92, 0, v26
    v_sub_f32 v93, 0, v26
    v_sub_f32 v94, 0, v26
    v_sub_f32 v95, 0, v26
    v_mov_b32 v112, 0
    v_mov_b32 v113, 0
    v_mov_b32 v114, 0
    v_mov_b32 v115, 0
    v_mov_b32 v116, 0
    v_mov_b32 v117, 0
    v_mov_b32 v118, 0
    v_mov_b32 v119, 0
    v_mov_b32 v120, 0
    v_mov_b32 v121, 0
    v_mov_b32 v122, 0
    v_mov_b32 v123, 0
    v_mov_b32 v124, 0
    v_mov_b32 v125, 0
    v_mov_b32 v126, 0
    v_mov_b32 v127, 0
    s_mov_b32 s50, s59
L_fb2_1:
    buffer_load_dwordx4 v[128:131], v1, s[4:7], s50 offen sc1
    s_not_b64 exec, s[82:83]
    buffer_load_dwordx4 v[136:139], v28, s[4:7], s50 offen sc1
    buffer_load_dwordx4 v[140:143], v28, s[4:7], s50 offen offset:512 sc1
    s_mov_b64 exec, -1
    s_waitcnt vmcnt(0)
    v_mfma_f32_32x32x16_bf16 v[32:47], v[128:131], v[12:15], v[80:95]
    s_nop 11
    v_exp_f32 v32, v32
    v_exp_f32 v33, v33
    v_exp_f32 v34, v34
    v_exp_f32 v35, v35
    v_exp_f32 v36, v36
    v_exp_f32 v37, v37
    v_exp_f32 v38, v38
    v_exp_f32 v39, v39
    v_exp_f32 v40, v40
    v_exp_f32 v41, v41
    v_exp_f32 v42, v42
    v_exp_f32 v43, v43
    v_exp_f32 v44, v44
    v_exp_f32 v45, v45
    v_exp_f32 v46, v46
    v_exp_f32 v47, v47
    v_smfmac_f32_32x32x32_bf16 v[112:127], v[136:139], v[32:39], v21
    s_nop 0
    v_smfmac_f32_32x32x32_bf16 v[112:127], v[140:143], v[40:47], v21
    s_nop 11
    s_add_u32 s50, s50, 2048
    s_cmp_lt_u32 s50, s53
    s_cbranch_scc1 L_fb2_1
    s_branch L_attn_fin
pubs_2:
    s_waitcnt vmcnt(0)
    buffer_wbl2 sc1
    s_waitcnt vmcnt(0)
    buffer_store_dword v27, off, s[4:7], s48 sc1
    s_branch pubd_3
pubs_4:
    s_waitcnt vmcnt(0)
    buffer_wbl2 sc1
    s_waitcnt vmcnt(0)
    buffer_store_dword v26, off, s[4:7], s48 sc1
    s_branch pubd_5
pubs_10:
    s_waitcnt vmcnt(0)
    buffer_wbl2 sc1
    s_waitcnt vmcnt(0)
    buffer_store_dword v15, off, s[4:7], s48 sc1
    s_branch pubd_11
pubs_24:
    s_waitcnt vmcnt(0)
    buffer_wbl2 sc1
    s_waitcnt vmcnt(0)
    buffer_store_dword v11, off, s[4:7], s48 sc1
    s_branch pubd_25
pubs_31:
    s_waitcnt vmcnt(0)
    buffer_wbl2 sc1
    s_waitcnt vmcnt(0)
    buffer_store_dword v27, off, s[4:7], s48 sc1
    s_branch pubd_32
pubs_83:
    s_waitcnt vmcnt(0)
    buffer_wbl2 sc1
    s_waitcnt vmcnt(0)
    buffer_store_dword v13, off, s[4:7], s48 sc1
    s_branch pubd_84
pubs_86:
    s_waitcnt vmcnt(0)
    buffer_wbl2 sc1
    s_waitcnt vmcnt(0)
    buffer_store_dword v13, off, s[4:7], s48 sc1
    s_branch pubd_87
pubs_89:
    s_waitcnt vmcnt(0)
    buffer_wbl2 sc1
    s_waitcnt vmcnt(0)
    buffer_store_dword v13, off, s[4:7], s48 sc1
    s_branch pubd_90
pubs_92:
    s_waitcnt vmcnt(0)
    buffer_wbl2 sc1
    s_waitcnt vmcnt(0)
    buffer_store_dword v13, off, s[4:7], s48 sc1
    s_branch pubd_93
pubs_124:
    s_waitcnt vmcnt(0)
    buffer_wbl2 sc1
    s_waitcnt vmcnt(0)
    buffer_store_dword v13, off, s[4:7], s48 sc1
    s_branch pubd_125
pubs_127:
    s_waitcnt vmcnt(0)
    buffer_wbl2 sc1
    s_waitcnt vmcnt(0)
    buffer_store_dword v13, off, s[4:7], s48 sc1
    s_branch pubd_128
pubs_130:
    s_waitcnt vmcnt(0)
    buffer_wbl2 sc1
    s_waitcnt vmcnt(0)
    buffer_store_dword v13, off, s[4:7], s48 sc1
    s_branch pubd_131
pubs_133:
    s_waitcnt vmcnt(0)
    buffer_wbl2 sc1
    s_waitcnt vmcnt(0)
    buffer_store_dword v13, off, s[4:7], s48 sc1
    s_branch pubd_134
pt_7:
    s_mov_b32 s46, 0
pa_8:
    s_waitcnt vmcnt(0)
    buffer_inv sc1
    s_waitcnt vmcnt(0)
    s_branch pd_9
pt_13:
    s_mov_b32 s46, 0
pa_14:
    s_waitcnt vmcnt(0)
    buffer_inv sc1
    s_waitcnt vmcnt(0)
    s_branch pd_15
pcs_16:
    s_add_u32 s56, s49, 2
pl_135:
    buffer_load_dword v15, v14, s[4:7], s47 offen sc1
    s_sub_u32 s46, s46, 1
    s_cbranch_scc1 pt_136
    s_cmp_lg_u32 s45, 0
    s_waitcnt vmcnt(0)
    v_cmp_gt_u32 vcc, s56, v15
    s_cbranch_vccnz pl_135
    s_cbranch_scc1 pa_137
pd_138:
    s_branch pc_17
pcs_18:
    s_add_u32 s56, s49, 3
pl_139:
    buffer_load_dword v15, v14, s[4:7], s47 offen sc1
    s_sub_u32 s46, s46, 1
    s_cbranch_scc1 pt_140
    s_cmp_lg_u32 s45, 0
    s_waitcnt vmcnt(0)
    v_cmp_gt_u32 vcc, s56, v15
    s_cbranch_vccnz pl_139
    s_cbranch_scc1 pa_141
pd_142:
    s_branch pc_19
pcs_20:
    s_add_u32 s56, s49, 4
pl_143:
    buffer_load_dword v15, v14, s[4:7], s47 offen sc1
    s_sub_u32 s46, s46, 1
    s_cbranch_scc1 pt_144
    s_cmp_lg_u32 s45, 0
    s_waitcnt vmcnt(0)
    v_cmp_gt_u32 vcc, s56, v15
    s_cbranch_vccnz pl_143
    s_cbranch_scc1 pa_145
pd_146:
    s_branch pc_21
pcs_22:
    s_add_u32 s56, s49, 5
pl_147:
    buffer_load_dword v15, v14, s[4:7], s47 offen sc1
    s_sub_u32 s46, s46, 1
    s_cbranch_scc1 pt_148
    s_cmp_lg_u32 s45, 0
    s_waitcnt vmcnt(0)
    v_cmp_gt_u32 vcc, s56, v15
    s_cbranch_vccnz pl_147
    s_cbranch_scc1 pa_149
pd_150:
    s_branch pc_23
pt_27:
    s_mov_b32 s46, 0
pa_28:
    s_waitcnt vmcnt(0)
    buffer_inv sc1
    s_waitcnt vmcnt(0)
    s_branch pd_29
pt_44:
    s_mov_b32 s46, 0
pa_45:
    s_waitcnt vmcnt(0)
    buffer_inv sc1
    s_waitcnt vmcnt(0)
    s_branch pd_46
pt_95:
    s_mov_b32 s46, 0
pa_96:
    s_waitcnt vmcnt(0)
    buffer_inv sc1
    s_waitcnt vmcnt(0)
    s_branch pd_97
pt_136:
    s_mov_b32 s46, 0
pa_137:
    s_waitcnt vmcnt(0)
    buffer_inv sc1
    s_waitcnt vmcnt(0)
    s_branch pd_138
pt_140:
    s_mov_b32 s46, 0
pa_141:
    s_waitcnt vmcnt(0)
    buffer_inv sc1
    s_waitcnt vmcnt(0)
    s_branch pd_142
pt_144:
    s_mov_b32 s46, 0
pa_145:
    s_waitcnt vmcnt(0)
    buffer_inv sc1
    s_waitcnt vmcnt(0)
    s_branch pd_146
pt_148:
    s_mov_b32 s46, 0
pa_149:
    s_waitcnt vmcnt(0)
    buffer_inv sc1
    s_waitcnt vmcnt(0)
    s_branch pd_150
L_end:
.section .rodata,"a"
.p2align 6
.amdhsa_kernel interleave_layers__softmax_full_mha__glu_gated_swiglu__prompt_kernel
  .amdhsa_next_free_vgpr 256
  .amdhsa_next_free_sgpr 98
  .amdhsa_accum_offset 256
  .amdhsa_group_segment_fixed_size 0
  .amdhsa_kernarg_size 80
  .amdhsa_user_sgpr_count 2
  .amdhsa_user_sgpr_kernarg_segment_ptr 1
  .amdhsa_system_sgpr_workgroup_id_x 1
.end_amdhsa_kernel
```
